```python
import torch

def _softmax(x, axis=-1):
    return torch.softmax(x, dim=axis)

def _gelu(x):
    return torch.nn.functional.gelu(x, approximate='tanh')

def _silu(x):
    return torch.nn.functional.silu(x)

def _sigmoid(x):
    return torch.sigmoid(x)

def _layernorm(x, axis=-1, eps=1e-05):
    m = x.mean(dim=axis, keepdim=True)
    v = x.var(dim=axis, keepdim=True, unbiased=False)
    return (x - m) / torch.sqrt(v + eps)

def _scatter_add(tgt, idx, src, axis=0):
    return tgt.clone().index_add_(axis, idx, src)

def _segment_sum(src, seg, n):
    out = torch.zeros((n,) + src.shape[1:], dtype=src.dtype)
    return out.index_add_(0, seg, src)

def _pad(x, pw):
    flat = tuple((v for pair in reversed(pw) for v in pair))
    return torch.nn.functional.pad(x, flat)
kernel_name = 'gated_mix__spectral_gfnet__memory_aug_recurrent_mem_tr__prompt'

def setup_inputs():

    _w = lambda a: (lambda t: t.to(torch.bfloat16) if t.is_floating_point() else t)(torch.as_tensor(a))

    def _A_setup():
        B, S, D = (1, 2048, 640)
        Df = D // 2 + 1
        return {'x': _w((lambda *s: torch.randn(*s, dtype=torch.bfloat16) * 0.05)(B, S, D)), 'w_r': _w((lambda *s: torch.randn(*s, dtype=torch.bfloat16) * 3.2)(S, Df) * 0.02), 'w_i': _w((lambda *s: torch.randn(*s, dtype=torch.bfloat16) * 3.2)(S, Df) * 0.02)}
    _A_in = _A_setup()

    def _B_setup():
        B, S, Dm = (1, 2048, 640)
        H, Dh = (32, 128)
        M, seg = (8, 32)
        seg = min(seg, S)
        S = S // seg * seg
        return {'x': _w((lambda *s: torch.randn(*s, dtype=torch.bfloat16) * 0.05)(B, S, Dm)), 'mem0': _w((lambda *s: torch.randn(*s, dtype=torch.bfloat16) * 0.4)(B, M, Dm)), 'Wq': _w((lambda *s: torch.randn(*s, dtype=torch.bfloat16) * 6.4)(Dm, H, Dh) * Dm ** (-0.5)), 'Wk': _w((lambda *s: torch.randn(*s, dtype=torch.bfloat16) * 6.4)(Dm, H, Dh) * Dm ** (-0.5)), 'Wv': _w((lambda *s: torch.randn(*s, dtype=torch.bfloat16) * 0.4)(Dm, H, Dh) * Dm ** (-0.5)), 'Wo': _w((lambda *s: torch.randn(*s, dtype=torch.bfloat16) * 0.4)(H, Dh, Dm) * (H * Dh) ** (-0.5)), 'seg_len': seg}
    _B_in = _B_setup()
    return {'A_x': _A_in['x'], 'A_w_r': _A_in['w_r'], 'A_w_i': _A_in['w_i'], 'B_x': _B_in['x'], 'B_mem0': _B_in['mem0'], 'B_Wq': _B_in['Wq'], 'B_Wk': _B_in['Wk'], 'B_Wv': _B_in['Wv'], 'B_Wo': _B_in['Wo'], 'B_seg_len': _B_in['seg_len'], 'gate_w': _w((lambda *s: torch.randn(*s, dtype=torch.bfloat16) * 0.05)(640) * 16.0)}

def reference(A_x, A_w_r, A_w_i, B_x, B_mem0, B_Wq, B_Wk, B_Wv, B_Wo, B_seg_len, gate_w):

    def _A_ref(x, w_r, w_i):
        B, S, D = x.shape
        X = (lambda x, axes=(-2, -1): torch.fft.rfft2(x.float(), dim=axes))(x, axes=(-2, -1))
        W = w_r + 1j * w_i
        X = X * W
        y = (lambda x, s, axes=(-2, -1): torch.fft.irfft2(x, s=s, dim=axes).to(torch.bfloat16))(X, (S, D), axes=(-2, -1))
        return y

    def _B_ref(x, mem0, Wq, Wk, Wv, Wo, seg_len):
        B, S, Dm = x.shape
        H, Dh = (Wq.shape[1], Wq.shape[2])
        M = mem0.shape[1]
        scale = Dh ** (-0.5)
        n_seg = S // seg_len
        L = M + seg_len
        idx = torch.arange(L)
        mask = (idx[:, None] < M) | (idx[:, None] >= idx[None, :])
        mem = mem0
        outs = []
        for s in range(n_seg):
            xs = x[:, s * seg_len:(s + 1) * seg_len, :].clone()
            h = torch.concatenate([mem, xs], axis=1)
            q = torch.einsum('btd,dhe->bhte', h, Wq)
            k = torch.einsum('btd,dhe->bhte', h, Wk)
            v = torch.einsum('btd,dhe->bhte', h, Wv)
            scores = torch.einsum('bhqe,bhke->bhqk', q, k) * scale
            scores = torch.where(mask[None, None], scores, -1000000000.0)
            p = _softmax(scores, axis=-1)
            o = torch.einsum('bhqk,bhke->bhqe', p, v)
            o = torch.einsum('bhte,hed->btd', o, Wo)
            mem = o[:, :M, :].clone()
            outs.append(o[:, M:, :])
        return torch.concatenate(outs, axis=1)
    x = A_x
    g = _sigmoid((x * gate_w).sum(-1, keepdims=True))
    a = _A_ref(x, A_w_r, A_w_i)
    b = _B_ref(x, B_mem0, B_Wq, B_Wk, B_Wv, B_Wo, B_seg_len)
    return g * a + (1 - g) * b
```

```asm
; @launch kernel=fused_kernel grid=(256,1,1) block=(256,1,1) lds=152448
.amdgcn_target "amdgcn-amd-amdhsa--gfx950"
.text
.globl fused_kernel
.p2align 8
.type fused_kernel,@function
fused_kernel:
    s_cmp_ge_u32 s2, 256
    s_cbranch_scc1 .exit_1
    s_load_dwordx16 s[40:55], s[0:1], 0
    s_load_dwordx8 s[56:63], s[0:1], 64
    s_load_dwordx4 s[64:67], s[0:1], 96
    s_waitcnt lgkmcnt(0)
    s_mov_b32 s8, s40
    s_and_b32 s9, s41, 0xffff
    s_mov_b32 s10, 2621440
    s_mov_b32 s11, 0x00020000
    s_mov_b32 s16, s66
    s_and_b32 s17, s67, 0xffff
    s_mov_b32 s18, 268435456
    s_mov_b32 s19, 0x00020000
    s_mov_b32 s20, s62
    s_and_b32 s21, s63, 0xffff
    s_mov_b32 s22, 2621440
    s_mov_b32 s23, 0x00020000
    s_mov_b32 s3, s2
    s_mov_b32 s96, s64
    s_and_b32 s97, s65, 0xffff
    s_mov_b32 s98, 256
    s_mov_b32 s99, 0x00020000
    s_cmp_ge_u32 s2, 64
    s_cbranch_scc1 .work_2
    v_lshlrev_b32 v1, 4, v0
    v_mov_b32 v4, 0
    v_mov_b32 v5, 0
    v_mov_b32 v6, 0
    v_mov_b32 v7, 0
    v_mov_b32 v8, -1
    v_mov_b32 v9, -1
    v_mov_b32 v10, -1
    v_mov_b32 v11, -1
    s_mul_i32 s4, s3, 20480
    s_add_u32 s4, s4, 104857600
    buffer_store_dwordx4 v[4:7], v1, s[16:19], s4 offen sc1
    s_add_u32 s4, s4, 4096
    buffer_store_dwordx4 v[4:7], v1, s[16:19], s4 offen sc1
    s_add_u32 s4, s4, 4096
    buffer_store_dwordx4 v[4:7], v1, s[16:19], s4 offen sc1
    s_add_u32 s4, s4, 4096
    buffer_store_dwordx4 v[4:7], v1, s[16:19], s4 offen sc1
    s_add_u32 s4, s4, 4096
    buffer_store_dwordx4 v[4:7], v1, s[16:19], s4 offen sc1
    s_add_u32 s4, s4, 4096
    s_mul_i32 s4, s3, 20480
    s_add_u32 s4, s4, 106954752
    buffer_store_dwordx4 v[8:11], v1, s[16:19], s4 offen sc1
    s_add_u32 s4, s4, 4096
    buffer_store_dwordx4 v[8:11], v1, s[16:19], s4 offen sc1
    s_add_u32 s4, s4, 4096
    buffer_store_dwordx4 v[8:11], v1, s[16:19], s4 offen sc1
    s_add_u32 s4, s4, 4096
    buffer_store_dwordx4 v[8:11], v1, s[16:19], s4 offen sc1
    s_add_u32 s4, s4, 4096
    buffer_store_dwordx4 v[8:11], v1, s[16:19], s4 offen sc1
    s_add_u32 s4, s4, 4096
    s_lshl_b32 s4, s3, 12
    s_add_u32 s4, s4, 109051904
    s_cmp_lt_u32 s3, 5
    s_cselect_b32 s4, s4, 0x7ff00000
    buffer_store_dwordx4 v[4:7], v1, s[16:19], s4 offen sc1
    s_waitcnt vmcnt(0)
    s_barrier
    v_mov_b32 v4, 1
    v_mov_b32 v5, 128
    v_cmp_eq_u32 vcc, 0, v0
    s_and_saveexec_b64 s[84:85], vcc
    buffer_atomic_add v4, v5, s[96:99], 0 offen
    s_mov_b64 exec, s[84:85]
    s_mov_b32 s12, s50
    s_and_b32 s13, s51, 0xffff
    s_mov_b32 s14, 5242880
    s_mov_b32 s15, 0x00020000
    s_mov_b32 s24, s52
    s_and_b32 s25, s53, 0xffff
    s_mov_b32 s26, 5242880
    s_mov_b32 s27, 0x00020000
    s_mov_b32 s28, s54
    s_and_b32 s29, s55, 0xffff
    s_mov_b32 s30, 5242880
    s_mov_b32 s31, 0x00020000
    s_mov_b32 s68, s56
    s_and_b32 s69, s57, 0xffff
    s_mov_b32 s70, 5242880
    s_mov_b32 s71, 0x00020000
    s_mov_b32 s72, s48
    s_and_b32 s73, s49, 0xffff
    s_mov_b32 s74, 10240
    s_mov_b32 s75, 0x00020000
    s_lshr_b32 s4, s3, 1
    s_and_b32 s5, s3, 1
    v_and_b32 v1, 63, v0
    v_lshrrev_b32 v2, 6, v0
    s_nop 0
    v_readfirstlane_b32 s6, v2
    v_and_b32 v3, 15, v1
    v_lshrrev_b32 v4, 4, v1
    v_lshrrev_b32 v5, 2, v3
    v_and_b32 v6, 3, v3
    v_lshrrev_b32 v8, 4, v0
    v_and_b32 v9, 15, v0
    v_lshlrev_b32 v10, 13, v8
    v_lshl_add_u32 v10, v9, 4, v10
    s_lshl_b32 s7, s4, 8
    v_add_u32 v10, s7, v10
    v_add_u32 v11, 131072, v10
    v_mul_u32_u24 v12, 656, v8
    v_lshl_add_u32 v12, v9, 4, v12
    v_add_u32 v12, 110464, v12
    v_lshrrev_b32 v8, 3, v0
    v_and_b32 v9, 7, v0
    v_lshlrev_b32 v13, 13, v8
    v_lshl_add_u32 v13, v9, 4, v13
    s_lshl_b32 s37, s5, 7
    s_add_u32 s7, s7, s37
    v_add_u32 v13, s7, v13
    v_mul_u32_u24 v14, 656, v8
    v_lshl_add_u32 v14, v9, 4, v14
    v_add_u32 v14, 110976, v14
    v_lshl_add_u32 v8, v4, 3, v5
    v_mul_u32_u24 v15, 656, v8
    v_lshl_add_u32 v15, v6, 4, v15
    v_add_u32 v15, 110464, v15
    s_lshl_b32 s7, s6, 6
    v_add_u32 v16, s7, v15
    s_lshr_b32 s7, s6, 1
    s_lshl_b32 s7, s7, 6
    s_and_b32 s37, s6, 1
    s_lshl_b32 s37, s37, 3
    s_add_u32 s7, s7, s37
    s_add_u32 s7, s7, 512
    v_add_u32 v17, s7, v15
    s_mul_i32 s7, s6, 20480
    s_add_u32 s7, s7, 28544
    v_lshlrev_b32 v18, 4, v1
    v_add_u32 v18, s7, v18
    s_mov_b32 s38, 0
    buffer_load_dwordx4 v[44:47], v10, s[12:15], s38 offen
    buffer_load_dwordx4 v[48:51], v11, s[12:15], s38 offen
    buffer_load_dwordx4 v[52:55], v10, s[24:27], s38 offen
    buffer_load_dwordx4 v[56:59], v11, s[24:27], s38 offen
    buffer_load_dwordx4 v[60:63], v13, s[28:31], s38 offen
    s_mov_b32 s38, 262144
    buffer_load_dwordx4 v[64:67], v10, s[12:15], s38 offen
    buffer_load_dwordx4 v[68:71], v11, s[12:15], s38 offen
    buffer_load_dwordx4 v[72:75], v10, s[24:27], s38 offen
    buffer_load_dwordx4 v[76:79], v11, s[24:27], s38 offen
    buffer_load_dwordx4 v[80:83], v13, s[28:31], s38 offen
    s_mov_b32 s38, 524288
    buffer_load_dwordx4 v[84:87], v10, s[12:15], s38 offen
    buffer_load_dwordx4 v[88:91], v11, s[12:15], s38 offen
    buffer_load_dwordx4 v[92:95], v10, s[24:27], s38 offen
    buffer_load_dwordx4 v[96:99], v11, s[24:27], s38 offen
    buffer_load_dwordx4 v[100:103], v13, s[28:31], s38 offen
    s_waitcnt vmcnt(10)
    ds_write_b128 v12, v[44:47] offset:0
    ds_write_b128 v12, v[48:51] offset:10496
    ds_write_b128 v12, v[52:55] offset:256
    ds_write_b128 v12, v[56:59] offset:10752
    ds_write_b128 v14, v[60:63] offset:0
    s_waitcnt lgkmcnt(0)
    s_mov_b32 s38, 786432
    buffer_load_dwordx4 v[44:47], v10, s[12:15], s38 offen
    buffer_load_dwordx4 v[48:51], v11, s[12:15], s38 offen
    buffer_load_dwordx4 v[52:55], v10, s[24:27], s38 offen
    buffer_load_dwordx4 v[56:59], v11, s[24:27], s38 offen
    buffer_load_dwordx4 v[60:63], v13, s[28:31], s38 offen
    s_barrier
    ds_read_b64_tr_b16 a[0:1], v16 offset:0
    ds_read_b64_tr_b16 a[2:3], v16 offset:2624
    ds_read_b64_tr_b16 a[80:81], v16 offset:8
    ds_read_b64_tr_b16 a[82:83], v16 offset:2632
    ds_read_b64_tr_b16 a[160:161], v16 offset:256
    ds_read_b64_tr_b16 a[162:163], v16 offset:2880
    ds_read_b64_tr_b16 a[240:241], v16 offset:264
    ds_read_b64_tr_b16 a[242:243], v16 offset:2888
    ds_read_b64_tr_b16 v[40:41], v17 offset:0
    ds_read_b64_tr_b16 v[42:43], v17 offset:2624
    s_waitcnt lgkmcnt(0)
    ds_write_b128 v18, v[40:43] offset:0
    s_waitcnt vmcnt(10)
    ds_write_b128 v12, v[64:67] offset:20992
    ds_write_b128 v12, v[68:71] offset:31488
    ds_write_b128 v12, v[72:75] offset:21248
    ds_write_b128 v12, v[76:79] offset:31744
    ds_write_b128 v14, v[80:83] offset:20992
    s_waitcnt lgkmcnt(0)
    s_mov_b32 s38, 1048576
    buffer_load_dwordx4 v[64:67], v10, s[12:15], s38 offen
    buffer_load_dwordx4 v[68:71], v11, s[12:15], s38 offen
    buffer_load_dwordx4 v[72:75], v10, s[24:27], s38 offen
    buffer_load_dwordx4 v[76:79], v11, s[24:27], s38 offen
    buffer_load_dwordx4 v[80:83], v13, s[28:31], s38 offen
    s_barrier
    ds_read_b64_tr_b16 a[4:5], v16 offset:20992
    ds_read_b64_tr_b16 a[6:7], v16 offset:23616
    ds_read_b64_tr_b16 a[84:85], v16 offset:21000
    ds_read_b64_tr_b16 a[86:87], v16 offset:23624
    ds_read_b64_tr_b16 a[164:165], v16 offset:21248
    ds_read_b64_tr_b16 a[166:167], v16 offset:23872
    ds_read_b64_tr_b16 a[244:245], v16 offset:21256
    ds_read_b64_tr_b16 a[246:247], v16 offset:23880
    ds_read_b64_tr_b16 v[40:41], v17 offset:20992
    ds_read_b64_tr_b16 v[42:43], v17 offset:23616
    s_waitcnt lgkmcnt(0)
    ds_write_b128 v18, v[40:43] offset:1024
    s_waitcnt vmcnt(10)
    ds_write_b128 v12, v[84:87] offset:0
    ds_write_b128 v12, v[88:91] offset:10496
    ds_write_b128 v12, v[92:95] offset:256
    ds_write_b128 v12, v[96:99] offset:10752
    ds_write_b128 v14, v[100:103] offset:0
    s_waitcnt lgkmcnt(0)
    s_mov_b32 s38, 1310720
    buffer_load_dwordx4 v[84:87], v10, s[12:15], s38 offen
    buffer_load_dwordx4 v[88:91], v11, s[12:15], s38 offen
    buffer_load_dwordx4 v[92:95], v10, s[24:27], s38 offen
    buffer_load_dwordx4 v[96:99], v11, s[24:27], s38 offen
    buffer_load_dwordx4 v[100:103], v13, s[28:31], s38 offen
    s_barrier
    ds_read_b64_tr_b16 a[8:9], v16 offset:0
    ds_read_b64_tr_b16 a[10:11], v16 offset:2624
    ds_read_b64_tr_b16 a[88:89], v16 offset:8
    ds_read_b64_tr_b16 a[90:91], v16 offset:2632
    ds_read_b64_tr_b16 a[168:169], v16 offset:256
    ds_read_b64_tr_b16 a[170:171], v16 offset:2880
    ds_read_b64_tr_b16 a[248:249], v16 offset:264
    ds_read_b64_tr_b16 a[250:251], v16 offset:2888
    ds_read_b64_tr_b16 v[40:41], v17 offset:0
    ds_read_b64_tr_b16 v[42:43], v17 offset:2624
    s_waitcnt lgkmcnt(0)
    ds_write_b128 v18, v[40:43] offset:2048
    s_waitcnt vmcnt(10)
    ds_write_b128 v12, v[44:47] offset:20992
    ds_write_b128 v12, v[48:51] offset:31488
    ds_write_b128 v12, v[52:55] offset:21248
    ds_write_b128 v12, v[56:59] offset:31744
    ds_write_b128 v14, v[60:63] offset:20992
    s_waitcnt lgkmcnt(0)
    s_mov_b32 s38, 1572864
    buffer_load_dwordx4 v[44:47], v10, s[12:15], s38 offen
    buffer_load_dwordx4 v[48:51], v11, s[12:15], s38 offen
    buffer_load_dwordx4 v[52:55], v10, s[24:27], s38 offen
    buffer_load_dwordx4 v[56:59], v11, s[24:27], s38 offen
    buffer_load_dwordx4 v[60:63], v13, s[28:31], s38 offen
    s_barrier
    ds_read_b64_tr_b16 a[12:13], v16 offset:20992
    ds_read_b64_tr_b16 a[14:15], v16 offset:23616
    ds_read_b64_tr_b16 a[92:93], v16 offset:21000
    ds_read_b64_tr_b16 a[94:95], v16 offset:23624
    ds_read_b64_tr_b16 a[172:173], v16 offset:21248
    ds_read_b64_tr_b16 a[174:175], v16 offset:23872
    ds_read_b64_tr_b16 a[252:253], v16 offset:21256
    ds_read_b64_tr_b16 a[254:255], v16 offset:23880
    ds_read_b64_tr_b16 v[40:41], v17 offset:20992
    ds_read_b64_tr_b16 v[42:43], v17 offset:23616
    s_waitcnt lgkmcnt(0)
    ds_write_b128 v18, v[40:43] offset:3072
    s_waitcnt vmcnt(10)
    ds_write_b128 v12, v[64:67] offset:0
    ds_write_b128 v12, v[68:71] offset:10496
    ds_write_b128 v12, v[72:75] offset:256
    ds_write_b128 v12, v[76:79] offset:10752
    ds_write_b128 v14, v[80:83] offset:0
    s_waitcnt lgkmcnt(0)
    s_mov_b32 s38, 1835008
    buffer_load_dwordx4 v[64:67], v10, s[12:15], s38 offen
    buffer_load_dwordx4 v[68:71], v11, s[12:15], s38 offen
    buffer_load_dwordx4 v[72:75], v10, s[24:27], s38 offen
    buffer_load_dwordx4 v[76:79], v11, s[24:27], s38 offen
    buffer_load_dwordx4 v[80:83], v13, s[28:31], s38 offen
    s_barrier
    ds_read_b64_tr_b16 a[16:17], v16 offset:0
    ds_read_b64_tr_b16 a[18:19], v16 offset:2624
    ds_read_b64_tr_b16 a[96:97], v16 offset:8
    ds_read_b64_tr_b16 a[98:99], v16 offset:2632
    ds_read_b64_tr_b16 a[176:177], v16 offset:256
    ds_read_b64_tr_b16 a[178:179], v16 offset:2880
    ds_read_b64_tr_b16 v[192:193], v16 offset:264
    ds_read_b64_tr_b16 v[194:195], v16 offset:2888
    ds_read_b64_tr_b16 v[40:41], v17 offset:0
    ds_read_b64_tr_b16 v[42:43], v17 offset:2624
    s_waitcnt lgkmcnt(0)
    ds_write_b128 v18, v[40:43] offset:4096
    s_waitcnt vmcnt(10)
    ds_write_b128 v12, v[84:87] offset:20992
    ds_write_b128 v12, v[88:91] offset:31488
    ds_write_b128 v12, v[92:95] offset:21248
    ds_write_b128 v12, v[96:99] offset:31744
    ds_write_b128 v14, v[100:103] offset:20992
    s_waitcnt lgkmcnt(0)
    s_mov_b32 s38, 2097152
    buffer_load_dwordx4 v[84:87], v10, s[12:15], s38 offen
    buffer_load_dwordx4 v[88:91], v11, s[12:15], s38 offen
    buffer_load_dwordx4 v[92:95], v10, s[24:27], s38 offen
    buffer_load_dwordx4 v[96:99], v11, s[24:27], s38 offen
    buffer_load_dwordx4 v[100:103], v13, s[28:31], s38 offen
    s_barrier
    ds_read_b64_tr_b16 a[20:21], v16 offset:20992
    ds_read_b64_tr_b16 a[22:23], v16 offset:23616
    ds_read_b64_tr_b16 a[100:101], v16 offset:21000
    ds_read_b64_tr_b16 a[102:103], v16 offset:23624
    ds_read_b64_tr_b16 a[180:181], v16 offset:21248
    ds_read_b64_tr_b16 a[182:183], v16 offset:23872
    ds_read_b64_tr_b16 v[196:197], v16 offset:21256
    ds_read_b64_tr_b16 v[198:199], v16 offset:23880
    ds_read_b64_tr_b16 v[40:41], v17 offset:20992
    ds_read_b64_tr_b16 v[42:43], v17 offset:23616
    s_waitcnt lgkmcnt(0)
    ds_write_b128 v18, v[40:43] offset:5120
    s_waitcnt vmcnt(10)
    ds_write_b128 v12, v[44:47] offset:0
    ds_write_b128 v12, v[48:51] offset:10496
    ds_write_b128 v12, v[52:55] offset:256
    ds_write_b128 v12, v[56:59] offset:10752
    ds_write_b128 v14, v[60:63] offset:0
    s_waitcnt lgkmcnt(0)
    s_mov_b32 s38, 2359296
    buffer_load_dwordx4 v[44:47], v10, s[12:15], s38 offen
    buffer_load_dwordx4 v[48:51], v11, s[12:15], s38 offen
    buffer_load_dwordx4 v[52:55], v10, s[24:27], s38 offen
    buffer_load_dwordx4 v[56:59], v11, s[24:27], s38 offen
    buffer_load_dwordx4 v[60:63], v13, s[28:31], s38 offen
    s_barrier
    ds_read_b64_tr_b16 a[24:25], v16 offset:0
    ds_read_b64_tr_b16 a[26:27], v16 offset:2624
    ds_read_b64_tr_b16 a[104:105], v16 offset:8
    ds_read_b64_tr_b16 a[106:107], v16 offset:2632
    ds_read_b64_tr_b16 a[184:185], v16 offset:256
    ds_read_b64_tr_b16 a[186:187], v16 offset:2880
    ds_read_b64_tr_b16 v[200:201], v16 offset:264
    ds_read_b64_tr_b16 v[202:203], v16 offset:2888
    ds_read_b64_tr_b16 v[40:41], v17 offset:0
    ds_read_b64_tr_b16 v[42:43], v17 offset:2624
    s_waitcnt lgkmcnt(0)
    ds_write_b128 v18, v[40:43] offset:6144
    s_waitcnt vmcnt(10)
    ds_write_b128 v12, v[64:67] offset:20992
    ds_write_b128 v12, v[68:71] offset:31488
    ds_write_b128 v12, v[72:75] offset:21248
    ds_write_b128 v12, v[76:79] offset:31744
    ds_write_b128 v14, v[80:83] offset:20992
    s_waitcnt lgkmcnt(0)
    s_mov_b32 s38, 2621440
    buffer_load_dwordx4 v[64:67], v10, s[12:15], s38 offen
    buffer_load_dwordx4 v[68:71], v11, s[12:15], s38 offen
    buffer_load_dwordx4 v[72:75], v10, s[24:27], s38 offen
    buffer_load_dwordx4 v[76:79], v11, s[24:27], s38 offen
    buffer_load_dwordx4 v[80:83], v13, s[28:31], s38 offen
    s_barrier
    ds_read_b64_tr_b16 a[28:29], v16 offset:20992
    ds_read_b64_tr_b16 a[30:31], v16 offset:23616
    ds_read_b64_tr_b16 a[108:109], v16 offset:21000
    ds_read_b64_tr_b16 a[110:111], v16 offset:23624
    ds_read_b64_tr_b16 a[188:189], v16 offset:21248
    ds_read_b64_tr_b16 a[190:191], v16 offset:23872
    ds_read_b64_tr_b16 v[204:205], v16 offset:21256
    ds_read_b64_tr_b16 v[206:207], v16 offset:23880
    ds_read_b64_tr_b16 v[40:41], v17 offset:20992
    ds_read_b64_tr_b16 v[42:43], v17 offset:23616
    s_waitcnt lgkmcnt(0)
    ds_write_b128 v18, v[40:43] offset:7168
    s_waitcnt vmcnt(10)
    ds_write_b128 v12, v[84:87] offset:0
    ds_write_b128 v12, v[88:91] offset:10496
    ds_write_b128 v12, v[92:95] offset:256
    ds_write_b128 v12, v[96:99] offset:10752
    ds_write_b128 v14, v[100:103] offset:0
    s_waitcnt lgkmcnt(0)
    s_mov_b32 s38, 2883584
    buffer_load_dwordx4 v[84:87], v10, s[12:15], s38 offen
    buffer_load_dwordx4 v[88:91], v11, s[12:15], s38 offen
    buffer_load_dwordx4 v[92:95], v10, s[24:27], s38 offen
    buffer_load_dwordx4 v[96:99], v11, s[24:27], s38 offen
    buffer_load_dwordx4 v[100:103], v13, s[28:31], s38 offen
    s_barrier
    ds_read_b64_tr_b16 a[32:33], v16 offset:0
    ds_read_b64_tr_b16 a[34:35], v16 offset:2624
    ds_read_b64_tr_b16 a[112:113], v16 offset:8
    ds_read_b64_tr_b16 a[114:115], v16 offset:2632
    ds_read_b64_tr_b16 a[192:193], v16 offset:256
    ds_read_b64_tr_b16 a[194:195], v16 offset:2880
    ds_read_b64_tr_b16 v[208:209], v16 offset:264
    ds_read_b64_tr_b16 v[210:211], v16 offset:2888
    ds_read_b64_tr_b16 v[40:41], v17 offset:0
    ds_read_b64_tr_b16 v[42:43], v17 offset:2624
    s_waitcnt lgkmcnt(0)
    ds_write_b128 v18, v[40:43] offset:8192
    s_waitcnt vmcnt(10)
    ds_write_b128 v12, v[44:47] offset:20992
    ds_write_b128 v12, v[48:51] offset:31488
    ds_write_b128 v12, v[52:55] offset:21248
    ds_write_b128 v12, v[56:59] offset:31744
    ds_write_b128 v14, v[60:63] offset:20992
    s_waitcnt lgkmcnt(0)
    s_mov_b32 s38, 3145728
    buffer_load_dwordx4 v[44:47], v10, s[12:15], s38 offen
    buffer_load_dwordx4 v[48:51], v11, s[12:15], s38 offen
    buffer_load_dwordx4 v[52:55], v10, s[24:27], s38 offen
    buffer_load_dwordx4 v[56:59], v11, s[24:27], s38 offen
    buffer_load_dwordx4 v[60:63], v13, s[28:31], s38 offen
    s_barrier
    ds_read_b64_tr_b16 a[36:37], v16 offset:20992
    ds_read_b64_tr_b16 a[38:39], v16 offset:23616
    ds_read_b64_tr_b16 a[116:117], v16 offset:21000
    ds_read_b64_tr_b16 a[118:119], v16 offset:23624
    ds_read_b64_tr_b16 a[196:197], v16 offset:21248
    ds_read_b64_tr_b16 a[198:199], v16 offset:23872
    ds_read_b64_tr_b16 v[212:213], v16 offset:21256
    ds_read_b64_tr_b16 v[214:215], v16 offset:23880
    ds_read_b64_tr_b16 v[40:41], v17 offset:20992
    ds_read_b64_tr_b16 v[42:43], v17 offset:23616
    s_waitcnt lgkmcnt(0)
    ds_write_b128 v18, v[40:43] offset:9216
    s_waitcnt vmcnt(10)
    ds_write_b128 v12, v[64:67] offset:0
    ds_write_b128 v12, v[68:71] offset:10496
    ds_write_b128 v12, v[72:75] offset:256
    ds_write_b128 v12, v[76:79] offset:10752
    ds_write_b128 v14, v[80:83] offset:0
    s_waitcnt lgkmcnt(0)
    s_mov_b32 s38, 3407872
    buffer_load_dwordx4 v[64:67], v10, s[12:15], s38 offen
    buffer_load_dwordx4 v[68:71], v11, s[12:15], s38 offen
    buffer_load_dwordx4 v[72:75], v10, s[24:27], s38 offen
    buffer_load_dwordx4 v[76:79], v11, s[24:27], s38 offen
    buffer_load_dwordx4 v[80:83], v13, s[28:31], s38 offen
    s_barrier
    ds_read_b64_tr_b16 a[40:41], v16 offset:0
    ds_read_b64_tr_b16 a[42:43], v16 offset:2624
    ds_read_b64_tr_b16 a[120:121], v16 offset:8
    ds_read_b64_tr_b16 a[122:123], v16 offset:2632
    ds_read_b64_tr_b16 a[200:201], v16 offset:256
    ds_read_b64_tr_b16 a[202:203], v16 offset:2880
    ds_read_b64_tr_b16 v[216:217], v16 offset:264
    ds_read_b64_tr_b16 v[218:219], v16 offset:2888
    ds_read_b64_tr_b16 v[40:41], v17 offset:0
    ds_read_b64_tr_b16 v[42:43], v17 offset:2624
    s_waitcnt lgkmcnt(0)
    ds_write_b128 v18, v[40:43] offset:10240
    s_waitcnt vmcnt(10)
    ds_write_b128 v12, v[84:87] offset:20992
    ds_write_b128 v12, v[88:91] offset:31488
    ds_write_b128 v12, v[92:95] offset:21248
    ds_write_b128 v12, v[96:99] offset:31744
    ds_write_b128 v14, v[100:103] offset:20992
    s_waitcnt lgkmcnt(0)
    s_mov_b32 s38, 3670016
    buffer_load_dwordx4 v[84:87], v10, s[12:15], s38 offen
    buffer_load_dwordx4 v[88:91], v11, s[12:15], s38 offen
    buffer_load_dwordx4 v[92:95], v10, s[24:27], s38 offen
    buffer_load_dwordx4 v[96:99], v11, s[24:27], s38 offen
    buffer_load_dwordx4 v[100:103], v13, s[28:31], s38 offen
    s_barrier
    ds_read_b64_tr_b16 a[44:45], v16 offset:20992
    ds_read_b64_tr_b16 a[46:47], v16 offset:23616
    ds_read_b64_tr_b16 a[124:125], v16 offset:21000
    ds_read_b64_tr_b16 a[126:127], v16 offset:23624
    ds_read_b64_tr_b16 a[204:205], v16 offset:21248
    ds_read_b64_tr_b16 a[206:207], v16 offset:23872
    ds_read_b64_tr_b16 v[220:221], v16 offset:21256
    ds_read_b64_tr_b16 v[222:223], v16 offset:23880
    ds_read_b64_tr_b16 v[40:41], v17 offset:20992
    ds_read_b64_tr_b16 v[42:43], v17 offset:23616
    s_waitcnt lgkmcnt(0)
    ds_write_b128 v18, v[40:43] offset:11264
    s_waitcnt vmcnt(10)
    ds_write_b128 v12, v[44:47] offset:0
    ds_write_b128 v12, v[48:51] offset:10496
    ds_write_b128 v12, v[52:55] offset:256
    ds_write_b128 v12, v[56:59] offset:10752
    ds_write_b128 v14, v[60:63] offset:0
    s_waitcnt lgkmcnt(0)
    s_mov_b32 s38, 3932160
    buffer_load_dwordx4 v[44:47], v10, s[12:15], s38 offen
    buffer_load_dwordx4 v[48:51], v11, s[12:15], s38 offen
    buffer_load_dwordx4 v[52:55], v10, s[24:27], s38 offen
    buffer_load_dwordx4 v[56:59], v11, s[24:27], s38 offen
    buffer_load_dwordx4 v[60:63], v13, s[28:31], s38 offen
    s_barrier
    ds_read_b64_tr_b16 a[48:49], v16 offset:0
    ds_read_b64_tr_b16 a[50:51], v16 offset:2624
    ds_read_b64_tr_b16 a[128:129], v16 offset:8
    ds_read_b64_tr_b16 a[130:131], v16 offset:2632
    ds_read_b64_tr_b16 a[208:209], v16 offset:256
    ds_read_b64_tr_b16 a[210:211], v16 offset:2880
    ds_read_b64_tr_b16 v[224:225], v16 offset:264
    ds_read_b64_tr_b16 v[226:227], v16 offset:2888
    ds_read_b64_tr_b16 v[40:41], v17 offset:0
    ds_read_b64_tr_b16 v[42:43], v17 offset:2624
    s_waitcnt lgkmcnt(0)
    ds_write_b128 v18, v[40:43] offset:12288
    s_waitcnt vmcnt(10)
    ds_write_b128 v12, v[64:67] offset:20992
    ds_write_b128 v12, v[68:71] offset:31488
    ds_write_b128 v12, v[72:75] offset:21248
    ds_write_b128 v12, v[76:79] offset:31744
    ds_write_b128 v14, v[80:83] offset:20992
    s_waitcnt lgkmcnt(0)
    s_mov_b32 s38, 4194304
    buffer_load_dwordx4 v[64:67], v10, s[12:15], s38 offen
    buffer_load_dwordx4 v[68:71], v11, s[12:15], s38 offen
    buffer_load_dwordx4 v[72:75], v10, s[24:27], s38 offen
    buffer_load_dwordx4 v[76:79], v11, s[24:27], s38 offen
    buffer_load_dwordx4 v[80:83], v13, s[28:31], s38 offen
    s_barrier
    ds_read_b64_tr_b16 a[52:53], v16 offset:20992
    ds_read_b64_tr_b16 a[54:55], v16 offset:23616
    ds_read_b64_tr_b16 a[132:133], v16 offset:21000
    ds_read_b64_tr_b16 a[134:135], v16 offset:23624
    ds_read_b64_tr_b16 a[212:213], v16 offset:21248
    ds_read_b64_tr_b16 a[214:215], v16 offset:23872
    ds_read_b64_tr_b16 v[228:229], v16 offset:21256
    ds_read_b64_tr_b16 v[230:231], v16 offset:23880
    ds_read_b64_tr_b16 v[40:41], v17 offset:20992
    ds_read_b64_tr_b16 v[42:43], v17 offset:23616
    s_waitcnt lgkmcnt(0)
    ds_write_b128 v18, v[40:43] offset:13312
    s_waitcnt vmcnt(10)
    ds_write_b128 v12, v[84:87] offset:0
    ds_write_b128 v12, v[88:91] offset:10496
    ds_write_b128 v12, v[92:95] offset:256
    ds_write_b128 v12, v[96:99] offset:10752
    ds_write_b128 v14, v[100:103] offset:0
    s_waitcnt lgkmcnt(0)
    s_mov_b32 s38, 4456448
    buffer_load_dwordx4 v[84:87], v10, s[12:15], s38 offen
    buffer_load_dwordx4 v[88:91], v11, s[12:15], s38 offen
    buffer_load_dwordx4 v[92:95], v10, s[24:27], s38 offen
    buffer_load_dwordx4 v[96:99], v11, s[24:27], s38 offen
    buffer_load_dwordx4 v[100:103], v13, s[28:31], s38 offen
    s_barrier
    ds_read_b64_tr_b16 a[56:57], v16 offset:0
    ds_read_b64_tr_b16 a[58:59], v16 offset:2624
    ds_read_b64_tr_b16 a[136:137], v16 offset:8
    ds_read_b64_tr_b16 a[138:139], v16 offset:2632
    ds_read_b64_tr_b16 a[216:217], v16 offset:256
    ds_read_b64_tr_b16 a[218:219], v16 offset:2880
    ds_read_b64_tr_b16 v[232:233], v16 offset:264
    ds_read_b64_tr_b16 v[234:235], v16 offset:2888
    ds_read_b64_tr_b16 v[40:41], v17 offset:0
    ds_read_b64_tr_b16 v[42:43], v17 offset:2624
    s_waitcnt lgkmcnt(0)
    ds_write_b128 v18, v[40:43] offset:14336
    s_waitcnt vmcnt(10)
    ds_write_b128 v12, v[44:47] offset:20992
    ds_write_b128 v12, v[48:51] offset:31488
    ds_write_b128 v12, v[52:55] offset:21248
    ds_write_b128 v12, v[56:59] offset:31744
    ds_write_b128 v14, v[60:63] offset:20992
    s_waitcnt lgkmcnt(0)
    s_mov_b32 s38, 4718592
    buffer_load_dwordx4 v[44:47], v10, s[12:15], s38 offen
    buffer_load_dwordx4 v[48:51], v11, s[12:15], s38 offen
    buffer_load_dwordx4 v[52:55], v10, s[24:27], s38 offen
    buffer_load_dwordx4 v[56:59], v11, s[24:27], s38 offen
    buffer_load_dwordx4 v[60:63], v13, s[28:31], s38 offen
    s_barrier
    ds_read_b64_tr_b16 a[60:61], v16 offset:20992
    ds_read_b64_tr_b16 a[62:63], v16 offset:23616
    ds_read_b64_tr_b16 a[140:141], v16 offset:21000
    ds_read_b64_tr_b16 a[142:143], v16 offset:23624
    ds_read_b64_tr_b16 a[220:221], v16 offset:21248
    ds_read_b64_tr_b16 a[222:223], v16 offset:23872
    ds_read_b64_tr_b16 v[236:237], v16 offset:21256
    ds_read_b64_tr_b16 v[238:239], v16 offset:23880
    ds_read_b64_tr_b16 v[40:41], v17 offset:20992
    ds_read_b64_tr_b16 v[42:43], v17 offset:23616
    s_waitcnt lgkmcnt(0)
    ds_write_b128 v18, v[40:43] offset:15360
    s_waitcnt vmcnt(10)
    ds_write_b128 v12, v[64:67] offset:0
    ds_write_b128 v12, v[68:71] offset:10496
    ds_write_b128 v12, v[72:75] offset:256
    ds_write_b128 v12, v[76:79] offset:10752
    ds_write_b128 v14, v[80:83] offset:0
    s_waitcnt lgkmcnt(0)
    s_mov_b32 s38, 4980736
    buffer_load_dwordx4 v[64:67], v10, s[12:15], s38 offen
    buffer_load_dwordx4 v[68:71], v11, s[12:15], s38 offen
    buffer_load_dwordx4 v[72:75], v10, s[24:27], s38 offen
    buffer_load_dwordx4 v[76:79], v11, s[24:27], s38 offen
    buffer_load_dwordx4 v[80:83], v13, s[28:31], s38 offen
    s_barrier
    ds_read_b64_tr_b16 a[64:65], v16 offset:0
    ds_read_b64_tr_b16 a[66:67], v16 offset:2624
    ds_read_b64_tr_b16 a[144:145], v16 offset:8
    ds_read_b64_tr_b16 a[146:147], v16 offset:2632
    ds_read_b64_tr_b16 a[224:225], v16 offset:256
    ds_read_b64_tr_b16 a[226:227], v16 offset:2880
    ds_read_b64_tr_b16 v[240:241], v16 offset:264
    ds_read_b64_tr_b16 v[242:243], v16 offset:2888
    ds_read_b64_tr_b16 v[40:41], v17 offset:0
    ds_read_b64_tr_b16 v[42:43], v17 offset:2624
    s_waitcnt lgkmcnt(0)
    ds_write_b128 v18, v[40:43] offset:16384
    s_waitcnt vmcnt(10)
    ds_write_b128 v12, v[84:87] offset:20992
    ds_write_b128 v12, v[88:91] offset:31488
    ds_write_b128 v12, v[92:95] offset:21248
    ds_write_b128 v12, v[96:99] offset:31744
    ds_write_b128 v14, v[100:103] offset:20992
    s_waitcnt lgkmcnt(0)
    s_barrier
    ds_read_b64_tr_b16 a[68:69], v16 offset:20992
    ds_read_b64_tr_b16 a[70:71], v16 offset:23616
    ds_read_b64_tr_b16 a[148:149], v16 offset:21000
    ds_read_b64_tr_b16 a[150:151], v16 offset:23624
    ds_read_b64_tr_b16 a[228:229], v16 offset:21248
    ds_read_b64_tr_b16 a[230:231], v16 offset:23872
    ds_read_b64_tr_b16 v[244:245], v16 offset:21256
    ds_read_b64_tr_b16 v[246:247], v16 offset:23880
    ds_read_b64_tr_b16 v[40:41], v17 offset:20992
    ds_read_b64_tr_b16 v[42:43], v17 offset:23616
    s_waitcnt lgkmcnt(0)
    ds_write_b128 v18, v[40:43] offset:17408
    s_waitcnt vmcnt(5)
    ds_write_b128 v12, v[44:47] offset:0
    ds_write_b128 v12, v[48:51] offset:10496
    ds_write_b128 v12, v[52:55] offset:256
    ds_write_b128 v12, v[56:59] offset:10752
    ds_write_b128 v14, v[60:63] offset:0
    s_waitcnt lgkmcnt(0)
    s_barrier
    ds_read_b64_tr_b16 a[72:73], v16 offset:0
    ds_read_b64_tr_b16 a[74:75], v16 offset:2624
    ds_read_b64_tr_b16 a[152:153], v16 offset:8
    ds_read_b64_tr_b16 a[154:155], v16 offset:2632
    ds_read_b64_tr_b16 a[232:233], v16 offset:256
    ds_read_b64_tr_b16 a[234:235], v16 offset:2880
    ds_read_b64_tr_b16 v[248:249], v16 offset:264
    ds_read_b64_tr_b16 v[250:251], v16 offset:2888
    ds_read_b64_tr_b16 v[40:41], v17 offset:0
    ds_read_b64_tr_b16 v[42:43], v17 offset:2624
    s_waitcnt lgkmcnt(0)
    ds_write_b128 v18, v[40:43] offset:18432
    s_waitcnt vmcnt(0)
    ds_write_b128 v12, v[64:67] offset:20992
    ds_write_b128 v12, v[68:71] offset:31488
    ds_write_b128 v12, v[72:75] offset:21248
    ds_write_b128 v12, v[76:79] offset:31744
    ds_write_b128 v14, v[80:83] offset:20992
    s_waitcnt lgkmcnt(0)
    s_barrier
    ds_read_b64_tr_b16 a[76:77], v16 offset:20992
    ds_read_b64_tr_b16 a[78:79], v16 offset:23616
    ds_read_b64_tr_b16 a[156:157], v16 offset:21000
    ds_read_b64_tr_b16 a[158:159], v16 offset:23624
    ds_read_b64_tr_b16 a[236:237], v16 offset:21248
    ds_read_b64_tr_b16 a[238:239], v16 offset:23872
    ds_read_b64_tr_b16 v[252:253], v16 offset:21256
    ds_read_b64_tr_b16 v[254:255], v16 offset:23880
    ds_read_b64_tr_b16 v[40:41], v17 offset:20992
    ds_read_b64_tr_b16 v[42:43], v17 offset:23616
    s_waitcnt lgkmcnt(0)
    ds_write_b128 v18, v[40:43] offset:19456
    s_waitcnt lgkmcnt(0)
    s_barrier
    s_lshl_b32 s7, s4, 7
    s_lshl_b32 s37, s5, 6
    s_add_u32 s7, s7, s37
    s_lshl_b32 s37, s6, 3
    s_add_u32 s7, s7, s37
    s_mul_i32 s7, s7, 1280
    v_lshlrev_b32 v10, 4, v1
    v_add_u32 v10, s7, v10
    v_lshlrev_b32 v11, 2, v1
    v_add_u32 v11, s7, v11
    v_add_u32 v11, 1024, v11
    s_mul_i32 s7, s37, 1296
    s_add_u32 s7, s7, 110464
    v_lshlrev_b32 v12, 4, v1
    v_add_u32 v12, s7, v12
    v_lshlrev_b32 v13, 2, v1
    v_add_u32 v13, s7, v13
    v_add_u32 v13, 1024, v13
    v_lshl_add_u32 v8, v4, 3, v5
    v_mul_u32_u24 v15, 1296, v8
    v_lshl_add_u32 v15, v6, 3, v15
    s_mul_i32 s7, s6, 320
    s_add_u32 s7, s7, 110464
    v_add_u32 v15, s7, v15
    s_mul_i32 s7, s6, 20480
    s_add_u32 s7, s7, 28544
    v_lshlrev_b32 v16, 4, v1
    v_add_u32 v16, s7, v16
    s_mov_b32 s38, 0
    buffer_load_dwordx4 v[20:23], v10, s[68:71], s38 offen
    buffer_load_dword v52, v11, s[68:71], s38 offen
    s_mov_b32 s38, 1280
    buffer_load_dwordx4 v[24:27], v10, s[68:71], s38 offen
    buffer_load_dword v53, v11, s[68:71], s38 offen
    s_mov_b32 s38, 2560
    buffer_load_dwordx4 v[28:31], v10, s[68:71], s38 offen
    buffer_load_dword v54, v11, s[68:71], s38 offen
    s_mov_b32 s38, 3840
    buffer_load_dwordx4 v[32:35], v10, s[68:71], s38 offen
    buffer_load_dword v55, v11, s[68:71], s38 offen
    s_mov_b32 s38, 5120
    buffer_load_dwordx4 v[36:39], v10, s[68:71], s38 offen
    buffer_load_dword v56, v11, s[68:71], s38 offen
    s_mov_b32 s38, 6400
    buffer_load_dwordx4 v[40:43], v10, s[68:71], s38 offen
    buffer_load_dword v57, v11, s[68:71], s38 offen
    s_mov_b32 s38, 7680
    buffer_load_dwordx4 v[44:47], v10, s[68:71], s38 offen
    buffer_load_dword v58, v11, s[68:71], s38 offen
    s_mov_b32 s38, 8960
    buffer_load_dwordx4 v[48:51], v10, s[68:71], s38 offen
    buffer_load_dword v59, v11, s[68:71], s38 offen
    s_mov_b32 s38, 40960
    buffer_load_dwordx4 v[60:63], v10, s[68:71], s38 offen
    buffer_load_dword v92, v11, s[68:71], s38 offen
    s_mov_b32 s38, 42240
    buffer_load_dwordx4 v[64:67], v10, s[68:71], s38 offen
    buffer_load_dword v93, v11, s[68:71], s38 offen
    s_mov_b32 s38, 43520
    buffer_load_dwordx4 v[68:71], v10, s[68:71], s38 offen
    buffer_load_dword v94, v11, s[68:71], s38 offen
    s_mov_b32 s38, 44800
    buffer_load_dwordx4 v[72:75], v10, s[68:71], s38 offen
    buffer_load_dword v95, v11, s[68:71], s38 offen
    s_mov_b32 s38, 46080
    buffer_load_dwordx4 v[76:79], v10, s[68:71], s38 offen
    buffer_load_dword v96, v11, s[68:71], s38 offen
    s_mov_b32 s38, 47360
    buffer_load_dwordx4 v[80:83], v10, s[68:71], s38 offen
    buffer_load_dword v97, v11, s[68:71], s38 offen
    s_mov_b32 s38, 48640
    buffer_load_dwordx4 v[84:87], v10, s[68:71], s38 offen
    buffer_load_dword v98, v11, s[68:71], s38 offen
    s_mov_b32 s38, 49920
    buffer_load_dwordx4 v[88:91], v10, s[68:71], s38 offen
    buffer_load_dword v99, v11, s[68:71], s38 offen
    s_waitcnt vmcnt(16)
    ds_write_b128 v12, v[20:23] offset:0
    ds_write_b32 v13, v52 offset:0
    ds_write_b128 v12, v[24:27] offset:1296
    ds_write_b32 v13, v53 offset:1296
    ds_write_b128 v12, v[28:31] offset:2592
    ds_write_b32 v13, v54 offset:2592
    ds_write_b128 v12, v[32:35] offset:3888
    ds_write_b32 v13, v55 offset:3888
    ds_write_b128 v12, v[36:39] offset:5184
    ds_write_b32 v13, v56 offset:5184
    ds_write_b128 v12, v[40:43] offset:6480
    ds_write_b32 v13, v57 offset:6480
    ds_write_b128 v12, v[44:47] offset:7776
    ds_write_b32 v13, v58 offset:7776
    ds_write_b128 v12, v[48:51] offset:9072
    ds_write_b32 v13, v59 offset:9072
    s_waitcnt lgkmcnt(0)
    s_barrier
    ds_read_b64_tr_b16 v[112:113], v15 offset:0
    ds_read_b64_tr_b16 v[114:115], v15 offset:5184
    ds_read_b64_tr_b16 v[120:121], v15 offset:32
    ds_read_b64_tr_b16 v[122:123], v15 offset:5216
    ds_read_b64_tr_b16 v[128:129], v15 offset:64
    ds_read_b64_tr_b16 v[130:131], v15 offset:5248
    ds_read_b64_tr_b16 v[136:137], v15 offset:96
    ds_read_b64_tr_b16 v[138:139], v15 offset:5280
    ds_read_b64_tr_b16 v[144:145], v15 offset:128
    ds_read_b64_tr_b16 v[146:147], v15 offset:5312
    ds_read_b64_tr_b16 v[152:153], v15 offset:160
    ds_read_b64_tr_b16 v[154:155], v15 offset:5344
    ds_read_b64_tr_b16 v[160:161], v15 offset:192
    ds_read_b64_tr_b16 v[162:163], v15 offset:5376
    ds_read_b64_tr_b16 v[168:169], v15 offset:224
    ds_read_b64_tr_b16 v[170:171], v15 offset:5408
    ds_read_b64_tr_b16 v[176:177], v15 offset:256
    ds_read_b64_tr_b16 v[178:179], v15 offset:5440
    ds_read_b64_tr_b16 v[184:185], v15 offset:288
    ds_read_b64_tr_b16 v[186:187], v15 offset:5472
    s_waitcnt lgkmcnt(0)
    s_barrier
    s_waitcnt vmcnt(0)
    ds_write_b128 v12, v[60:63] offset:0
    ds_write_b32 v13, v92 offset:0
    ds_write_b128 v12, v[64:67] offset:1296
    ds_write_b32 v13, v93 offset:1296
    ds_write_b128 v12, v[68:71] offset:2592
    ds_write_b32 v13, v94 offset:2592
    ds_write_b128 v12, v[72:75] offset:3888
    ds_write_b32 v13, v95 offset:3888
    ds_write_b128 v12, v[76:79] offset:5184
    ds_write_b32 v13, v96 offset:5184
    ds_write_b128 v12, v[80:83] offset:6480
    ds_write_b32 v13, v97 offset:6480
    ds_write_b128 v12, v[84:87] offset:7776
    ds_write_b32 v13, v98 offset:7776
    ds_write_b128 v12, v[88:91] offset:9072
    ds_write_b32 v13, v99 offset:9072
    s_waitcnt lgkmcnt(0)
    s_barrier
    ds_read_b64_tr_b16 v[116:117], v15 offset:0
    ds_read_b64_tr_b16 v[118:119], v15 offset:5184
    ds_read_b64_tr_b16 v[124:125], v15 offset:32
    ds_read_b64_tr_b16 v[126:127], v15 offset:5216
    ds_read_b64_tr_b16 v[132:133], v15 offset:64
    ds_read_b64_tr_b16 v[134:135], v15 offset:5248
    ds_read_b64_tr_b16 v[140:141], v15 offset:96
    ds_read_b64_tr_b16 v[142:143], v15 offset:5280
    ds_read_b64_tr_b16 v[148:149], v15 offset:128
    ds_read_b64_tr_b16 v[150:151], v15 offset:5312
    ds_read_b64_tr_b16 v[156:157], v15 offset:160
    ds_read_b64_tr_b16 v[158:159], v15 offset:5344
    ds_read_b64_tr_b16 v[164:165], v15 offset:192
    ds_read_b64_tr_b16 v[166:167], v15 offset:5376
    ds_read_b64_tr_b16 v[172:173], v15 offset:224
    ds_read_b64_tr_b16 v[174:175], v15 offset:5408
    ds_read_b64_tr_b16 v[180:181], v15 offset:256
    ds_read_b64_tr_b16 v[182:183], v15 offset:5440
    ds_read_b64_tr_b16 v[188:189], v15 offset:288
    ds_read_b64_tr_b16 v[190:191], v15 offset:5472
    s_waitcnt lgkmcnt(0)
    s_barrier
    v_mov_b32 v2, v16
    v_min_u32 v7, 8, v3
    v_mul_u32_u24 v7, 1344, v7
    v_lshl_add_u32 v7, v4, 4, v7
    v_add_u32 v7, 0, v7
    v_lshl_add_u32 v8, v5, 3, v6
    v_lshlrev_b32 v8, 13, v8
    v_lshl_add_u32 v8, v4, 4, v8
    s_lshl_b32 s7, s4, 8
    s_lshl_b32 s37, s6, 6
    s_add_u32 s7, s7, s37
    s_add_u32 s7, s7, 16777216
    v_add_u32 v8, s7, v8
    v_lshl_add_u32 v9, v5, 3, v6
    v_lshlrev_b32 v9, 6, v9
    v_lshl_add_u32 v9, v4, 4, v9
    s_lshl_b32 s7, s4, 13
    s_lshl_b32 s37, s5, 12
    s_add_u32 s7, s7, s37
    s_add_u32 s7, s7, 33554432
    v_add_u32 v9, s7, v9
    v_and_b32 v20, 7, v3
    v_lshl_add_u32 v10, v4, 3, v20
    v_lshlrev_b32 v10, 4, v10
    v_lshrrev_b32 v20, 3, v3
    v_lshl_add_u32 v10, v20, 9, v10
    s_mul_i32 s7, s3, 20480
    s_mul_i32 s37, s6, 5120
    s_add_u32 s7, s7, s37
    s_add_u32 s7, s7, 104857600
    v_add_u32 v10, s7, v10
    v_lshrrev_b32 v11, 3, v1
    v_mul_u32_u24 v11, 20480, v11
    v_and_b32 v20, 7, v1
    v_lshl_add_u32 v11, v20, 4, v11
    s_lshl_b32 s7, s6, 7
    s_lshl_b32 s37, s3, 9
    s_add_u32 s7, s7, s37
    s_add_u32 s7, s7, 104857600
    v_add_u32 v11, s7, v11
    v_lshlrev_b32 v12, 3, v1
    s_lshl_b32 s7, s3, 9
    s_lshl_b32 s37, s6, 7
    s_add_u32 s7, s7, s37
    s_add_u32 s7, s7, 106954752
    v_add_u32 v12, s7, v12
    v_cmp_lt_u32 vcc, 7, v1
    v_mov_b32 v20, 0x7ff00000
    s_nop 1
    v_cndmask_b32 v12, v12, v20, vcc
    v_lshrrev_b32 v13, 3, v0
    v_lshlrev_b32 v13, 7, v13
    v_and_b32 v20, 7, v0
    v_lshl_add_u32 v13, v20, 3, v13
    v_add_u32 v13, 106954752, v13
    v_add_u32 v20, 0, v0
    v_mul_u32_u24 v21, 52429, v20
    v_lshrrev_b32 v21, 23, v21
    v_mul_u32_u24 v22, 160, v21
    v_sub_u32 v22, v20, v22
    v_mul_u32_u24 v21, 1344, v21
    v_lshl_add_u32 v21, v22, 3, v21
    v_add_u32 v96, 0, v21
    v_and_b32 v21, 7, v20
    v_lshrrev_b32 v22, 3, v20
    v_mul_u32_u24 v21, 1344, v21
    v_lshl_add_u32 v21, v22, 3, v21
    v_add_u32 v104, 0, v21
    v_add_u32 v20, 256, v0
    v_mul_u32_u24 v21, 52429, v20
    v_lshrrev_b32 v21, 23, v21
    v_mul_u32_u24 v22, 160, v21
    v_sub_u32 v22, v20, v22
    v_mul_u32_u24 v21, 1344, v21
    v_lshl_add_u32 v21, v22, 3, v21
    v_add_u32 v97, 0, v21
    v_and_b32 v21, 7, v20
    v_lshrrev_b32 v22, 3, v20
    v_mul_u32_u24 v21, 1344, v21
    v_lshl_add_u32 v21, v22, 3, v21
    v_add_u32 v105, 0, v21
    v_add_u32 v20, 512, v0
    v_mul_u32_u24 v21, 52429, v20
    v_lshrrev_b32 v21, 23, v21
    v_mul_u32_u24 v22, 160, v21
    v_sub_u32 v22, v20, v22
    v_mul_u32_u24 v21, 1344, v21
    v_lshl_add_u32 v21, v22, 3, v21
    v_add_u32 v98, 0, v21
    v_and_b32 v21, 7, v20
    v_lshrrev_b32 v22, 3, v20
    v_mul_u32_u24 v21, 1344, v21
    v_lshl_add_u32 v21, v22, 3, v21
    v_add_u32 v106, 0, v21
    v_add_u32 v20, 768, v0
    v_mul_u32_u24 v21, 52429, v20
    v_lshrrev_b32 v21, 23, v21
    v_mul_u32_u24 v22, 160, v21
    v_sub_u32 v22, v20, v22
    v_mul_u32_u24 v21, 1344, v21
    v_lshl_add_u32 v21, v22, 3, v21
    v_add_u32 v99, 0, v21
    v_and_b32 v21, 7, v20
    v_lshrrev_b32 v22, 3, v20
    v_mul_u32_u24 v21, 1344, v21
    v_lshl_add_u32 v21, v22, 3, v21
    v_add_u32 v107, 0, v21
    v_add_u32 v20, 1024, v0
    v_mul_u32_u24 v21, 52429, v20
    v_lshrrev_b32 v21, 23, v21
    v_mul_u32_u24 v22, 160, v21
    v_sub_u32 v22, v20, v22
    v_mul_u32_u24 v21, 1344, v21
    v_lshl_add_u32 v21, v22, 3, v21
    v_add_u32 v100, 0, v21
    v_and_b32 v21, 7, v20
    v_lshrrev_b32 v22, 3, v20
    v_mul_u32_u24 v21, 1344, v21
    v_lshl_add_u32 v21, v22, 3, v21
    v_add_u32 v108, 0, v21
    v_lshlrev_b32 v14, 8, v3
    v_lshl_add_u32 v14, v4, 4, v14
    s_lshl_b32 s7, s4, 11
    s_lshl_b32 s37, s6, 6
    s_add_u32 s7, s7, s37
    s_add_u32 s7, s7, 67108864
    s_cmp_eq_u32 s5, 0
    s_cselect_b32 s7, s7, 0x7ff00000
    v_add_u32 v14, s7, v14
    v_cmp_lt_u32 vcc, 7, v3
    v_mov_b32 v20, 0x7ff00000
    s_nop 1
    v_cndmask_b32 v14, v14, v20, vcc
    v_lshl_add_u32 v15, v5, 3, v6
    v_lshlrev_b32 v15, 4, v15
    v_lshl_add_u32 v15, v4, 3, v15
    s_lshl_b32 s7, s4, 11
    s_lshl_b32 s37, s5, 10
    s_add_u32 s7, s7, s37
    s_lshr_b32 s37, s6, 1
    s_lshl_b32 s37, s37, 9
    s_add_u32 s7, s7, s37
    s_and_b32 s37, s6, 1
    s_lshl_b32 s37, s37, 6
    s_add_u32 s7, s7, s37
    s_add_u32 s7, s7, 71303168
    v_add_u32 v15, s7, v15
    v_cmp_lt_u32 vcc, 1, v4
    v_mov_b32 v20, 0x7ff00000
    s_nop 1
    v_cndmask_b32 v15, v15, v20, vcc
    v_lshlrev_b32 v110, 4, v1
    s_mul_i32 s7, s6, 3072
    s_add_u32 s7, s7, 12160
    v_add_u32 v109, s7, v110
    v_mov_b32 v111, 1
    s_mov_b32 s76, 0
    s_mov_b32 s77, 0x00ff00ff
    s_mov_b32 s94, 0xff00ff00
    s_mov_b32 s95, 0xff00ff00
    v_subrev_u32 v5, 128, v110
    v_add_u32 v5, 2048, v5
    v_mov_b32 v6, v5
    v_cmp_gt_u32 vcc, 8, v3
    v_add_u32 v20, 1024, v110
    s_nop 0
    v_cndmask_b32 v5, v5, v110, vcc
    v_cndmask_b32 v6, v6, v20, vcc
    s_mov_b32 s78, 0xfffffffe
    s_mov_b32 s79, 0
    s_mov_b32 s80, 0
    s_mov_b32 s81, 32768
    s_mov_b32 s82, 0
    s_mov_b32 s83, 0
    s_mov_b32 s87, 4096
    s_mov_b32 s88, 8192
    s_mov_b32 s86, 4096
    s_mov_b32 s89, 8192
    v_mov_b32 v20, 0
    v_mov_b32 v21, 0
    v_lshlrev_b32 v22, 3, v0
    v_add_u32 v22, 10752, v22
    v_cmp_gt_u32 vcc, 160, v0
    s_and_saveexec_b64 s[84:85], vcc
    ds_write_b64 v22, v[20:21]
    s_mov_b64 exec, s[84:85]
    v_lshlrev_b32 v22, 3, v0
    buffer_load_dwordx2 v[24:25], v22, s[72:75], 0 offen offset:0
    buffer_load_dwordx2 v[26:27], v22, s[72:75], 0 offen offset:2048
    buffer_load_dwordx2 v[28:29], v22, s[72:75], s86 offen offset:0
    buffer_load_dwordx2 v[30:31], v22, s[72:75], s86 offen offset:2048
    buffer_load_dwordx2 v[32:33], v22, s[72:75], s89 offen offset:0
    s_waitcnt vmcnt(0)
    v_mov_b32 v40, 128
    s_mov_b32 s90, 0
.cw_5:
    s_add_u32 s90, s90, 1
    s_cmp_gt_u32 s90, 400000
    s_cbranch_scc1 .cend_4
    buffer_load_dword v41, v40, s[96:99], 0 offen sc1
    s_waitcnt vmcnt(0)
    v_readfirstlane_b32 s7, v41
    s_cmp_ge_u32 s7, 64
    s_cbranch_scc0 .cw_5
    v_mov_b32 v40, 109051904
    s_mov_b32 s90, 0
.cw_6:
    s_add_u32 s90, s90, 1
    s_cmp_gt_u32 s90, 400000
    s_cbranch_scc1 .cend_4
    buffer_load_dword v41, v40, s[16:19], 0 offen sc1
    s_waitcnt vmcnt(0)
    v_readfirstlane_b32 s7, v41
    s_cmp_ge_u32 s7, 64
    s_cbranch_scc0 .cw_6
    buffer_load_dwordx4 v[56:59], v8, s[16:19], s80 offen sc1
    buffer_load_dwordx4 v[60:63], v8, s[16:19], s81 offen sc1
    buffer_load_dwordx4 v[64:67], v9, s[16:19], s80 offen offset:0 sc1
    buffer_load_dwordx4 v[68:71], v9, s[16:19], s80 offen offset:256 sc1
    buffer_load_dwordx4 v[72:75], v9, s[16:19], s80 offen offset:2048 sc1
    buffer_load_dwordx4 v[76:79], v9, s[16:19], s80 offen offset:2304 sc1
    s_waitcnt vmcnt(6)
    ds_write_b64 v96, v[24:25]
    ds_write_b64 v97, v[26:27]
    ds_write_b64 v98, v[28:29]
    ds_write_b64 v99, v[30:31]
    ds_write_b64 v100, v[32:33]
.ctop_7:
    s_waitcnt lgkmcnt(0)
    s_barrier
    ds_read_b128 v[36:39], v7 offset:0
    ds_read_b128 v[80:83], v2 offset:0
    ds_read_b128 v[40:43], v7 offset:64
    ds_read_b128 v[84:87], v2 offset:1024
    s_add_u32 s7, s79, 1
    s_lshr_b32 s7, s7, 2
    s_lshl_b32 s7, s7, 6
    s_add_u32 s91, s7, 109051904
    v_mov_b32 v52, s91
    buffer_load_dword v53, v52, s[16:19], 0 offen sc1
    s_lshl_b32 s7, s3, 4
    s_lshl_b32 s100, s6, 2
    s_add_u32 s7, s7, s100
    s_add_u32 s7, s7, 109056192
    s_add_u32 s100, s79, 0
    v_mov_b32 v54, s100
    v_mov_b32 v55, s7
    v_cmp_eq_u32 vcc, 0, v1
    s_and_saveexec_b64 s[84:85], vcc
    buffer_store_dword v54, v55, s[16:19], 0 offen sc1
    s_mov_b64 exec, s[84:85]
    s_or_b32 s7, s3, s6
    s_cmp_eq_u32 s7, 0
    s_mov_b32 s100, 0x7ff00000
    s_cselect_b32 s7, 109064704, s100
    v_mov_b32 v48, s79
    v_mov_b32 v49, s7
    buffer_store_dword v48, v49, s[16:19], 0 offen sc1
    ds_read_b128 v[44:47], v7 offset:128
    ds_read_b128 v[88:91], v2 offset:2048
    s_waitcnt lgkmcnt(4)
    v_mfma_f32_16x16x32_bf16 v[16:19], a[0:3], v[36:39], 0
    v_mfma_f32_16x16x32_bf16 v[20:23], a[80:83], v[36:39], 0
    v_mfma_f32_16x16x32_bf16 v[24:27], a[160:163], v[36:39], 0
    v_mfma_f32_16x16x32_bf16 v[28:31], a[240:243], v[36:39], 0
    v_mfma_f32_16x16x32_bf16 v[32:35], v[36:39], v[80:83], 0
    ds_read_b128 v[36:39], v7 offset:192
    ds_read_b128 v[80:83], v2 offset:3072
    s_waitcnt lgkmcnt(4)
    v_mfma_f32_16x16x32_bf16 v[16:19], a[4:7], v[40:43], v[16:19]
    v_mfma_f32_16x16x32_bf16 v[20:23], a[84:87], v[40:43], v[20:23]
    v_mfma_f32_16x16x32_bf16 v[24:27], a[164:167], v[40:43], v[24:27]
    v_mfma_f32_16x16x32_bf16 v[28:31], a[244:247], v[40:43], v[28:31]
    v_mfma_f32_16x16x32_bf16 v[32:35], v[40:43], v[84:87], v[32:35]
    ds_read_b128 v[40:43], v7 offset:256
    ds_read_b128 v[84:87], v2 offset:4096
    s_waitcnt lgkmcnt(4)
    v_mfma_f32_16x16x32_bf16 v[16:19], a[8:11], v[44:47], v[16:19]
    v_mfma_f32_16x16x32_bf16 v[20:23], a[88:91], v[44:47], v[20:23]
    v_mfma_f32_16x16x32_bf16 v[24:27], a[168:171], v[44:47], v[24:27]
    v_mfma_f32_16x16x32_bf16 v[28:31], a[248:251], v[44:47], v[28:31]
    v_mfma_f32_16x16x32_bf16 v[32:35], v[44:47], v[88:91], v[32:35]
    ds_read_b128 v[44:47], v7 offset:320
    ds_read_b128 v[88:91], v2 offset:5120
    s_waitcnt lgkmcnt(4)
    v_mfma_f32_16x16x32_bf16 v[16:19], a[12:15], v[36:39], v[16:19]
    v_mfma_f32_16x16x32_bf16 v[20:23], a[92:95], v[36:39], v[20:23]
    v_mfma_f32_16x16x32_bf16 v[24:27], a[172:175], v[36:39], v[24:27]
    v_mfma_f32_16x16x32_bf16 v[28:31], a[252:255], v[36:39], v[28:31]
    v_mfma_f32_16x16x32_bf16 v[32:35], v[36:39], v[80:83], v[32:35]
    ds_read_b128 v[36:39], v7 offset:384
    ds_read_b128 v[80:83], v2 offset:6144
    s_waitcnt lgkmcnt(4)
    v_mfma_f32_16x16x32_bf16 v[16:19], a[16:19], v[40:43], v[16:19]
    v_mfma_f32_16x16x32_bf16 v[20:23], a[96:99], v[40:43], v[20:23]
    v_mfma_f32_16x16x32_bf16 v[24:27], a[176:179], v[40:43], v[24:27]
    v_mfma_f32_16x16x32_bf16 v[28:31], v[192:195], v[40:43], v[28:31]
    v_mfma_f32_16x16x32_bf16 v[32:35], v[40:43], v[84:87], v[32:35]
    ds_read_b128 v[40:43], v7 offset:448
    ds_read_b128 v[84:87], v2 offset:7168
    s_waitcnt lgkmcnt(4)
    v_mfma_f32_16x16x32_bf16 v[16:19], a[20:23], v[44:47], v[16:19]
    v_mfma_f32_16x16x32_bf16 v[20:23], a[100:103], v[44:47], v[20:23]
    v_mfma_f32_16x16x32_bf16 v[24:27], a[180:183], v[44:47], v[24:27]
    v_mfma_f32_16x16x32_bf16 v[28:31], v[196:199], v[44:47], v[28:31]
    v_mfma_f32_16x16x32_bf16 v[32:35], v[44:47], v[88:91], v[32:35]
    ds_read_b128 v[44:47], v7 offset:512
    ds_read_b128 v[88:91], v2 offset:8192
    s_waitcnt lgkmcnt(4)
    v_mfma_f32_16x16x32_bf16 v[16:19], a[24:27], v[36:39], v[16:19]
    v_mfma_f32_16x16x32_bf16 v[20:23], a[104:107], v[36:39], v[20:23]
    v_mfma_f32_16x16x32_bf16 v[24:27], a[184:187], v[36:39], v[24:27]
    v_mfma_f32_16x16x32_bf16 v[28:31], v[200:203], v[36:39], v[28:31]
    v_mfma_f32_16x16x32_bf16 v[32:35], v[36:39], v[80:83], v[32:35]
    ds_read_b128 v[36:39], v7 offset:576
    ds_read_b128 v[80:83], v2 offset:9216
    s_waitcnt lgkmcnt(4)
    v_mfma_f32_16x16x32_bf16 v[16:19], a[28:31], v[40:43], v[16:19]
    v_mfma_f32_16x16x32_bf16 v[20:23], a[108:111], v[40:43], v[20:23]
    v_mfma_f32_16x16x32_bf16 v[24:27], a[188:191], v[40:43], v[24:27]
    v_mfma_f32_16x16x32_bf16 v[28:31], v[204:207], v[40:43], v[28:31]
    v_mfma_f32_16x16x32_bf16 v[32:35], v[40:43], v[84:87], v[32:35]
    ds_read_b128 v[40:43], v7 offset:640
    ds_read_b128 v[84:87], v2 offset:10240
    s_waitcnt lgkmcnt(4)
    v_mfma_f32_16x16x32_bf16 v[16:19], a[32:35], v[44:47], v[16:19]
    v_mfma_f32_16x16x32_bf16 v[20:23], a[112:115], v[44:47], v[20:23]
    v_mfma_f32_16x16x32_bf16 v[24:27], a[192:195], v[44:47], v[24:27]
    v_mfma_f32_16x16x32_bf16 v[28:31], v[208:211], v[44:47], v[28:31]
    v_mfma_f32_16x16x32_bf16 v[32:35], v[44:47], v[88:91], v[32:35]
    ds_read_b128 v[44:47], v7 offset:704
    ds_read_b128 v[88:91], v2 offset:11264
    s_waitcnt lgkmcnt(4)
    v_mfma_f32_16x16x32_bf16 v[16:19], a[36:39], v[36:39], v[16:19]
    v_mfma_f32_16x16x32_bf16 v[20:23], a[116:119], v[36:39], v[20:23]
    v_mfma_f32_16x16x32_bf16 v[24:27], a[196:199], v[36:39], v[24:27]
    v_mfma_f32_16x16x32_bf16 v[28:31], v[212:215], v[36:39], v[28:31]
    v_mfma_f32_16x16x32_bf16 v[32:35], v[36:39], v[80:83], v[32:35]
    ds_read_b128 v[36:39], v7 offset:768
    ds_read_b128 v[80:83], v2 offset:12288
    s_waitcnt lgkmcnt(4)
    v_mfma_f32_16x16x32_bf16 v[16:19], a[40:43], v[40:43], v[16:19]
    v_mfma_f32_16x16x32_bf16 v[20:23], a[120:123], v[40:43], v[20:23]
    v_mfma_f32_16x16x32_bf16 v[24:27], a[200:203], v[40:43], v[24:27]
    v_mfma_f32_16x16x32_bf16 v[28:31], v[216:219], v[40:43], v[28:31]
    v_mfma_f32_16x16x32_bf16 v[32:35], v[40:43], v[84:87], v[32:35]
    ds_read_b128 v[40:43], v7 offset:832
    ds_read_b128 v[84:87], v2 offset:13312
    s_waitcnt lgkmcnt(4)
    v_mfma_f32_16x16x32_bf16 v[16:19], a[44:47], v[44:47], v[16:19]
    v_mfma_f32_16x16x32_bf16 v[20:23], a[124:127], v[44:47], v[20:23]
    v_mfma_f32_16x16x32_bf16 v[24:27], a[204:207], v[44:47], v[24:27]
    v_mfma_f32_16x16x32_bf16 v[28:31], v[220:223], v[44:47], v[28:31]
    v_mfma_f32_16x16x32_bf16 v[32:35], v[44:47], v[88:91], v[32:35]
    ds_read_b128 v[44:47], v7 offset:896
    ds_read_b128 v[88:91], v2 offset:14336
    s_waitcnt lgkmcnt(4)
    v_mfma_f32_16x16x32_bf16 v[16:19], a[48:51], v[36:39], v[16:19]
    v_mfma_f32_16x16x32_bf16 v[20:23], a[128:131], v[36:39], v[20:23]
    v_mfma_f32_16x16x32_bf16 v[24:27], a[208:211], v[36:39], v[24:27]
    v_mfma_f32_16x16x32_bf16 v[28:31], v[224:227], v[36:39], v[28:31]
    v_mfma_f32_16x16x32_bf16 v[32:35], v[36:39], v[80:83], v[32:35]
    ds_read_b128 v[36:39], v7 offset:960
    ds_read_b128 v[80:83], v2 offset:15360
    s_waitcnt lgkmcnt(4)
    v_mfma_f32_16x16x32_bf16 v[16:19], a[52:55], v[40:43], v[16:19]
    v_mfma_f32_16x16x32_bf16 v[20:23], a[132:135], v[40:43], v[20:23]
    v_mfma_f32_16x16x32_bf16 v[24:27], a[212:215], v[40:43], v[24:27]
    v_mfma_f32_16x16x32_bf16 v[28:31], v[228:231], v[40:43], v[28:31]
    v_mfma_f32_16x16x32_bf16 v[32:35], v[40:43], v[84:87], v[32:35]
    ds_read_b128 v[40:43], v7 offset:1024
    ds_read_b128 v[84:87], v2 offset:16384
    s_waitcnt lgkmcnt(4)
    v_mfma_f32_16x16x32_bf16 v[16:19], a[56:59], v[44:47], v[16:19]
    v_mfma_f32_16x16x32_bf16 v[20:23], a[136:139], v[44:47], v[20:23]
    v_mfma_f32_16x16x32_bf16 v[24:27], a[216:219], v[44:47], v[24:27]
    v_mfma_f32_16x16x32_bf16 v[28:31], v[232:235], v[44:47], v[28:31]
    v_mfma_f32_16x16x32_bf16 v[32:35], v[44:47], v[88:91], v[32:35]
    ds_read_b128 v[44:47], v7 offset:1088
    ds_read_b128 v[88:91], v2 offset:17408
    s_waitcnt lgkmcnt(4)
    v_mfma_f32_16x16x32_bf16 v[16:19], a[60:63], v[36:39], v[16:19]
    v_mfma_f32_16x16x32_bf16 v[20:23], a[140:143], v[36:39], v[20:23]
    v_mfma_f32_16x16x32_bf16 v[24:27], a[220:223], v[36:39], v[24:27]
    v_mfma_f32_16x16x32_bf16 v[28:31], v[236:239], v[36:39], v[28:31]
    v_mfma_f32_16x16x32_bf16 v[32:35], v[36:39], v[80:83], v[32:35]
    ds_read_b128 v[36:39], v7 offset:1152
    ds_read_b128 v[80:83], v2 offset:18432
    s_waitcnt lgkmcnt(4)
    v_mfma_f32_16x16x32_bf16 v[16:19], a[64:67], v[40:43], v[16:19]
    v_mfma_f32_16x16x32_bf16 v[20:23], a[144:147], v[40:43], v[20:23]
    v_mfma_f32_16x16x32_bf16 v[24:27], a[224:227], v[40:43], v[24:27]
    v_mfma_f32_16x16x32_bf16 v[28:31], v[240:243], v[40:43], v[28:31]
    v_mfma_f32_16x16x32_bf16 v[32:35], v[40:43], v[84:87], v[32:35]
    ds_read_b128 v[40:43], v7 offset:1216
    ds_read_b128 v[84:87], v2 offset:19456
    s_waitcnt lgkmcnt(4)
    v_mfma_f32_16x16x32_bf16 v[16:19], a[68:71], v[44:47], v[16:19]
    v_mfma_f32_16x16x32_bf16 v[20:23], a[148:151], v[44:47], v[20:23]
    v_mfma_f32_16x16x32_bf16 v[24:27], a[228:231], v[44:47], v[24:27]
    v_mfma_f32_16x16x32_bf16 v[28:31], v[244:247], v[44:47], v[28:31]
    v_mfma_f32_16x16x32_bf16 v[32:35], v[44:47], v[88:91], v[32:35]
    s_waitcnt lgkmcnt(2)
    v_mfma_f32_16x16x32_bf16 v[16:19], a[72:75], v[36:39], v[16:19]
    v_mfma_f32_16x16x32_bf16 v[20:23], a[152:155], v[36:39], v[20:23]
    v_mfma_f32_16x16x32_bf16 v[24:27], a[232:235], v[36:39], v[24:27]
    v_mfma_f32_16x16x32_bf16 v[28:31], v[248:251], v[36:39], v[28:31]
    v_mfma_f32_16x16x32_bf16 v[32:35], v[36:39], v[80:83], v[32:35]
    s_waitcnt lgkmcnt(0)
    v_mfma_f32_16x16x32_bf16 v[16:19], a[76:79], v[40:43], v[16:19]
    v_mfma_f32_16x16x32_bf16 v[20:23], a[156:159], v[40:43], v[20:23]
    v_mfma_f32_16x16x32_bf16 v[24:27], a[236:239], v[40:43], v[24:27]
    v_mfma_f32_16x16x32_bf16 v[28:31], v[252:255], v[40:43], v[28:31]
    v_mfma_f32_16x16x32_bf16 v[32:35], v[40:43], v[84:87], v[32:35]
    s_waitcnt vmcnt(2)
    v_readfirstlane_b32 s92, v53
    s_nop 2
    v_cvt_pk_bf16_f32 v44, v16, v17
    v_cvt_pk_bf16_f32 v45, v18, v19
    v_cvt_pk_bf16_f32 v46, v20, v21
    v_cvt_pk_bf16_f32 v47, v22, v23
    v_cvt_pk_bf16_f32 v48, v24, v25
    v_cvt_pk_bf16_f32 v49, v26, v27
    v_cvt_pk_bf16_f32 v50, v28, v29
    v_cvt_pk_bf16_f32 v51, v30, v31
    v_cvt_pk_bf16_f32 v52, v32, v33
    v_cvt_pk_bf16_f32 v53, v34, v35
    s_cmp_eq_u32 s79, 63
    s_cbranch_scc1 .cfin_9
    v_mfma_f32_16x16x32_bf16 v[84:87], v[56:59], v[44:47], 0
    v_mfma_f32_16x16x32_bf16 v[88:91], v[60:63], v[44:47], 0
    v_mfma_f32_16x16x32_bf16 v[80:83], v[48:51], v[44:47], 0
    s_lshl_b32 s7, s6, 9
    v_lshlrev_b32 v54, 3, v1
    v_add_u32 v54, s7, v54
    ds_write_b64 v54, v[52:53] offset:24448
    buffer_store_dwordx4 v[48:51], v14, s[16:19], s82 offen sc1
    buffer_store_dwordx2 v[52:53], v15, s[16:19], s82 offen sc1
    ds_write_b128 v109, v[84:87] offset:1024
    ds_write_b128 v109, v[88:91] offset:2048
    s_nop 0
    ds_write_b128 v109, v[80:83]
    s_waitcnt lgkmcnt(0)
    s_barrier
    ds_read_b128 v[16:19], v5 offset:12160
    ds_read_b128 v[20:23], v6 offset:12160
    ds_read_b128 v[24:27], v5 offset:15232
    ds_read_b128 v[28:31], v6 offset:15232
    ds_read_b128 v[32:35], v5 offset:18304
    ds_read_b128 v[36:39], v6 offset:18304
    ds_read_b128 v[40:43], v5 offset:21376
    ds_read_b128 v[44:47], v6 offset:21376
    s_waitcnt lgkmcnt(4)
    v_pk_add_f32 v[80:81], v[16:17], v[24:25]
    v_pk_add_f32 v[82:83], v[18:19], v[26:27]
    v_pk_add_f32 v[84:85], v[20:21], v[28:29]
    v_pk_add_f32 v[86:87], v[22:23], v[30:31]
    s_waitcnt lgkmcnt(0)
    v_pk_add_f32 v[32:33], v[32:33], v[40:41]
    v_pk_add_f32 v[34:35], v[34:35], v[42:43]
    v_pk_add_f32 v[36:37], v[36:37], v[44:45]
    v_pk_add_f32 v[38:39], v[38:39], v[46:47]
    v_pk_add_f32 v[80:81], v[80:81], v[32:33]
    v_pk_add_f32 v[82:83], v[82:83], v[34:35]
    v_pk_add_f32 v[84:85], v[84:85], v[36:37]
    v_pk_add_f32 v[86:87], v[86:87], v[38:39]
    v_lshlrev_b32 v54, 3, v1
    ds_read_b64 v[16:17], v54 offset:24448
    ds_read_b64 v[18:19], v54 offset:24960
    ds_read_b64 v[20:21], v54 offset:25472
    ds_read_b64 v[22:23], v54 offset:25984
    v_mov_b32 v94, 0x3db504f3
    v_mov_b32 v95, 0x3db504f3
    v_cvt_pk_bf16_f32 v92, v80, v81
    v_lshlrev_b32 v80, 16, v92
    v_and_b32 v81, 0xffff0000, v92
    v_pk_mul_f32 v[80:81], v[80:81], v[94:95]
    v_cvt_pk_bf16_f32 v92, v80, v81
    v_lshlrev_b32 v80, 16, v92
    v_and_b32 v81, 0xffff0000, v92
    v_cvt_pk_bf16_f32 v92, v82, v83
    v_lshlrev_b32 v82, 16, v92
    v_and_b32 v83, 0xffff0000, v92
    v_pk_mul_f32 v[82:83], v[82:83], v[94:95]
    v_cvt_pk_bf16_f32 v92, v82, v83
    v_lshlrev_b32 v82, 16, v92
    v_and_b32 v83, 0xffff0000, v92
    v_cvt_pk_bf16_f32 v92, v84, v85
    v_lshlrev_b32 v84, 16, v92
    v_and_b32 v85, 0xffff0000, v92
    v_pk_mul_f32 v[84:85], v[84:85], v[94:95]
    v_cvt_pk_bf16_f32 v92, v84, v85
    v_lshlrev_b32 v84, 16, v92
    v_and_b32 v85, 0xffff0000, v92
    v_cvt_pk_bf16_f32 v92, v86, v87
    v_lshlrev_b32 v86, 16, v92
    v_and_b32 v87, 0xffff0000, v92
    v_pk_mul_f32 v[86:87], v[86:87], v[94:95]
    v_cvt_pk_bf16_f32 v92, v86, v87
    v_lshlrev_b32 v86, 16, v92
    v_and_b32 v87, 0xffff0000, v92
    v_mov_b32 v92, 0xff800000
    v_cndmask_b32 v80, v80, v92, s[76:77]
    v_cndmask_b32 v81, v81, v92, s[76:77]
    v_cndmask_b32 v82, v82, v92, s[76:77]
    v_cndmask_b32 v83, v83, v92, s[76:77]
    v_cndmask_b32 v84, v84, v92, s[94:95]
    v_cndmask_b32 v85, v85, v92, s[94:95]
    v_cndmask_b32 v86, v86, v92, s[94:95]
    v_cndmask_b32 v87, v87, v92, s[94:95]
    v_max3_f32 v92, v80, v81, v82
    v_max3_f32 v93, v83, v84, v85
    v_max3_f32 v92, v92, v86, v87
    v_max_f32 v92, v92, v93
    v_mov_b32 v93, v92
    s_nop 1
    v_permlane32_swap_b32 v92, v93
    v_max_f32 v92, v92, v93
    v_mov_b32 v93, v92
    s_nop 1
    v_permlane16_swap_b32 v92, v93
    v_max_f32 v92, v92, v93
    v_mov_b32 v94, 0x3fb8aa3b
    v_mov_b32 v95, 0x3fb8aa3b
    v_max_f32_dpp v92, v92, v92 row_ror:8 row_mask:0xf bank_mask:0xf
    v_mul_f32 v92, 0xbfb8aa3b, v92
    v_mov_b32 v93, v92
    v_pk_fma_f32 v[80:81], v[80:81], v[94:95], v[92:93]
    v_pk_fma_f32 v[82:83], v[82:83], v[94:95], v[92:93]
    v_pk_fma_f32 v[84:85], v[84:85], v[94:95], v[92:93]
    v_pk_fma_f32 v[86:87], v[86:87], v[94:95], v[92:93]
    v_exp_f32 v80, v80
    v_exp_f32 v81, v81
    v_exp_f32 v82, v82
    v_exp_f32 v83, v83
    v_exp_f32 v84, v84
    v_exp_f32 v85, v85
    v_exp_f32 v86, v86
    v_exp_f32 v87, v87
    s_nop 0
    v_pk_add_f32 v[92:93], v[80:81], v[82:83]
    v_pk_add_f32 v[94:95], v[84:85], v[86:87]
    v_pk_add_f32 v[92:93], v[92:93], v[94:95]
    v_add_f32 v92, v92, v93
    v_mov_b32 v93, v92
    s_nop 1
    v_permlane32_swap_b32 v92, v93
    v_add_f32 v92, v92, v93
    v_mov_b32 v93, v92
    s_nop 1
    v_permlane16_swap_b32 v92, v93
    v_add_f32 v92, v92, v93
    s_nop 1
    v_add_f32_dpp v92, v92, v92 row_ror:8 row_mask:0xf bank_mask:0xf
    v_rcp_f32 v92, v92
    s_nop 0
    v_mov_b32 v93, v92
    v_pk_mul_f32 v[80:81], v[80:81], v[92:93]
    v_pk_mul_f32 v[82:83], v[82:83], v[92:93]
    v_pk_mul_f32 v[84:85], v[84:85], v[92:93]
    v_pk_mul_f32 v[86:87], v[86:87], v[92:93]
    v_cvt_pk_bf16_f32 v48, v80, v81
    v_cvt_pk_bf16_f32 v49, v82, v83
    v_cvt_pk_bf16_f32 v44, v84, v85
    v_cvt_pk_bf16_f32 v45, v86, v87
    s_nop 0
    v_mov_b32_dpp v46, v48 row_shl:8 row_mask:0xf bank_mask:0xf
    v_mov_b32_dpp v47, v49 row_shl:8 row_mask:0xf bank_mask:0xf
    s_waitcnt lgkmcnt(0)
    s_nop 0
    v_mfma_f32_16x16x32_bf16 v[80:83], v[64:67], v[44:47], 0
    v_mfma_f32_16x16x32_bf16 v[84:87], v[68:71], v[44:47], 0
    v_mfma_f32_16x16x32_bf16 v[88:91], v[72:75], v[44:47], 0
    v_mfma_f32_16x16x32_bf16 v[92:95], v[76:79], v[44:47], 0
    v_mfma_f32_16x16x16_bf16 v[80:83], v[16:17], v[48:49], v[80:83]
    v_mfma_f32_16x16x16_bf16 v[84:87], v[18:19], v[48:49], v[84:87]
    v_mfma_f32_16x16x16_bf16 v[88:91], v[20:21], v[48:49], v[88:91]
    v_mfma_f32_16x16x16_bf16 v[92:95], v[22:23], v[48:49], v[92:95]
    s_add_u32 s80, s80, 262144
    s_add_u32 s81, s81, 262144
    s_add_u32 s82, s82, 65536
    s_nop 1
    v_cvt_pk_bf16_f32 v96, v80, v81
    v_cvt_pk_bf16_f32 v97, v82, v83
    v_cvt_pk_bf16_f32 v98, v84, v85
    v_cvt_pk_bf16_f32 v99, v86, v87
    v_cvt_pk_bf16_f32 v100, v88, v89
    v_cvt_pk_bf16_f32 v101, v90, v91
    v_cvt_pk_bf16_f32 v102, v92, v93
    v_cvt_pk_bf16_f32 v103, v94, v95
    s_nop 1
    v_mfma_f32_16x16x32_bf16 v[16:19], v[112:115], v[96:99], 0
    v_mfma_f32_16x16x32_bf16 v[20:23], v[120:123], v[96:99], 0
    v_mfma_f32_16x16x32_bf16 v[16:19], v[116:119], v[100:103], v[16:19]
    v_mfma_f32_16x16x32_bf16 v[20:23], v[124:127], v[100:103], v[20:23]
    v_mfma_f32_16x16x32_bf16 v[24:27], v[128:131], v[96:99], 0
    v_mfma_f32_16x16x32_bf16 v[28:31], v[136:139], v[96:99], 0
    v_mfma_f32_16x16x32_bf16 v[24:27], v[132:135], v[100:103], v[24:27]
    v_mfma_f32_16x16x32_bf16 v[28:31], v[140:143], v[100:103], v[28:31]
    v_mov_b32_dpp v16, v20 row_shr:8 row_mask:0xf bank_mask:0xc
    v_mov_b32_dpp v17, v21 row_shr:8 row_mask:0xf bank_mask:0xc
    v_mov_b32_dpp v18, v22 row_shr:8 row_mask:0xf bank_mask:0xc
    v_mov_b32_dpp v19, v23 row_shr:8 row_mask:0xf bank_mask:0xc
    v_and_or_b32 v16, v16, s78, v111
    v_and_or_b32 v17, v17, s78, v111
    v_and_or_b32 v18, v18, s78, v111
    v_and_or_b32 v19, v19, s78, v111
    buffer_store_dwordx4 v[16:19], v10, s[16:19], 0 offen offset:0 sc1
    v_mfma_f32_16x16x32_bf16 v[32:35], v[144:147], v[96:99], 0
    v_mfma_f32_16x16x32_bf16 v[36:39], v[152:155], v[96:99], 0
    v_mfma_f32_16x16x32_bf16 v[32:35], v[148:151], v[100:103], v[32:35]
    v_mfma_f32_16x16x32_bf16 v[36:39], v[156:159], v[100:103], v[36:39]
    v_mov_b32_dpp v24, v28 row_shr:8 row_mask:0xf bank_mask:0xc
    v_mov_b32_dpp v25, v29 row_shr:8 row_mask:0xf bank_mask:0xc
    v_mov_b32_dpp v26, v30 row_shr:8 row_mask:0xf bank_mask:0xc
    v_mov_b32_dpp v27, v31 row_shr:8 row_mask:0xf bank_mask:0xc
    v_and_or_b32 v24, v24, s78, v111
    v_and_or_b32 v25, v25, s78, v111
    v_and_or_b32 v26, v26, s78, v111
    v_and_or_b32 v27, v27, s78, v111
    buffer_store_dwordx4 v[24:27], v10, s[16:19], 0 offen offset:1024 sc1
    v_mfma_f32_16x16x32_bf16 v[40:43], v[160:163], v[96:99], 0
    v_mfma_f32_16x16x32_bf16 v[44:47], v[168:171], v[96:99], 0
    v_mfma_f32_16x16x32_bf16 v[40:43], v[164:167], v[100:103], v[40:43]
    v_mfma_f32_16x16x32_bf16 v[44:47], v[172:175], v[100:103], v[44:47]
    v_mov_b32_dpp v32, v36 row_shr:8 row_mask:0xf bank_mask:0xc
    v_mov_b32_dpp v33, v37 row_shr:8 row_mask:0xf bank_mask:0xc
    v_mov_b32_dpp v34, v38 row_shr:8 row_mask:0xf bank_mask:0xc
    v_mov_b32_dpp v35, v39 row_shr:8 row_mask:0xf bank_mask:0xc
    v_and_or_b32 v32, v32, s78, v111
    v_and_or_b32 v33, v33, s78, v111
    v_and_or_b32 v34, v34, s78, v111
    v_and_or_b32 v35, v35, s78, v111
    buffer_store_dwordx4 v[32:35], v10, s[16:19], 0 offen offset:2048 sc1
    v_mfma_f32_16x16x32_bf16 v[48:51], v[176:179], v[96:99], 0
    v_mfma_f32_16x16x32_bf16 v[52:55], v[184:187], v[96:99], 0
    v_mfma_f32_16x16x32_bf16 v[48:51], v[180:183], v[100:103], v[48:51]
    v_mfma_f32_16x16x32_bf16 v[52:55], v[188:191], v[100:103], v[52:55]
    v_mov_b32_dpp v40, v44 row_shr:8 row_mask:0xf bank_mask:0xc
    v_mov_b32_dpp v41, v45 row_shr:8 row_mask:0xf bank_mask:0xc
    v_mov_b32_dpp v42, v46 row_shr:8 row_mask:0xf bank_mask:0xc
    v_mov_b32_dpp v43, v47 row_shr:8 row_mask:0xf bank_mask:0xc
    v_and_or_b32 v40, v40, s78, v111
    v_and_or_b32 v41, v41, s78, v111
    v_and_or_b32 v42, v42, s78, v111
    v_and_or_b32 v43, v43, s78, v111
    buffer_store_dwordx4 v[40:43], v10, s[16:19], 0 offen offset:3072 sc1
    s_nop 1
    v_mov_b32_dpp v48, v52 row_shr:8 row_mask:0xf bank_mask:0xc
    v_mov_b32_dpp v49, v53 row_shr:8 row_mask:0xf bank_mask:0xc
    v_mov_b32_dpp v50, v54 row_shr:8 row_mask:0xf bank_mask:0xc
    v_mov_b32_dpp v51, v55 row_shr:8 row_mask:0xf bank_mask:0xc
    v_and_or_b32 v48, v48, s78, v111
    v_and_or_b32 v49, v49, s78, v111
    v_and_or_b32 v50, v50, s78, v111
    v_and_or_b32 v51, v51, s78, v111
    buffer_store_dwordx4 v[48:51], v10, s[16:19], s86 offen offset:0 sc1
    s_cmp_ge_u32 s92, 64
    s_cbranch_scc1 .cok_10
    v_mov_b32 v96, s91
    s_mov_b32 s90, 0
.cw_11:
    s_add_u32 s90, s90, 1
    s_cmp_gt_u32 s90, 400000
    s_cbranch_scc1 .cend_4
    buffer_load_dword v97, v96, s[16:19], 0 offen sc1
    s_waitcnt vmcnt(0)
    v_readfirstlane_b32 s7, v97
    s_cmp_ge_u32 s7, 64
    s_cbranch_scc0 .cw_11
.cok_10:
    buffer_load_dwordx4 v[56:59], v8, s[16:19], s80 offen sc1
    buffer_load_dwordx4 v[60:63], v8, s[16:19], s81 offen sc1
    buffer_load_dwordx4 v[64:67], v9, s[16:19], s80 offen offset:0 sc1
    buffer_load_dwordx4 v[68:71], v9, s[16:19], s80 offen offset:256 sc1
    buffer_load_dwordx4 v[72:75], v9, s[16:19], s80 offen offset:2048 sc1
    buffer_load_dwordx4 v[76:79], v9, s[16:19], s80 offen offset:2304 sc1
    s_cmp_ge_u32 s3, 40
    s_cbranch_scc1 .cnored_8
    s_sleep 2
    s_sleep 2
    s_sleep 2
    s_sleep 2
    s_sleep 2
    s_sleep 2
    s_sleep 2
    s_sleep 2
    s_sleep 2
    s_sleep 2
    s_mov_b32 s90, 0
.cpollB_12:
    s_add_u32 s90, s90, 1
    s_cmp_gt_u32 s90, 400000
    s_cbranch_scc1 .cend_4
    s_mov_b32 s7, 0
    buffer_load_dwordx4 v[16:19], v11, s[16:19], s7 offen sc1
    s_mov_b32 s7, 163840
    buffer_load_dwordx4 v[20:23], v11, s[16:19], s7 offen sc1
    s_mov_b32 s7, 327680
    buffer_load_dwordx4 v[24:27], v11, s[16:19], s7 offen sc1
    s_mov_b32 s7, 491520
    buffer_load_dwordx4 v[28:31], v11, s[16:19], s7 offen sc1
    s_mov_b32 s7, 655360
    buffer_load_dwordx4 v[32:35], v11, s[16:19], s7 offen sc1
    s_mov_b32 s7, 819200
    buffer_load_dwordx4 v[36:39], v11, s[16:19], s7 offen sc1
    s_mov_b32 s7, 983040
    buffer_load_dwordx4 v[40:43], v11, s[16:19], s7 offen sc1
    s_mov_b32 s7, 1146880
    buffer_load_dwordx4 v[44:47], v11, s[16:19], s7 offen sc1
    s_waitcnt vmcnt(0)
    s_bitcmp1_b32 s79, 0
    s_cbranch_scc1 .codd_13
    v_and_b32 v48, v16, v17
    v_and_b32 v96, v18, v19
    v_and_b32 v49, v20, v21
    v_and_b32 v97, v22, v23
    v_and_b32 v50, v24, v25
    v_and_b32 v98, v26, v27
    v_and_b32 v51, v28, v29
    v_and_b32 v99, v30, v31
    v_and_b32 v52, v32, v33
    v_and_b32 v100, v34, v35
    v_and_b32 v53, v36, v37
    v_and_b32 v101, v38, v39
    v_and_b32 v54, v40, v41
    v_and_b32 v102, v42, v43
    v_and_b32 v55, v44, v45
    v_and_b32 v103, v46, v47
    v_and_b32 v48, v48, v96
    v_and_b32 v49, v49, v97
    v_and_b32 v50, v50, v98
    v_and_b32 v51, v51, v99
    v_and_b32 v52, v52, v100
    v_and_b32 v53, v53, v101
    v_and_b32 v54, v54, v102
    v_and_b32 v55, v55, v103
    v_and_b32 v48, v48, v49
    v_and_b32 v50, v50, v51
    v_and_b32 v52, v52, v53
    v_and_b32 v54, v54, v55
    v_and_b32 v48, v48, v50
    v_and_b32 v52, v52, v54
    v_and_b32 v48, v48, v52
    v_and_b32 v48, 1, v48
    v_cmp_eq_u32 vcc, 0, v48
    s_and_b64 exec, exec, vcc
    s_cbranch_execnz .cpollB_12
    s_branch .crdy_14
.codd_13:
    v_or3_b32 v48, v16, v17, v18
    v_or3_b32 v49, v19, v20, v21
    v_or3_b32 v50, v22, v23, v24
    v_or3_b32 v51, v25, v26, v27
    v_or3_b32 v52, v28, v29, v30
    v_or3_b32 v53, v31, v32, v33
    v_or3_b32 v54, v34, v35, v36
    v_or3_b32 v55, v37, v38, v39
    v_or3_b32 v96, v40, v41, v42
    v_or3_b32 v97, v43, v44, v45
    v_or3_b32 v48, v48, v49, v50
    v_or3_b32 v51, v51, v52, v53
    v_or3_b32 v54, v54, v55, v96
    v_or3_b32 v97, v97, v46, v47
    v_or3_b32 v48, v48, v51, v54
    v_or_b32 v48, v48, v97
    v_and_b32 v48, 1, v48
    v_cmp_ne_u32 vcc, 0, v48
    s_and_b64 exec, exec, vcc
    s_cbranch_execnz .cpollB_12
.crdy_14:
    s_mov_b64 exec, -1
    v_pk_add_f32 v[16:17], v[16:17], v[32:33]
    v_pk_add_f32 v[18:19], v[18:19], v[34:35]
    v_pk_add_f32 v[20:21], v[20:21], v[36:37]
    v_pk_add_f32 v[22:23], v[22:23], v[38:39]
    v_pk_add_f32 v[24:25], v[24:25], v[40:41]
    v_pk_add_f32 v[26:27], v[26:27], v[42:43]
    v_pk_add_f32 v[28:29], v[28:29], v[44:45]
    v_pk_add_f32 v[30:31], v[30:31], v[46:47]
    v_pk_add_f32 v[16:17], v[16:17], v[24:25]
    v_pk_add_f32 v[18:19], v[18:19], v[26:27]
    v_pk_add_f32 v[20:21], v[20:21], v[28:29]
    v_pk_add_f32 v[22:23], v[22:23], v[30:31]
    v_pk_add_f32 v[16:17], v[16:17], v[20:21]
    v_pk_add_f32 v[18:19], v[18:19], v[22:23]
    v_mov_b32 v20, v16
    v_mov_b32 v21, v17
    v_mov_b32 v22, v18
    v_mov_b32 v23, v19
    s_nop 1
    v_permlane32_swap_b32 v16, v20
    v_permlane32_swap_b32 v17, v21
    v_permlane32_swap_b32 v18, v22
    v_permlane32_swap_b32 v19, v23
    v_pk_add_f32 v[16:17], v[16:17], v[20:21]
    v_pk_add_f32 v[18:19], v[18:19], v[22:23]
    v_mov_b32 v20, v16
    v_mov_b32 v21, v17
    v_mov_b32 v22, v18
    v_mov_b32 v23, v19
    s_nop 1
    v_permlane16_swap_b32 v16, v20
    v_permlane16_swap_b32 v17, v21
    v_permlane16_swap_b32 v18, v22
    v_permlane16_swap_b32 v19, v23
    v_pk_add_f32 v[16:17], v[16:17], v[20:21]
    v_pk_add_f32 v[18:19], v[18:19], v[22:23]
    s_nop 1
    v_add_f32_dpp v16, v16, v16 row_ror:8 row_mask:0xf bank_mask:0xf
    v_add_f32_dpp v17, v17, v17 row_ror:8 row_mask:0xf bank_mask:0xf
    v_add_f32_dpp v18, v18, v18 row_ror:8 row_mask:0xf bank_mask:0xf
    v_add_f32_dpp v19, v19, v19 row_ror:8 row_mask:0xf bank_mask:0xf
    v_cvt_pk_bf16_f32 v20, v16, v17
    v_cvt_pk_bf16_f32 v21, v18, v19
    v_mov_b32 v22, 0x7fff7fff
    v_cmp_eq_u32 vcc, -1, v20
    s_nop 1
    v_cndmask_b32 v20, v20, v22, vcc
    v_cmp_eq_u32 vcc, -1, v21
    s_nop 1
    v_cndmask_b32 v21, v21, v22, vcc
    buffer_store_dwordx2 v[20:21], v12, s[16:19], s83 offen sc1
.cnopub_15:
    s_sleep 2
    s_sleep 2
    s_sleep 2
    s_sleep 2
    s_sleep 2
    s_sleep 2
    s_sleep 2
    s_sleep 2
    s_sleep 2
    s_sleep 2
    s_branch .cgo_16
.cnored_8:
    s_sleep 2
    s_sleep 2
    s_sleep 2
    s_sleep 2
    s_sleep 2
    s_sleep 2
    s_sleep 2
    s_sleep 2
    s_sleep 2
    s_sleep 2
    s_sleep 2
    s_sleep 2
    s_sleep 2
    s_sleep 2
    s_sleep 2
    s_sleep 2
    s_sleep 2
    s_sleep 2
    s_sleep 2
    s_sleep 2
    s_sleep 2
    s_sleep 2
    s_sleep 2
    s_sleep 2
    s_sleep 2
    s_sleep 2
    s_sleep 2
    s_sleep 2
    s_sleep 2
    s_sleep 2
    s_sleep 2
    s_sleep 2
    s_sleep 2
    s_sleep 2
    s_sleep 2
    s_sleep 2
.cgo_16:
    s_mov_b32 s90, 0
.cpollA_17:
    s_add_u32 s90, s90, 1
    s_cmp_gt_u32 s90, 400000
    s_cbranch_scc1 .cend_4
    s_add_u32 s7, s83, 0
    buffer_load_dwordx2 v[24:25], v13, s[16:19], s7 offen sc1
    s_add_u32 s7, s83, 4096
    buffer_load_dwordx2 v[26:27], v13, s[16:19], s7 offen sc1
    s_add_u32 s7, s83, 8192
    buffer_load_dwordx2 v[28:29], v13, s[16:19], s7 offen sc1
    s_add_u32 s7, s83, 12288
    buffer_load_dwordx2 v[30:31], v13, s[16:19], s7 offen sc1
    s_add_u32 s7, s83, 16384
    buffer_load_dwordx2 v[32:33], v13, s[16:19], s7 offen sc1
    s_waitcnt vmcnt(0)
    v_max3_u32 v34, v24, v25, v26
    v_max3_u32 v35, v27, v28, v29
    v_max3_u32 v36, v30, v31, v32
    v_max3_u32 v34, v34, v35, v33
    v_max_u32 v34, v34, v36
    v_cmp_eq_u32 vcc, -1, v34
    s_and_b64 exec, exec, vcc
    s_cbranch_execnz .cpollA_17
    s_mov_b64 exec, -1
    ds_write_b64 v104, v[24:25]
    ds_write_b64 v105, v[26:27]
    ds_write_b64 v106, v[28:29]
    ds_write_b64 v107, v[30:31]
    ds_write_b64 v108, v[32:33]
    s_add_u32 s79, s79, 1
    s_add_u32 s83, s83, 20480
    s_add_u32 s87, s87, 10240
    s_add_u32 s88, s88, 10240
    v_xor_b32 v111, 1, v111
    s_branch .ctop_7
.cfin_9:
    buffer_store_dwordx4 v[48:51], v14, s[16:19], s82 offen sc1
    buffer_store_dwordx2 v[52:53], v15, s[16:19], s82 offen sc1
    s_waitcnt vmcnt(0)
    s_lshl_b32 s7, s3, 4
    s_lshl_b32 s100, s6, 2
    s_add_u32 s7, s7, s100
    s_add_u32 s7, s7, 109056192
    s_add_u32 s100, s79, 1
    v_mov_b32 v54, s100
    v_mov_b32 v55, s7
    v_cmp_eq_u32 vcc, 0, v1
    s_and_saveexec_b64 s[84:85], vcc
    buffer_store_dword v54, v55, s[16:19], 0 offen sc1
    s_mov_b64 exec, s[84:85]
.cend_4:
    s_mov_b64 exec, -1
    s_branch .fexit_3
.work_2:
    v_lshrrev_b32 v250, 6, v0
    s_nop 0
    v_readfirstlane_b32 s39, v250
    s_cmp_lg_u32 s39, 0
    s_cbranch_scc1 .wsk_18
    s_mov_b32 s100, 128
    v_mov_b32 v250, s100
    s_mov_b32 s101, 0
.ww_19:
    buffer_load_dword v251, v250, s[96:99], 0 offen sc1
    s_waitcnt vmcnt(0)
    v_readfirstlane_b32 s100, v251
    s_cmp_ge_u32 s100, 64
    s_cbranch_scc1 .wok_20
    s_add_u32 s101, s101, 1
    s_cmp_gt_u32 s101, 200000
    s_cbranch_scc1 .fexit_3
    s_sleep 4
    s_branch .ww_19
.wok_20:
.wsk_18:
    s_barrier
    s_mov_b32 s94, 4000
    s_mov_b32 s93, -1
.wloop_21:
    s_waitcnt vmcnt(0) lgkmcnt(0)
    s_barrier
    v_cmp_eq_u32 vcc, 0, v0
    s_and_saveexec_b64 s[84:85], vcc
    s_cbranch_execz .skipf_23
    v_mov_b32 v250, 1
    s_cmp_eq_u32 s93, -1
    s_cbranch_scc1 .nosig_22
    v_mov_b32 v251, s93
    buffer_atomic_add v250, v251, s[16:19], 0 offen
.nosig_22:
    v_mov_b32 v251, 0
    buffer_atomic_add v250, v251, s[96:99], 0 offen sc0
    s_waitcnt vmcnt(0)
    v_mov_b32 v251, 152000
    ds_write_b32 v251, v250
.skipf_23:
    s_mov_b64 exec, s[84:85]
    s_waitcnt lgkmcnt(0)
    s_barrier
    v_mov_b32 v251, 152000
    ds_read_b32 v250, v251
    s_waitcnt lgkmcnt(0)
    v_readfirstlane_b32 s94, v250
    s_mov_b32 s93, -1
    s_cmp_ge_u32 s94, 3713
    s_cbranch_scc1 .fexit_3
    s_cmp_lt_u32 s94, 1024
    s_cbranch_scc0 .tG_25
    s_mov_b32 s3, s94
    s_lshr_b32 s93, s3, 6
    s_lshl_b32 s93, s93, 6
    s_add_u32 s93, s93, 109051904
    s_branch .tP_24
.tG_25:
    s_cmp_lt_u32 s94, 1088
    s_cbranch_scc0 .tQ_31
    s_sub_u32 s3, s94, 1024
    s_mov_b32 s93, 109056128
    s_mov_b32 s24, s60
    s_and_b32 s25, s61, 0xffff
    s_mov_b32 s26, 1280
    s_mov_b32 s27, 0x00020000
    v_and_b32 v1, 63, v0
    v_lshrrev_b32 v2, 6, v0
    s_nop 0
    v_readfirstlane_b32 s6, v2
    v_lshlrev_b32 v3, 2, v1
    buffer_load_dword v8, v3, s[24:27], 0 offen offset:0
    buffer_load_dword v9, v3, s[24:27], 0 offen offset:256
    buffer_load_dword v10, v3, s[24:27], 0 offen offset:512
    buffer_load_dword v11, v3, s[24:27], 0 offen offset:768
    buffer_load_dword v12, v3, s[24:27], 0 offen offset:1024
    s_lshl_b32 s4, s3, 5
    s_lshl_b32 s5, s6, 3
    s_add_u32 s4, s4, s5
    s_mul_i32 s5, s4, 1280
    buffer_load_dword v32, v3, s[8:11], s5 offen offset:0
    buffer_load_dword v33, v3, s[8:11], s5 offen offset:256
    buffer_load_dword v34, v3, s[8:11], s5 offen offset:512
    buffer_load_dword v35, v3, s[8:11], s5 offen offset:768
    buffer_load_dword v36, v3, s[8:11], s5 offen offset:1024
    s_add_u32 s5, s5, 1280
    buffer_load_dword v37, v3, s[8:11], s5 offen offset:0
    buffer_load_dword v38, v3, s[8:11], s5 offen offset:256
    buffer_load_dword v39, v3, s[8:11], s5 offen offset:512
    buffer_load_dword v40, v3, s[8:11], s5 offen offset:768
    buffer_load_dword v41, v3, s[8:11], s5 offen offset:1024
    s_add_u32 s5, s5, 1280
    buffer_load_dword v42, v3, s[8:11], s5 offen offset:0
    buffer_load_dword v43, v3, s[8:11], s5 offen offset:256
    buffer_load_dword v44, v3, s[8:11], s5 offen offset:512
    buffer_load_dword v45, v3, s[8:11], s5 offen offset:768
    buffer_load_dword v46, v3, s[8:11], s5 offen offset:1024
    s_add_u32 s5, s5, 1280
    buffer_load_dword v47, v3, s[8:11], s5 offen offset:0
    buffer_load_dword v48, v3, s[8:11], s5 offen offset:256
    buffer_load_dword v49, v3, s[8:11], s5 offen offset:512
    buffer_load_dword v50, v3, s[8:11], s5 offen offset:768
    buffer_load_dword v51, v3, s[8:11], s5 offen offset:1024
    s_add_u32 s5, s5, 1280
    buffer_load_dword v52, v3, s[8:11], s5 offen offset:0
    buffer_load_dword v53, v3, s[8:11], s5 offen offset:256
    buffer_load_dword v54, v3, s[8:11], s5 offen offset:512
    buffer_load_dword v55, v3, s[8:11], s5 offen offset:768
    buffer_load_dword v56, v3, s[8:11], s5 offen offset:1024
    s_add_u32 s5, s5, 1280
    buffer_load_dword v57, v3, s[8:11], s5 offen offset:0
    buffer_load_dword v58, v3, s[8:11], s5 offen offset:256
    buffer_load_dword v59, v3, s[8:11], s5 offen offset:512
    buffer_load_dword v60, v3, s[8:11], s5 offen offset:768
    buffer_load_dword v61, v3, s[8:11], s5 offen offset:1024
    s_add_u32 s5, s5, 1280
    buffer_load_dword v62, v3, s[8:11], s5 offen offset:0
    buffer_load_dword v63, v3, s[8:11], s5 offen offset:256
    buffer_load_dword v64, v3, s[8:11], s5 offen offset:512
    buffer_load_dword v65, v3, s[8:11], s5 offen offset:768
    buffer_load_dword v66, v3, s[8:11], s5 offen offset:1024
    s_add_u32 s5, s5, 1280
    buffer_load_dword v67, v3, s[8:11], s5 offen offset:0
    buffer_load_dword v68, v3, s[8:11], s5 offen offset:256
    buffer_load_dword v69, v3, s[8:11], s5 offen offset:512
    buffer_load_dword v70, v3, s[8:11], s5 offen offset:768
    buffer_load_dword v71, v3, s[8:11], s5 offen offset:1024
    s_add_u32 s5, s5, 1280
    s_waitcnt vmcnt(0)
    v_lshlrev_b32 v16, 16, v8
    v_and_b32 v17, 0xffff0000, v8
    v_lshlrev_b32 v18, 16, v9
    v_and_b32 v19, 0xffff0000, v9
    v_lshlrev_b32 v20, 16, v10
    v_and_b32 v21, 0xffff0000, v10
    v_lshlrev_b32 v22, 16, v11
    v_and_b32 v23, 0xffff0000, v11
    v_lshlrev_b32 v24, 16, v12
    v_and_b32 v25, 0xffff0000, v12
    v_mov_b32 v26, 0
    v_lshlrev_b32 v27, 16, v32
    v_and_b32 v28, 0xffff0000, v32
    v_mul_f32 v27, v27, v16
    v_mul_f32 v28, v28, v17
    v_cvt_pk_bf16_f32 v27, v27, v28
    v_lshlrev_b32 v28, 16, v27
    v_and_b32 v27, 0xffff0000, v27
    v_add_f32 v26, v26, v28
    v_add_f32 v26, v26, v27
    v_lshlrev_b32 v27, 16, v33
    v_and_b32 v28, 0xffff0000, v33
    v_mul_f32 v27, v27, v18
    v_mul_f32 v28, v28, v19
    v_cvt_pk_bf16_f32 v27, v27, v28
    v_lshlrev_b32 v28, 16, v27
    v_and_b32 v27, 0xffff0000, v27
    v_add_f32 v26, v26, v28
    v_add_f32 v26, v26, v27
    v_lshlrev_b32 v27, 16, v34
    v_and_b32 v28, 0xffff0000, v34
    v_mul_f32 v27, v27, v20
    v_mul_f32 v28, v28, v21
    v_cvt_pk_bf16_f32 v27, v27, v28
    v_lshlrev_b32 v28, 16, v27
    v_and_b32 v27, 0xffff0000, v27
    v_add_f32 v26, v26, v28
    v_add_f32 v26, v26, v27
    v_lshlrev_b32 v27, 16, v35
    v_and_b32 v28, 0xffff0000, v35
    v_mul_f32 v27, v27, v22
    v_mul_f32 v28, v28, v23
    v_cvt_pk_bf16_f32 v27, v27, v28
    v_lshlrev_b32 v28, 16, v27
    v_and_b32 v27, 0xffff0000, v27
    v_add_f32 v26, v26, v28
    v_add_f32 v26, v26, v27
    v_lshlrev_b32 v27, 16, v36
    v_and_b32 v28, 0xffff0000, v36
    v_mul_f32 v27, v27, v24
    v_mul_f32 v28, v28, v25
    v_cvt_pk_bf16_f32 v27, v27, v28
    v_lshlrev_b32 v28, 16, v27
    v_and_b32 v27, 0xffff0000, v27
    v_add_f32 v26, v26, v28
    v_add_f32 v26, v26, v27
    v_mov_b32 v27, v26
    s_nop 1
    v_permlane32_swap_b32 v26, v27
    v_add_f32 v26, v26, v27
    v_mov_b32 v27, v26
    s_nop 1
    v_permlane16_swap_b32 v26, v27
    v_add_f32 v26, v26, v27
    s_nop 1
    v_add_f32_dpp v26, v26, v26 row_ror:8 row_mask:0xf bank_mask:0xf
    s_nop 1
    v_add_f32_dpp v26, v26, v26 row_ror:4 row_mask:0xf bank_mask:0xf
    s_nop 1
    v_add_f32_dpp v26, v26, v26 row_ror:2 row_mask:0xf bank_mask:0xf
    s_nop 1
    v_add_f32_dpp v26, v26, v26 row_ror:1 row_mask:0xf bank_mask:0xf
    v_mov_b32 v80, v26
    v_mov_b32 v26, 0
    v_lshlrev_b32 v27, 16, v37
    v_and_b32 v28, 0xffff0000, v37
    v_mul_f32 v27, v27, v16
    v_mul_f32 v28, v28, v17
    v_cvt_pk_bf16_f32 v27, v27, v28
    v_lshlrev_b32 v28, 16, v27
    v_and_b32 v27, 0xffff0000, v27
    v_add_f32 v26, v26, v28
    v_add_f32 v26, v26, v27
    v_lshlrev_b32 v27, 16, v38
    v_and_b32 v28, 0xffff0000, v38
    v_mul_f32 v27, v27, v18
    v_mul_f32 v28, v28, v19
    v_cvt_pk_bf16_f32 v27, v27, v28
    v_lshlrev_b32 v28, 16, v27
    v_and_b32 v27, 0xffff0000, v27
    v_add_f32 v26, v26, v28
    v_add_f32 v26, v26, v27
    v_lshlrev_b32 v27, 16, v39
    v_and_b32 v28, 0xffff0000, v39
    v_mul_f32 v27, v27, v20
    v_mul_f32 v28, v28, v21
    v_cvt_pk_bf16_f32 v27, v27, v28
    v_lshlrev_b32 v28, 16, v27
    v_and_b32 v27, 0xffff0000, v27
    v_add_f32 v26, v26, v28
    v_add_f32 v26, v26, v27
    v_lshlrev_b32 v27, 16, v40
    v_and_b32 v28, 0xffff0000, v40
    v_mul_f32 v27, v27, v22
    v_mul_f32 v28, v28, v23
    v_cvt_pk_bf16_f32 v27, v27, v28
    v_lshlrev_b32 v28, 16, v27
    v_and_b32 v27, 0xffff0000, v27
    v_add_f32 v26, v26, v28
    v_add_f32 v26, v26, v27
    v_lshlrev_b32 v27, 16, v41
    v_and_b32 v28, 0xffff0000, v41
    v_mul_f32 v27, v27, v24
    v_mul_f32 v28, v28, v25
    v_cvt_pk_bf16_f32 v27, v27, v28
    v_lshlrev_b32 v28, 16, v27
    v_and_b32 v27, 0xffff0000, v27
    v_add_f32 v26, v26, v28
    v_add_f32 v26, v26, v27
    v_mov_b32 v27, v26
    s_nop 1
    v_permlane32_swap_b32 v26, v27
    v_add_f32 v26, v26, v27
    v_mov_b32 v27, v26
    s_nop 1
    v_permlane16_swap_b32 v26, v27
    v_add_f32 v26, v26, v27
    s_nop 1
    v_add_f32_dpp v26, v26, v26 row_ror:8 row_mask:0xf bank_mask:0xf
    s_nop 1
    v_add_f32_dpp v26, v26, v26 row_ror:4 row_mask:0xf bank_mask:0xf
    s_nop 1
    v_add_f32_dpp v26, v26, v26 row_ror:2 row_mask:0xf bank_mask:0xf
    s_nop 1
    v_add_f32_dpp v26, v26, v26 row_ror:1 row_mask:0xf bank_mask:0xf
    v_mov_b32 v81, v26
    v_mov_b32 v26, 0
    v_lshlrev_b32 v27, 16, v42
    v_and_b32 v28, 0xffff0000, v42
    v_mul_f32 v27, v27, v16
    v_mul_f32 v28, v28, v17
    v_cvt_pk_bf16_f32 v27, v27, v28
    v_lshlrev_b32 v28, 16, v27
    v_and_b32 v27, 0xffff0000, v27
    v_add_f32 v26, v26, v28
    v_add_f32 v26, v26, v27
    v_lshlrev_b32 v27, 16, v43
    v_and_b32 v28, 0xffff0000, v43
    v_mul_f32 v27, v27, v18
    v_mul_f32 v28, v28, v19
    v_cvt_pk_bf16_f32 v27, v27, v28
    v_lshlrev_b32 v28, 16, v27
    v_and_b32 v27, 0xffff0000, v27
    v_add_f32 v26, v26, v28
    v_add_f32 v26, v26, v27
    v_lshlrev_b32 v27, 16, v44
    v_and_b32 v28, 0xffff0000, v44
    v_mul_f32 v27, v27, v20
    v_mul_f32 v28, v28, v21
    v_cvt_pk_bf16_f32 v27, v27, v28
    v_lshlrev_b32 v28, 16, v27
    v_and_b32 v27, 0xffff0000, v27
    v_add_f32 v26, v26, v28
    v_add_f32 v26, v26, v27
    v_lshlrev_b32 v27, 16, v45
    v_and_b32 v28, 0xffff0000, v45
    v_mul_f32 v27, v27, v22
    v_mul_f32 v28, v28, v23
    v_cvt_pk_bf16_f32 v27, v27, v28
    v_lshlrev_b32 v28, 16, v27
    v_and_b32 v27, 0xffff0000, v27
    v_add_f32 v26, v26, v28
    v_add_f32 v26, v26, v27
    v_lshlrev_b32 v27, 16, v46
    v_and_b32 v28, 0xffff0000, v46
    v_mul_f32 v27, v27, v24
    v_mul_f32 v28, v28, v25
    v_cvt_pk_bf16_f32 v27, v27, v28
    v_lshlrev_b32 v28, 16, v27
    v_and_b32 v27, 0xffff0000, v27
    v_add_f32 v26, v26, v28
    v_add_f32 v26, v26, v27
    v_mov_b32 v27, v26
    s_nop 1
    v_permlane32_swap_b32 v26, v27
    v_add_f32 v26, v26, v27
    v_mov_b32 v27, v26
    s_nop 1
    v_permlane16_swap_b32 v26, v27
    v_add_f32 v26, v26, v27
    s_nop 1
    v_add_f32_dpp v26, v26, v26 row_ror:8 row_mask:0xf bank_mask:0xf
    s_nop 1
    v_add_f32_dpp v26, v26, v26 row_ror:4 row_mask:0xf bank_mask:0xf
    s_nop 1
    v_add_f32_dpp v26, v26, v26 row_ror:2 row_mask:0xf bank_mask:0xf
    s_nop 1
    v_add_f32_dpp v26, v26, v26 row_ror:1 row_mask:0xf bank_mask:0xf
    v_mov_b32 v82, v26
    v_mov_b32 v26, 0
    v_lshlrev_b32 v27, 16, v47
    v_and_b32 v28, 0xffff0000, v47
    v_mul_f32 v27, v27, v16
    v_mul_f32 v28, v28, v17
    v_cvt_pk_bf16_f32 v27, v27, v28
    v_lshlrev_b32 v28, 16, v27
    v_and_b32 v27, 0xffff0000, v27
    v_add_f32 v26, v26, v28
    v_add_f32 v26, v26, v27
    v_lshlrev_b32 v27, 16, v48
    v_and_b32 v28, 0xffff0000, v48
    v_mul_f32 v27, v27, v18
    v_mul_f32 v28, v28, v19
    v_cvt_pk_bf16_f32 v27, v27, v28
    v_lshlrev_b32 v28, 16, v27
    v_and_b32 v27, 0xffff0000, v27
    v_add_f32 v26, v26, v28
    v_add_f32 v26, v26, v27
    v_lshlrev_b32 v27, 16, v49
    v_and_b32 v28, 0xffff0000, v49
    v_mul_f32 v27, v27, v20
    v_mul_f32 v28, v28, v21
    v_cvt_pk_bf16_f32 v27, v27, v28
    v_lshlrev_b32 v28, 16, v27
    v_and_b32 v27, 0xffff0000, v27
    v_add_f32 v26, v26, v28
    v_add_f32 v26, v26, v27
    v_lshlrev_b32 v27, 16, v50
    v_and_b32 v28, 0xffff0000, v50
    v_mul_f32 v27, v27, v22
    v_mul_f32 v28, v28, v23
    v_cvt_pk_bf16_f32 v27, v27, v28
    v_lshlrev_b32 v28, 16, v27
    v_and_b32 v27, 0xffff0000, v27
    v_add_f32 v26, v26, v28
    v_add_f32 v26, v26, v27
    v_lshlrev_b32 v27, 16, v51
    v_and_b32 v28, 0xffff0000, v51
    v_mul_f32 v27, v27, v24
    v_mul_f32 v28, v28, v25
    v_cvt_pk_bf16_f32 v27, v27, v28
    v_lshlrev_b32 v28, 16, v27
    v_and_b32 v27, 0xffff0000, v27
    v_add_f32 v26, v26, v28
    v_add_f32 v26, v26, v27
    v_mov_b32 v27, v26
    s_nop 1
    v_permlane32_swap_b32 v26, v27
    v_add_f32 v26, v26, v27
    v_mov_b32 v27, v26
    s_nop 1
    v_permlane16_swap_b32 v26, v27
    v_add_f32 v26, v26, v27
    s_nop 1
    v_add_f32_dpp v26, v26, v26 row_ror:8 row_mask:0xf bank_mask:0xf
    s_nop 1
    v_add_f32_dpp v26, v26, v26 row_ror:4 row_mask:0xf bank_mask:0xf
    s_nop 1
    v_add_f32_dpp v26, v26, v26 row_ror:2 row_mask:0xf bank_mask:0xf
    s_nop 1
    v_add_f32_dpp v26, v26, v26 row_ror:1 row_mask:0xf bank_mask:0xf
    v_mov_b32 v83, v26
    v_mov_b32 v26, 0
    v_lshlrev_b32 v27, 16, v52
    v_and_b32 v28, 0xffff0000, v52
    v_mul_f32 v27, v27, v16
    v_mul_f32 v28, v28, v17
    v_cvt_pk_bf16_f32 v27, v27, v28
    v_lshlrev_b32 v28, 16, v27
    v_and_b32 v27, 0xffff0000, v27
    v_add_f32 v26, v26, v28
    v_add_f32 v26, v26, v27
    v_lshlrev_b32 v27, 16, v53
    v_and_b32 v28, 0xffff0000, v53
    v_mul_f32 v27, v27, v18
    v_mul_f32 v28, v28, v19
    v_cvt_pk_bf16_f32 v27, v27, v28
    v_lshlrev_b32 v28, 16, v27
    v_and_b32 v27, 0xffff0000, v27
    v_add_f32 v26, v26, v28
    v_add_f32 v26, v26, v27
    v_lshlrev_b32 v27, 16, v54
    v_and_b32 v28, 0xffff0000, v54
    v_mul_f32 v27, v27, v20
    v_mul_f32 v28, v28, v21
    v_cvt_pk_bf16_f32 v27, v27, v28
    v_lshlrev_b32 v28, 16, v27
    v_and_b32 v27, 0xffff0000, v27
    v_add_f32 v26, v26, v28
    v_add_f32 v26, v26, v27
    v_lshlrev_b32 v27, 16, v55
    v_and_b32 v28, 0xffff0000, v55
    v_mul_f32 v27, v27, v22
    v_mul_f32 v28, v28, v23
    v_cvt_pk_bf16_f32 v27, v27, v28
    v_lshlrev_b32 v28, 16, v27
    v_and_b32 v27, 0xffff0000, v27
    v_add_f32 v26, v26, v28
    v_add_f32 v26, v26, v27
    v_lshlrev_b32 v27, 16, v56
    v_and_b32 v28, 0xffff0000, v56
    v_mul_f32 v27, v27, v24
    v_mul_f32 v28, v28, v25
    v_cvt_pk_bf16_f32 v27, v27, v28
    v_lshlrev_b32 v28, 16, v27
    v_and_b32 v27, 0xffff0000, v27
    v_add_f32 v26, v26, v28
    v_add_f32 v26, v26, v27
    v_mov_b32 v27, v26
    s_nop 1
    v_permlane32_swap_b32 v26, v27
    v_add_f32 v26, v26, v27
    v_mov_b32 v27, v26
    s_nop 1
    v_permlane16_swap_b32 v26, v27
    v_add_f32 v26, v26, v27
    s_nop 1
    v_add_f32_dpp v26, v26, v26 row_ror:8 row_mask:0xf bank_mask:0xf
    s_nop 1
    v_add_f32_dpp v26, v26, v26 row_ror:4 row_mask:0xf bank_mask:0xf
    s_nop 1
    v_add_f32_dpp v26, v26, v26 row_ror:2 row_mask:0xf bank_mask:0xf
    s_nop 1
    v_add_f32_dpp v26, v26, v26 row_ror:1 row_mask:0xf bank_mask:0xf
    v_mov_b32 v84, v26
    v_mov_b32 v26, 0
    v_lshlrev_b32 v27, 16, v57
    v_and_b32 v28, 0xffff0000, v57
    v_mul_f32 v27, v27, v16
    v_mul_f32 v28, v28, v17
    v_cvt_pk_bf16_f32 v27, v27, v28
    v_lshlrev_b32 v28, 16, v27
    v_and_b32 v27, 0xffff0000, v27
    v_add_f32 v26, v26, v28
    v_add_f32 v26, v26, v27
    v_lshlrev_b32 v27, 16, v58
    v_and_b32 v28, 0xffff0000, v58
    v_mul_f32 v27, v27, v18
    v_mul_f32 v28, v28, v19
    v_cvt_pk_bf16_f32 v27, v27, v28
    v_lshlrev_b32 v28, 16, v27
    v_and_b32 v27, 0xffff0000, v27
    v_add_f32 v26, v26, v28
    v_add_f32 v26, v26, v27
    v_lshlrev_b32 v27, 16, v59
    v_and_b32 v28, 0xffff0000, v59
    v_mul_f32 v27, v27, v20
    v_mul_f32 v28, v28, v21
    v_cvt_pk_bf16_f32 v27, v27, v28
    v_lshlrev_b32 v28, 16, v27
    v_and_b32 v27, 0xffff0000, v27
    v_add_f32 v26, v26, v28
    v_add_f32 v26, v26, v27
    v_lshlrev_b32 v27, 16, v60
    v_and_b32 v28, 0xffff0000, v60
    v_mul_f32 v27, v27, v22
    v_mul_f32 v28, v28, v23
    v_cvt_pk_bf16_f32 v27, v27, v28
    v_lshlrev_b32 v28, 16, v27
    v_and_b32 v27, 0xffff0000, v27
    v_add_f32 v26, v26, v28
    v_add_f32 v26, v26, v27
    v_lshlrev_b32 v27, 16, v61
    v_and_b32 v28, 0xffff0000, v61
    v_mul_f32 v27, v27, v24
    v_mul_f32 v28, v28, v25
    v_cvt_pk_bf16_f32 v27, v27, v28
    v_lshlrev_b32 v28, 16, v27
    v_and_b32 v27, 0xffff0000, v27
    v_add_f32 v26, v26, v28
    v_add_f32 v26, v26, v27
    v_mov_b32 v27, v26
    s_nop 1
    v_permlane32_swap_b32 v26, v27
    v_add_f32 v26, v26, v27
    v_mov_b32 v27, v26
    s_nop 1
    v_permlane16_swap_b32 v26, v27
    v_add_f32 v26, v26, v27
    s_nop 1
    v_add_f32_dpp v26, v26, v26 row_ror:8 row_mask:0xf bank_mask:0xf
    s_nop 1
    v_add_f32_dpp v26, v26, v26 row_ror:4 row_mask:0xf bank_mask:0xf
    s_nop 1
    v_add_f32_dpp v26, v26, v26 row_ror:2 row_mask:0xf bank_mask:0xf
    s_nop 1
    v_add_f32_dpp v26, v26, v26 row_ror:1 row_mask:0xf bank_mask:0xf
    v_mov_b32 v85, v26
    v_mov_b32 v26, 0
    v_lshlrev_b32 v27, 16, v62
    v_and_b32 v28, 0xffff0000, v62
    v_mul_f32 v27, v27, v16
    v_mul_f32 v28, v28, v17
    v_cvt_pk_bf16_f32 v27, v27, v28
    v_lshlrev_b32 v28, 16, v27
    v_and_b32 v27, 0xffff0000, v27
    v_add_f32 v26, v26, v28
    v_add_f32 v26, v26, v27
    v_lshlrev_b32 v27, 16, v63
    v_and_b32 v28, 0xffff0000, v63
    v_mul_f32 v27, v27, v18
    v_mul_f32 v28, v28, v19
    v_cvt_pk_bf16_f32 v27, v27, v28
    v_lshlrev_b32 v28, 16, v27
    v_and_b32 v27, 0xffff0000, v27
    v_add_f32 v26, v26, v28
    v_add_f32 v26, v26, v27
    v_lshlrev_b32 v27, 16, v64
    v_and_b32 v28, 0xffff0000, v64
    v_mul_f32 v27, v27, v20
    v_mul_f32 v28, v28, v21
    v_cvt_pk_bf16_f32 v27, v27, v28
    v_lshlrev_b32 v28, 16, v27
    v_and_b32 v27, 0xffff0000, v27
    v_add_f32 v26, v26, v28
    v_add_f32 v26, v26, v27
    v_lshlrev_b32 v27, 16, v65
    v_and_b32 v28, 0xffff0000, v65
    v_mul_f32 v27, v27, v22
    v_mul_f32 v28, v28, v23
    v_cvt_pk_bf16_f32 v27, v27, v28
    v_lshlrev_b32 v28, 16, v27
    v_and_b32 v27, 0xffff0000, v27
    v_add_f32 v26, v26, v28
    v_add_f32 v26, v26, v27
    v_lshlrev_b32 v27, 16, v66
    v_and_b32 v28, 0xffff0000, v66
    v_mul_f32 v27, v27, v24
    v_mul_f32 v28, v28, v25
    v_cvt_pk_bf16_f32 v27, v27, v28
    v_lshlrev_b32 v28, 16, v27
    v_and_b32 v27, 0xffff0000, v27
    v_add_f32 v26, v26, v28
    v_add_f32 v26, v26, v27
    v_mov_b32 v27, v26
    s_nop 1
    v_permlane32_swap_b32 v26, v27
    v_add_f32 v26, v26, v27
    v_mov_b32 v27, v26
    s_nop 1
    v_permlane16_swap_b32 v26, v27
    v_add_f32 v26, v26, v27
    s_nop 1
    v_add_f32_dpp v26, v26, v26 row_ror:8 row_mask:0xf bank_mask:0xf
    s_nop 1
    v_add_f32_dpp v26, v26, v26 row_ror:4 row_mask:0xf bank_mask:0xf
    s_nop 1
    v_add_f32_dpp v26, v26, v26 row_ror:2 row_mask:0xf bank_mask:0xf
    s_nop 1
    v_add_f32_dpp v26, v26, v26 row_ror:1 row_mask:0xf bank_mask:0xf
    v_mov_b32 v86, v26
    v_mov_b32 v26, 0
    v_lshlrev_b32 v27, 16, v67
    v_and_b32 v28, 0xffff0000, v67
    v_mul_f32 v27, v27, v16
    v_mul_f32 v28, v28, v17
    v_cvt_pk_bf16_f32 v27, v27, v28
    v_lshlrev_b32 v28, 16, v27
    v_and_b32 v27, 0xffff0000, v27
    v_add_f32 v26, v26, v28
    v_add_f32 v26, v26, v27
    v_lshlrev_b32 v27, 16, v68
    v_and_b32 v28, 0xffff0000, v68
    v_mul_f32 v27, v27, v18
    v_mul_f32 v28, v28, v19
    v_cvt_pk_bf16_f32 v27, v27, v28
    v_lshlrev_b32 v28, 16, v27
    v_and_b32 v27, 0xffff0000, v27
    v_add_f32 v26, v26, v28
    v_add_f32 v26, v26, v27
    v_lshlrev_b32 v27, 16, v69
    v_and_b32 v28, 0xffff0000, v69
    v_mul_f32 v27, v27, v20
    v_mul_f32 v28, v28, v21
    v_cvt_pk_bf16_f32 v27, v27, v28
    v_lshlrev_b32 v28, 16, v27
    v_and_b32 v27, 0xffff0000, v27
    v_add_f32 v26, v26, v28
    v_add_f32 v26, v26, v27
    v_lshlrev_b32 v27, 16, v70
    v_and_b32 v28, 0xffff0000, v70
    v_mul_f32 v27, v27, v22
    v_mul_f32 v28, v28, v23
    v_cvt_pk_bf16_f32 v27, v27, v28
    v_lshlrev_b32 v28, 16, v27
    v_and_b32 v27, 0xffff0000, v27
    v_add_f32 v26, v26, v28
    v_add_f32 v26, v26, v27
    v_lshlrev_b32 v27, 16, v71
    v_and_b32 v28, 0xffff0000, v71
    v_mul_f32 v27, v27, v24
    v_mul_f32 v28, v28, v25
    v_cvt_pk_bf16_f32 v27, v27, v28
    v_lshlrev_b32 v28, 16, v27
    v_and_b32 v27, 0xffff0000, v27
    v_add_f32 v26, v26, v28
    v_add_f32 v26, v26, v27
    v_mov_b32 v27, v26
    s_nop 1
    v_permlane32_swap_b32 v26, v27
    v_add_f32 v26, v26, v27
    v_mov_b32 v27, v26
    s_nop 1
    v_permlane16_swap_b32 v26, v27
    v_add_f32 v26, v26, v27
    s_nop 1
    v_add_f32_dpp v26, v26, v26 row_ror:8 row_mask:0xf bank_mask:0xf
    s_nop 1
    v_add_f32_dpp v26, v26, v26 row_ror:4 row_mask:0xf bank_mask:0xf
    s_nop 1
    v_add_f32_dpp v26, v26, v26 row_ror:2 row_mask:0xf bank_mask:0xf
    s_nop 1
    v_add_f32_dpp v26, v26, v26 row_ror:1 row_mask:0xf bank_mask:0xf
    v_mov_b32 v87, v26
    v_mov_b32 v26, v80
    v_cmp_eq_u32 vcc, 1, v1
    s_nop 1
    v_cndmask_b32 v26, v26, v81, vcc
    v_cmp_eq_u32 vcc, 2, v1
    s_nop 1
    v_cndmask_b32 v26, v26, v82, vcc
    v_cmp_eq_u32 vcc, 3, v1
    s_nop 1
    v_cndmask_b32 v26, v26, v83, vcc
    v_cmp_eq_u32 vcc, 4, v1
    s_nop 1
    v_cndmask_b32 v26, v26, v84, vcc
    v_cmp_eq_u32 vcc, 5, v1
    s_nop 1
    v_cndmask_b32 v26, v26, v85, vcc
    v_cmp_eq_u32 vcc, 6, v1
    s_nop 1
    v_cndmask_b32 v26, v26, v86, vcc
    v_cmp_eq_u32 vcc, 7, v1
    s_nop 1
    v_cndmask_b32 v26, v26, v87, vcc
    v_cvt_pk_bf16_f32 v26, v26, v26
    v_lshlrev_b32 v26, 16, v26
    v_mul_f32 v27, 0xbfb8aa3b, v26
    v_exp_f32 v27, v27
    s_nop 0
    v_add_f32 v27, 1.0, v27
    v_rcp_f32 v27, v27
    s_nop 0
    v_cvt_pk_bf16_f32 v27, v27, v27
    v_lshlrev_b32 v28, 16, v27
    v_sub_f32 v29, 1.0, v28
    v_cvt_pk_bf16_f32 v29, v29, v29
    v_lshlrev_b32 v29, 16, v29
    s_lshl_b32 s5, s4, 3
    s_add_u32 s5, s5, 103809024
    v_lshlrev_b32 v30, 3, v1
    v_add_u32 v30, s5, v30
    v_cmp_gt_u32 vcc, 8, v1
    s_and_saveexec_b64 s[84:85], vcc
    buffer_store_dwordx2 v[28:29], v30, s[16:19], 0 offen sc1
    s_mov_b64 exec, s[84:85]
    s_branch .wloop_21
.tQ_31:
    s_cmp_lt_u32 s94, 1600
    s_cbranch_scc0 .tF1_26
    s_sub_u32 s3, s94, 1088
    s_lshr_b32 s93, s3, 5
    s_lshl_b32 s93, s93, 6
    s_add_u32 s93, s93, 109052928
    s_add_u32 s3, s3, 1024
.tP_24:
    s_cmp_lt_u32 s3, 1024
    s_cbranch_scc0 .Pq_33
    s_lshr_b32 s30, s3, 6
    s_and_b32 s31, s3, 63
    s_add_u32 s31, s31, 32
    s_branch .Pd_34
.Pq_33:
    s_sub_u32 s31, s3, 1024
    s_lshr_b32 s30, s31, 5
    s_and_b32 s31, s31, 31
.Pd_34:
    s_lshr_b32 s32, s31, 5
    s_and_b32 s33, s31, 31
    s_cmp_eq_u32 s32, 0
    s_cselect_b32 s12, s50, s52
    s_cselect_b32 s13, s51, s53
    s_cmp_eq_u32 s32, 2
    s_cselect_b32 s12, s54, s12
    s_cselect_b32 s13, s55, s13
    s_and_b32 s13, s13, 0xffff
    s_mov_b32 s14, 5242880
    s_mov_b32 s15, 0x00020000
    v_and_b32 v7, 63, v0
    v_lshrrev_b32 v20, 6, v0
    s_nop 0
    v_readfirstlane_b32 s6, v20
    v_lshrrev_b32 v20, 3, v0
    v_and_b32 v21, 7, v0
    v_mul_u32_u24 v3, 144, v20
    v_lshl_add_u32 v3, v21, 4, v3
    v_lshrrev_b32 v22, 4, v0
    v_and_b32 v23, 15, v0
    v_mul_u32_u24 v4, 272, v22
    v_lshl_add_u32 v4, v23, 4, v4
    v_add_u32 v4, 36864, v4
    v_and_b32 v24, 15, v7
    v_lshrrev_b32 v25, 4, v7
    v_lshrrev_b32 v26, 2, v24
    v_and_b32 v27, 3, v24
    v_lshl_add_u32 v28, v26, 3, v27
    s_lshr_b32 s7, s6, 1
    s_lshl_b32 s7, s7, 6
    v_add_u32 v28, s7, v28
    v_mul_u32_u24 v5, 144, v28
    v_lshl_add_u32 v5, v25, 4, v5
    v_lshl_add_u32 v28, v25, 3, v26
    v_mul_u32_u24 v6, 272, v28
    s_and_b32 s7, s6, 1
    s_lshl_b32 s7, s7, 7
    v_lshl_add_u32 v6, v27, 4, v6
    v_add_u32 v6, s7, v6
    v_add_u32 v6, 36864, v6
    s_lshl_b32 s7, s30, 7
    v_add_u32 v28, s7, v20
    v_mul_u32_u24 v8, 1280, v28
    v_lshl_add_u32 v8, v21, 4, v8
    v_add_u32 v9, 40960, v8
    v_add_u32 v10, 81920, v8
    v_add_u32 v11, 122880, v8
    v_lshlrev_b32 v12, 13, v22
    v_lshl_add_u32 v12, v23, 4, v12
    s_lshl_b32 s7, s33, 8
    v_add_u32 v12, s7, v12
    v_add_u32 v13, 131072, v12
    v_add_u32 v14, 262144, v12
    v_add_u32 v15, 393216, v12
    s_mov_b32 s34, 0
    s_mov_b32 s35, 0
    s_cmp_eq_u32 s32, 2
    s_cbranch_scc1 .Pv_35
    v_mov_b32 v64, 0
    v_mov_b32 v65, 0
    v_mov_b32 v66, 0
    v_mov_b32 v67, 0
    v_mov_b32 v68, 0
    v_mov_b32 v69, 0
    v_mov_b32 v70, 0
    v_mov_b32 v71, 0
    v_mov_b32 v72, 0
    v_mov_b32 v73, 0
    v_mov_b32 v74, 0
    v_mov_b32 v75, 0
    v_mov_b32 v76, 0
    v_mov_b32 v77, 0
    v_mov_b32 v78, 0
    v_mov_b32 v79, 0
    v_mov_b32 v80, 0
    v_mov_b32 v81, 0
    v_mov_b32 v82, 0
    v_mov_b32 v83, 0
    v_mov_b32 v84, 0
    v_mov_b32 v85, 0
    v_mov_b32 v86, 0
    v_mov_b32 v87, 0
    v_mov_b32 v88, 0
    v_mov_b32 v89, 0
    v_mov_b32 v90, 0
    v_mov_b32 v91, 0
    v_mov_b32 v92, 0
    v_mov_b32 v93, 0
    v_mov_b32 v94, 0
    v_mov_b32 v95, 0
    v_mov_b32 v96, 0
    v_mov_b32 v97, 0
    v_mov_b32 v98, 0
    v_mov_b32 v99, 0
    v_mov_b32 v100, 0
    v_mov_b32 v101, 0
    v_mov_b32 v102, 0
    v_mov_b32 v103, 0
    v_mov_b32 v104, 0
    v_mov_b32 v105, 0
    v_mov_b32 v106, 0
    v_mov_b32 v107, 0
    v_mov_b32 v108, 0
    v_mov_b32 v109, 0
    v_mov_b32 v110, 0
    v_mov_b32 v111, 0
    v_mov_b32 v112, 0
    v_mov_b32 v113, 0
    v_mov_b32 v114, 0
    v_mov_b32 v115, 0
    v_mov_b32 v116, 0
    v_mov_b32 v117, 0
    v_mov_b32 v118, 0
    v_mov_b32 v119, 0
    v_mov_b32 v120, 0
    v_mov_b32 v121, 0
    v_mov_b32 v122, 0
    v_mov_b32 v123, 0
    v_mov_b32 v124, 0
    v_mov_b32 v125, 0
    v_mov_b32 v126, 0
    v_mov_b32 v127, 0
    buffer_load_dwordx4 v[128:131], v8, s[8:11], s34 offen
    buffer_load_dwordx4 v[132:135], v9, s[8:11], s34 offen
    buffer_load_dwordx4 v[136:139], v10, s[8:11], s34 offen
    buffer_load_dwordx4 v[140:143], v11, s[8:11], s34 offen
    buffer_load_dwordx4 v[144:147], v12, s[12:15], s35 offen
    buffer_load_dwordx4 v[148:151], v13, s[12:15], s35 offen
    buffer_load_dwordx4 v[152:155], v14, s[12:15], s35 offen
    buffer_load_dwordx4 v[156:159], v15, s[12:15], s35 offen
    s_add_u32 s34, s34, 128
    s_add_u32 s35, s35, 524288
    s_waitcnt vmcnt(0)
    ds_write_b128 v3, v[128:131] offset:0
    ds_write_b128 v3, v[132:135] offset:4608
    ds_write_b128 v3, v[136:139] offset:9216
    ds_write_b128 v3, v[140:143] offset:13824
    ds_write_b128 v4, v[144:147] offset:0
    ds_write_b128 v4, v[148:151] offset:4352
    ds_write_b128 v4, v[152:155] offset:8704
    ds_write_b128 v4, v[156:159] offset:13056
    s_waitcnt lgkmcnt(0)
    s_barrier
    s_mov_b32 s5, 0
.glqk_38:
    buffer_load_dwordx4 v[128:131], v8, s[8:11], s34 offen
    buffer_load_dwordx4 v[132:135], v9, s[8:11], s34 offen
    buffer_load_dwordx4 v[136:139], v10, s[8:11], s34 offen
    buffer_load_dwordx4 v[140:143], v11, s[8:11], s34 offen
    buffer_load_dwordx4 v[144:147], v12, s[12:15], s35 offen
    buffer_load_dwordx4 v[148:151], v13, s[12:15], s35 offen
    buffer_load_dwordx4 v[152:155], v14, s[12:15], s35 offen
    buffer_load_dwordx4 v[156:159], v15, s[12:15], s35 offen
    s_add_u32 s34, s34, 128
    s_add_u32 s35, s35, 524288
    ds_read_b128 v[16:19], v5 offset:0
    ds_read_b128 v[20:23], v5 offset:576
    ds_read_b128 v[24:27], v5 offset:4608
    ds_read_b128 v[28:31], v5 offset:5184
    ds_read_b64_tr_b16 v[32:33], v6 offset:0
    ds_read_b64_tr_b16 v[34:35], v6 offset:1088
    ds_read_b64_tr_b16 v[36:37], v6 offset:8
    ds_read_b64_tr_b16 v[38:39], v6 offset:1096
    ds_read_b64_tr_b16 v[40:41], v6 offset:64
    ds_read_b64_tr_b16 v[42:43], v6 offset:1152
    ds_read_b64_tr_b16 v[44:45], v6 offset:72
    ds_read_b64_tr_b16 v[46:47], v6 offset:1160
    ds_read_b128 v[48:51], v5 offset:64
    ds_read_b128 v[52:55], v5 offset:640
    ds_read_b128 v[56:59], v5 offset:4672
    ds_read_b128 v[60:63], v5 offset:5248
    ds_read_b64_tr_b16 v[160:161], v6 offset:8704
    ds_read_b64_tr_b16 v[162:163], v6 offset:9792
    ds_read_b64_tr_b16 v[164:165], v6 offset:8712
    ds_read_b64_tr_b16 v[166:167], v6 offset:9800
    ds_read_b64_tr_b16 v[168:169], v6 offset:8768
    ds_read_b64_tr_b16 v[170:171], v6 offset:9856
    ds_read_b64_tr_b16 v[172:173], v6 offset:8776
    ds_read_b64_tr_b16 v[174:175], v6 offset:9864
    s_waitcnt lgkmcnt(12)
    v_mfma_f32_16x16x32_bf16 v[64:67], v[32:35], v[16:19], v[64:67]
    v_mfma_f32_16x16x32_bf16 v[68:71], v[32:35], v[20:23], v[68:71]
    v_mfma_f32_16x16x32_bf16 v[72:75], v[32:35], v[24:27], v[72:75]
    v_mfma_f32_16x16x32_bf16 v[76:79], v[32:35], v[28:31], v[76:79]
    v_mfma_f32_16x16x32_bf16 v[80:83], v[36:39], v[16:19], v[80:83]
    v_mfma_f32_16x16x32_bf16 v[84:87], v[36:39], v[20:23], v[84:87]
    v_mfma_f32_16x16x32_bf16 v[88:91], v[36:39], v[24:27], v[88:91]
    v_mfma_f32_16x16x32_bf16 v[92:95], v[36:39], v[28:31], v[92:95]
    v_mfma_f32_16x16x32_bf16 v[96:99], v[40:43], v[16:19], v[96:99]
    v_mfma_f32_16x16x32_bf16 v[100:103], v[40:43], v[20:23], v[100:103]
    v_mfma_f32_16x16x32_bf16 v[104:107], v[40:43], v[24:27], v[104:107]
    v_mfma_f32_16x16x32_bf16 v[108:111], v[40:43], v[28:31], v[108:111]
    v_mfma_f32_16x16x32_bf16 v[112:115], v[44:47], v[16:19], v[112:115]
    v_mfma_f32_16x16x32_bf16 v[116:119], v[44:47], v[20:23], v[116:119]
    v_mfma_f32_16x16x32_bf16 v[120:123], v[44:47], v[24:27], v[120:123]
    v_mfma_f32_16x16x32_bf16 v[124:127], v[44:47], v[28:31], v[124:127]
    s_waitcnt lgkmcnt(0)
    v_mfma_f32_16x16x32_bf16 v[64:67], v[160:163], v[48:51], v[64:67]
    v_mfma_f32_16x16x32_bf16 v[68:71], v[160:163], v[52:55], v[68:71]
    v_mfma_f32_16x16x32_bf16 v[72:75], v[160:163], v[56:59], v[72:75]
    v_mfma_f32_16x16x32_bf16 v[76:79], v[160:163], v[60:63], v[76:79]
    v_mfma_f32_16x16x32_bf16 v[80:83], v[164:167], v[48:51], v[80:83]
    v_mfma_f32_16x16x32_bf16 v[84:87], v[164:167], v[52:55], v[84:87]
    v_mfma_f32_16x16x32_bf16 v[88:91], v[164:167], v[56:59], v[88:91]
    v_mfma_f32_16x16x32_bf16 v[92:95], v[164:167], v[60:63], v[92:95]
    v_mfma_f32_16x16x32_bf16 v[96:99], v[168:171], v[48:51], v[96:99]
    v_mfma_f32_16x16x32_bf16 v[100:103], v[168:171], v[52:55], v[100:103]
    v_mfma_f32_16x16x32_bf16 v[104:107], v[168:171], v[56:59], v[104:107]
    v_mfma_f32_16x16x32_bf16 v[108:111], v[168:171], v[60:63], v[108:111]
    v_mfma_f32_16x16x32_bf16 v[112:115], v[172:175], v[48:51], v[112:115]
    v_mfma_f32_16x16x32_bf16 v[116:119], v[172:175], v[52:55], v[116:119]
    v_mfma_f32_16x16x32_bf16 v[120:123], v[172:175], v[56:59], v[120:123]
    v_mfma_f32_16x16x32_bf16 v[124:127], v[172:175], v[60:63], v[124:127]
    s_waitcnt vmcnt(0)
    ds_write_b128 v3, v[128:131] offset:18432
    ds_write_b128 v3, v[132:135] offset:23040
    ds_write_b128 v3, v[136:139] offset:27648
    ds_write_b128 v3, v[140:143] offset:32256
    ds_write_b128 v4, v[144:147] offset:17408
    ds_write_b128 v4, v[148:151] offset:21760
    ds_write_b128 v4, v[152:155] offset:26112
    ds_write_b128 v4, v[156:159] offset:30464
    s_waitcnt lgkmcnt(0)
    s_barrier
    buffer_load_dwordx4 v[128:131], v8, s[8:11], s34 offen
    buffer_load_dwordx4 v[132:135], v9, s[8:11], s34 offen
    buffer_load_dwordx4 v[136:139], v10, s[8:11], s34 offen
    buffer_load_dwordx4 v[140:143], v11, s[8:11], s34 offen
    buffer_load_dwordx4 v[144:147], v12, s[12:15], s35 offen
    buffer_load_dwordx4 v[148:151], v13, s[12:15], s35 offen
    buffer_load_dwordx4 v[152:155], v14, s[12:15], s35 offen
    buffer_load_dwordx4 v[156:159], v15, s[12:15], s35 offen
    s_add_u32 s34, s34, 128
    s_add_u32 s35, s35, 524288
    ds_read_b128 v[16:19], v5 offset:18432
    ds_read_b128 v[20:23], v5 offset:19008
    ds_read_b128 v[24:27], v5 offset:23040
    ds_read_b128 v[28:31], v5 offset:23616
    ds_read_b64_tr_b16 v[32:33], v6 offset:17408
    ds_read_b64_tr_b16 v[34:35], v6 offset:18496
    ds_read_b64_tr_b16 v[36:37], v6 offset:17416
    ds_read_b64_tr_b16 v[38:39], v6 offset:18504
    ds_read_b64_tr_b16 v[40:41], v6 offset:17472
    ds_read_b64_tr_b16 v[42:43], v6 offset:18560
    ds_read_b64_tr_b16 v[44:45], v6 offset:17480
    ds_read_b64_tr_b16 v[46:47], v6 offset:18568
    ds_read_b128 v[48:51], v5 offset:18496
    ds_read_b128 v[52:55], v5 offset:19072
    ds_read_b128 v[56:59], v5 offset:23104
    ds_read_b128 v[60:63], v5 offset:23680
    ds_read_b64_tr_b16 v[160:161], v6 offset:26112
    ds_read_b64_tr_b16 v[162:163], v6 offset:27200
    ds_read_b64_tr_b16 v[164:165], v6 offset:26120
    ds_read_b64_tr_b16 v[166:167], v6 offset:27208
    ds_read_b64_tr_b16 v[168:169], v6 offset:26176
    ds_read_b64_tr_b16 v[170:171], v6 offset:27264
    ds_read_b64_tr_b16 v[172:173], v6 offset:26184
    ds_read_b64_tr_b16 v[174:175], v6 offset:27272
    s_waitcnt lgkmcnt(12)
    v_mfma_f32_16x16x32_bf16 v[64:67], v[32:35], v[16:19], v[64:67]
    v_mfma_f32_16x16x32_bf16 v[68:71], v[32:35], v[20:23], v[68:71]
    v_mfma_f32_16x16x32_bf16 v[72:75], v[32:35], v[24:27], v[72:75]
    v_mfma_f32_16x16x32_bf16 v[76:79], v[32:35], v[28:31], v[76:79]
    v_mfma_f32_16x16x32_bf16 v[80:83], v[36:39], v[16:19], v[80:83]
    v_mfma_f32_16x16x32_bf16 v[84:87], v[36:39], v[20:23], v[84:87]
    v_mfma_f32_16x16x32_bf16 v[88:91], v[36:39], v[24:27], v[88:91]
    v_mfma_f32_16x16x32_bf16 v[92:95], v[36:39], v[28:31], v[92:95]
    v_mfma_f32_16x16x32_bf16 v[96:99], v[40:43], v[16:19], v[96:99]
    v_mfma_f32_16x16x32_bf16 v[100:103], v[40:43], v[20:23], v[100:103]
    v_mfma_f32_16x16x32_bf16 v[104:107], v[40:43], v[24:27], v[104:107]
    v_mfma_f32_16x16x32_bf16 v[108:111], v[40:43], v[28:31], v[108:111]
    v_mfma_f32_16x16x32_bf16 v[112:115], v[44:47], v[16:19], v[112:115]
    v_mfma_f32_16x16x32_bf16 v[116:119], v[44:47], v[20:23], v[116:119]
    v_mfma_f32_16x16x32_bf16 v[120:123], v[44:47], v[24:27], v[120:123]
    v_mfma_f32_16x16x32_bf16 v[124:127], v[44:47], v[28:31], v[124:127]
    s_waitcnt lgkmcnt(0)
    v_mfma_f32_16x16x32_bf16 v[64:67], v[160:163], v[48:51], v[64:67]
    v_mfma_f32_16x16x32_bf16 v[68:71], v[160:163], v[52:55], v[68:71]
    v_mfma_f32_16x16x32_bf16 v[72:75], v[160:163], v[56:59], v[72:75]
    v_mfma_f32_16x16x32_bf16 v[76:79], v[160:163], v[60:63], v[76:79]
    v_mfma_f32_16x16x32_bf16 v[80:83], v[164:167], v[48:51], v[80:83]
    v_mfma_f32_16x16x32_bf16 v[84:87], v[164:167], v[52:55], v[84:87]
    v_mfma_f32_16x16x32_bf16 v[88:91], v[164:167], v[56:59], v[88:91]
    v_mfma_f32_16x16x32_bf16 v[92:95], v[164:167], v[60:63], v[92:95]
    v_mfma_f32_16x16x32_bf16 v[96:99], v[168:171], v[48:51], v[96:99]
    v_mfma_f32_16x16x32_bf16 v[100:103], v[168:171], v[52:55], v[100:103]
    v_mfma_f32_16x16x32_bf16 v[104:107], v[168:171], v[56:59], v[104:107]
    v_mfma_f32_16x16x32_bf16 v[108:111], v[168:171], v[60:63], v[108:111]
    v_mfma_f32_16x16x32_bf16 v[112:115], v[172:175], v[48:51], v[112:115]
    v_mfma_f32_16x16x32_bf16 v[116:119], v[172:175], v[52:55], v[116:119]
    v_mfma_f32_16x16x32_bf16 v[120:123], v[172:175], v[56:59], v[120:123]
    v_mfma_f32_16x16x32_bf16 v[124:127], v[172:175], v[60:63], v[124:127]
    s_waitcnt vmcnt(0)
    ds_write_b128 v3, v[128:131] offset:0
    ds_write_b128 v3, v[132:135] offset:4608
    ds_write_b128 v3, v[136:139] offset:9216
    ds_write_b128 v3, v[140:143] offset:13824
    ds_write_b128 v4, v[144:147] offset:0
    ds_write_b128 v4, v[148:151] offset:4352
    ds_write_b128 v4, v[152:155] offset:8704
    ds_write_b128 v4, v[156:159] offset:13056
    s_waitcnt lgkmcnt(0)
    s_barrier
    s_add_u32 s5, s5, 2
    s_cmp_lt_u32 s5, 10
    s_cbranch_scc1 .glqk_38
    s_nop 7
    s_nop 7
    v_and_b32 v24, 15, v7
    v_lshrrev_b32 v25, 4, v7
    v_lshrrev_b32 v26, 2, v24
    v_and_b32 v27, 3, v24
    v_lshl_add_u32 v28, v26, 3, v27
    s_lshl_b32 s7, s30, 7
    s_lshr_b32 s36, s6, 1
    s_lshl_b32 s36, s36, 6
    s_add_u32 s7, s7, s36
    v_add_u32 v28, s7, v28
    v_lshlrev_b32 v28, 13, v28
    v_lshl_add_u32 v28, v25, 4, v28
    s_lshl_b32 s7, s33, 8
    s_and_b32 s36, s6, 1
    s_lshl_b32 s36, s36, 7
    s_add_u32 s7, s7, s36
    s_lshl_b32 s36, s32, 24
    s_add_u32 s7, s7, s36
    v_add_u32 v28, s7, v28
    v_add_u32 v29, 0, v28
    v_cvt_pk_bf16_f32 v16, v64, v65
    v_cvt_pk_bf16_f32 v17, v66, v67
    v_cvt_pk_bf16_f32 v18, v80, v81
    v_cvt_pk_bf16_f32 v19, v82, v83
    buffer_store_dwordx4 v[16:19], v29, s[16:19], 0 offen offset:0 sc1
    s_nop 1
    v_cvt_pk_bf16_f32 v16, v96, v97
    v_cvt_pk_bf16_f32 v17, v98, v99
    v_cvt_pk_bf16_f32 v18, v112, v113
    v_cvt_pk_bf16_f32 v19, v114, v115
    buffer_store_dwordx4 v[16:19], v29, s[16:19], 0 offen offset:64 sc1
    s_nop 1
    v_add_u32 v29, 32768, v28
    v_cvt_pk_bf16_f32 v16, v68, v69
    v_cvt_pk_bf16_f32 v17, v70, v71
    v_cvt_pk_bf16_f32 v18, v84, v85
    v_cvt_pk_bf16_f32 v19, v86, v87
    buffer_store_dwordx4 v[16:19], v29, s[16:19], 0 offen offset:0 sc1
    s_nop 1
    v_cvt_pk_bf16_f32 v16, v100, v101
    v_cvt_pk_bf16_f32 v17, v102, v103
    v_cvt_pk_bf16_f32 v18, v116, v117
    v_cvt_pk_bf16_f32 v19, v118, v119
    buffer_store_dwordx4 v[16:19], v29, s[16:19], 0 offen offset:64 sc1
    s_nop 1
    v_add_u32 v29, 262144, v28
    v_cvt_pk_bf16_f32 v16, v72, v73
    v_cvt_pk_bf16_f32 v17, v74, v75
    v_cvt_pk_bf16_f32 v18, v88, v89
    v_cvt_pk_bf16_f32 v19, v90, v91
    buffer_store_dwordx4 v[16:19], v29, s[16:19], 0 offen offset:0 sc1
    s_nop 1
    v_cvt_pk_bf16_f32 v16, v104, v105
    v_cvt_pk_bf16_f32 v17, v106, v107
    v_cvt_pk_bf16_f32 v18, v120, v121
    v_cvt_pk_bf16_f32 v19, v122, v123
    buffer_store_dwordx4 v[16:19], v29, s[16:19], 0 offen offset:64 sc1
    s_nop 1
    v_add_u32 v29, 294912, v28
    v_cvt_pk_bf16_f32 v16, v76, v77
    v_cvt_pk_bf16_f32 v17, v78, v79
    v_cvt_pk_bf16_f32 v18, v92, v93
    v_cvt_pk_bf16_f32 v19, v94, v95
    buffer_store_dwordx4 v[16:19], v29, s[16:19], 0 offen offset:0 sc1
    s_nop 1
    v_cvt_pk_bf16_f32 v16, v108, v109
    v_cvt_pk_bf16_f32 v17, v110, v111
    v_cvt_pk_bf16_f32 v18, v124, v125
    v_cvt_pk_bf16_f32 v19, v126, v127
    buffer_store_dwordx4 v[16:19], v29, s[16:19], 0 offen offset:64 sc1
    s_nop 1
    s_branch .Pend_36
.Pv_35:
    v_mov_b32 v64, 0
    v_mov_b32 v65, 0
    v_mov_b32 v66, 0
    v_mov_b32 v67, 0
    v_mov_b32 v68, 0
    v_mov_b32 v69, 0
    v_mov_b32 v70, 0
    v_mov_b32 v71, 0
    v_mov_b32 v72, 0
    v_mov_b32 v73, 0
    v_mov_b32 v74, 0
    v_mov_b32 v75, 0
    v_mov_b32 v76, 0
    v_mov_b32 v77, 0
    v_mov_b32 v78, 0
    v_mov_b32 v79, 0
    v_mov_b32 v80, 0
    v_mov_b32 v81, 0
    v_mov_b32 v82, 0
    v_mov_b32 v83, 0
    v_mov_b32 v84, 0
    v_mov_b32 v85, 0
    v_mov_b32 v86, 0
    v_mov_b32 v87, 0
    v_mov_b32 v88, 0
    v_mov_b32 v89, 0
    v_mov_b32 v90, 0
    v_mov_b32 v91, 0
    v_mov_b32 v92, 0
    v_mov_b32 v93, 0
    v_mov_b32 v94, 0
    v_mov_b32 v95, 0
    v_mov_b32 v96, 0
    v_mov_b32 v97, 0
    v_mov_b32 v98, 0
    v_mov_b32 v99, 0
    v_mov_b32 v100, 0
    v_mov_b32 v101, 0
    v_mov_b32 v102, 0
    v_mov_b32 v103, 0
    v_mov_b32 v104, 0
    v_mov_b32 v105, 0
    v_mov_b32 v106, 0
    v_mov_b32 v107, 0
    v_mov_b32 v108, 0
    v_mov_b32 v109, 0
    v_mov_b32 v110, 0
    v_mov_b32 v111, 0
    v_mov_b32 v112, 0
    v_mov_b32 v113, 0
    v_mov_b32 v114, 0
    v_mov_b32 v115, 0
    v_mov_b32 v116, 0
    v_mov_b32 v117, 0
    v_mov_b32 v118, 0
    v_mov_b32 v119, 0
    v_mov_b32 v120, 0
    v_mov_b32 v121, 0
    v_mov_b32 v122, 0
    v_mov_b32 v123, 0
    v_mov_b32 v124, 0
    v_mov_b32 v125, 0
    v_mov_b32 v126, 0
    v_mov_b32 v127, 0
    buffer_load_dwordx4 v[128:131], v8, s[8:11], s34 offen
    buffer_load_dwordx4 v[132:135], v9, s[8:11], s34 offen
    buffer_load_dwordx4 v[136:139], v10, s[8:11], s34 offen
    buffer_load_dwordx4 v[140:143], v11, s[8:11], s34 offen
    buffer_load_dwordx4 v[144:147], v12, s[12:15], s35 offen
    buffer_load_dwordx4 v[148:151], v13, s[12:15], s35 offen
    buffer_load_dwordx4 v[152:155], v14, s[12:15], s35 offen
    buffer_load_dwordx4 v[156:159], v15, s[12:15], s35 offen
    s_add_u32 s34, s34, 128
    s_add_u32 s35, s35, 524288
    s_waitcnt vmcnt(0)
    ds_write_b128 v3, v[128:131] offset:0
    ds_write_b128 v3, v[132:135] offset:4608
    ds_write_b128 v3, v[136:139] offset:9216
    ds_write_b128 v3, v[140:143] offset:13824
    ds_write_b128 v4, v[144:147] offset:0
    ds_write_b128 v4, v[148:151] offset:4352
    ds_write_b128 v4, v[152:155] offset:8704
    ds_write_b128 v4, v[156:159] offset:13056
    s_waitcnt lgkmcnt(0)
    s_barrier
    s_mov_b32 s5, 0
.glv_39:
    buffer_load_dwordx4 v[128:131], v8, s[8:11], s34 offen
    buffer_load_dwordx4 v[132:135], v9, s[8:11], s34 offen
    buffer_load_dwordx4 v[136:139], v10, s[8:11], s34 offen
    buffer_load_dwordx4 v[140:143], v11, s[8:11], s34 offen
    buffer_load_dwordx4 v[144:147], v12, s[12:15], s35 offen
    buffer_load_dwordx4 v[148:151], v13, s[12:15], s35 offen
    buffer_load_dwordx4 v[152:155], v14, s[12:15], s35 offen
    buffer_load_dwordx4 v[156:159], v15, s[12:15], s35 offen
    s_add_u32 s34, s34, 128
    s_add_u32 s35, s35, 524288
    ds_read_b128 v[16:19], v5 offset:0
    ds_read_b128 v[20:23], v5 offset:576
    ds_read_b128 v[24:27], v5 offset:4608
    ds_read_b128 v[28:31], v5 offset:5184
    ds_read_b64_tr_b16 v[32:33], v6 offset:0
    ds_read_b64_tr_b16 v[34:35], v6 offset:1088
    ds_read_b64_tr_b16 v[36:37], v6 offset:8
    ds_read_b64_tr_b16 v[38:39], v6 offset:1096
    ds_read_b64_tr_b16 v[40:41], v6 offset:64
    ds_read_b64_tr_b16 v[42:43], v6 offset:1152
    ds_read_b64_tr_b16 v[44:45], v6 offset:72
    ds_read_b64_tr_b16 v[46:47], v6 offset:1160
    ds_read_b128 v[48:51], v5 offset:64
    ds_read_b128 v[52:55], v5 offset:640
    ds_read_b128 v[56:59], v5 offset:4672
    ds_read_b128 v[60:63], v5 offset:5248
    ds_read_b64_tr_b16 v[160:161], v6 offset:8704
    ds_read_b64_tr_b16 v[162:163], v6 offset:9792
    ds_read_b64_tr_b16 v[164:165], v6 offset:8712
    ds_read_b64_tr_b16 v[166:167], v6 offset:9800
    ds_read_b64_tr_b16 v[168:169], v6 offset:8768
    ds_read_b64_tr_b16 v[170:171], v6 offset:9856
    ds_read_b64_tr_b16 v[172:173], v6 offset:8776
    ds_read_b64_tr_b16 v[174:175], v6 offset:9864
    s_waitcnt lgkmcnt(12)
    v_mfma_f32_16x16x32_bf16 v[64:67], v[16:19], v[32:35], v[64:67]
    v_mfma_f32_16x16x32_bf16 v[68:71], v[20:23], v[32:35], v[68:71]
    v_mfma_f32_16x16x32_bf16 v[72:75], v[24:27], v[32:35], v[72:75]
    v_mfma_f32_16x16x32_bf16 v[76:79], v[28:31], v[32:35], v[76:79]
    v_mfma_f32_16x16x32_bf16 v[80:83], v[16:19], v[36:39], v[80:83]
    v_mfma_f32_16x16x32_bf16 v[84:87], v[20:23], v[36:39], v[84:87]
    v_mfma_f32_16x16x32_bf16 v[88:91], v[24:27], v[36:39], v[88:91]
    v_mfma_f32_16x16x32_bf16 v[92:95], v[28:31], v[36:39], v[92:95]
    v_mfma_f32_16x16x32_bf16 v[96:99], v[16:19], v[40:43], v[96:99]
    v_mfma_f32_16x16x32_bf16 v[100:103], v[20:23], v[40:43], v[100:103]
    v_mfma_f32_16x16x32_bf16 v[104:107], v[24:27], v[40:43], v[104:107]
    v_mfma_f32_16x16x32_bf16 v[108:111], v[28:31], v[40:43], v[108:111]
    v_mfma_f32_16x16x32_bf16 v[112:115], v[16:19], v[44:47], v[112:115]
    v_mfma_f32_16x16x32_bf16 v[116:119], v[20:23], v[44:47], v[116:119]
    v_mfma_f32_16x16x32_bf16 v[120:123], v[24:27], v[44:47], v[120:123]
    v_mfma_f32_16x16x32_bf16 v[124:127], v[28:31], v[44:47], v[124:127]
    s_waitcnt lgkmcnt(0)
    v_mfma_f32_16x16x32_bf16 v[64:67], v[48:51], v[160:163], v[64:67]
    v_mfma_f32_16x16x32_bf16 v[68:71], v[52:55], v[160:163], v[68:71]
    v_mfma_f32_16x16x32_bf16 v[72:75], v[56:59], v[160:163], v[72:75]
    v_mfma_f32_16x16x32_bf16 v[76:79], v[60:63], v[160:163], v[76:79]
    v_mfma_f32_16x16x32_bf16 v[80:83], v[48:51], v[164:167], v[80:83]
    v_mfma_f32_16x16x32_bf16 v[84:87], v[52:55], v[164:167], v[84:87]
    v_mfma_f32_16x16x32_bf16 v[88:91], v[56:59], v[164:167], v[88:91]
    v_mfma_f32_16x16x32_bf16 v[92:95], v[60:63], v[164:167], v[92:95]
    v_mfma_f32_16x16x32_bf16 v[96:99], v[48:51], v[168:171], v[96:99]
    v_mfma_f32_16x16x32_bf16 v[100:103], v[52:55], v[168:171], v[100:103]
    v_mfma_f32_16x16x32_bf16 v[104:107], v[56:59], v[168:171], v[104:107]
    v_mfma_f32_16x16x32_bf16 v[108:111], v[60:63], v[168:171], v[108:111]
    v_mfma_f32_16x16x32_bf16 v[112:115], v[48:51], v[172:175], v[112:115]
    v_mfma_f32_16x16x32_bf16 v[116:119], v[52:55], v[172:175], v[116:119]
    v_mfma_f32_16x16x32_bf16 v[120:123], v[56:59], v[172:175], v[120:123]
    v_mfma_f32_16x16x32_bf16 v[124:127], v[60:63], v[172:175], v[124:127]
    s_waitcnt vmcnt(0)
    ds_write_b128 v3, v[128:131] offset:18432
    ds_write_b128 v3, v[132:135] offset:23040
    ds_write_b128 v3, v[136:139] offset:27648
    ds_write_b128 v3, v[140:143] offset:32256
    ds_write_b128 v4, v[144:147] offset:17408
    ds_write_b128 v4, v[148:151] offset:21760
    ds_write_b128 v4, v[152:155] offset:26112
    ds_write_b128 v4, v[156:159] offset:30464
    s_waitcnt lgkmcnt(0)
    s_barrier
    buffer_load_dwordx4 v[128:131], v8, s[8:11], s34 offen
    buffer_load_dwordx4 v[132:135], v9, s[8:11], s34 offen
    buffer_load_dwordx4 v[136:139], v10, s[8:11], s34 offen
    buffer_load_dwordx4 v[140:143], v11, s[8:11], s34 offen
    buffer_load_dwordx4 v[144:147], v12, s[12:15], s35 offen
    buffer_load_dwordx4 v[148:151], v13, s[12:15], s35 offen
    buffer_load_dwordx4 v[152:155], v14, s[12:15], s35 offen
    buffer_load_dwordx4 v[156:159], v15, s[12:15], s35 offen
    s_add_u32 s34, s34, 128
    s_add_u32 s35, s35, 524288
    ds_read_b128 v[16:19], v5 offset:18432
    ds_read_b128 v[20:23], v5 offset:19008
    ds_read_b128 v[24:27], v5 offset:23040
    ds_read_b128 v[28:31], v5 offset:23616
    ds_read_b64_tr_b16 v[32:33], v6 offset:17408
    ds_read_b64_tr_b16 v[34:35], v6 offset:18496
    ds_read_b64_tr_b16 v[36:37], v6 offset:17416
    ds_read_b64_tr_b16 v[38:39], v6 offset:18504
    ds_read_b64_tr_b16 v[40:41], v6 offset:17472
    ds_read_b64_tr_b16 v[42:43], v6 offset:18560
    ds_read_b64_tr_b16 v[44:45], v6 offset:17480
    ds_read_b64_tr_b16 v[46:47], v6 offset:18568
    ds_read_b128 v[48:51], v5 offset:18496
    ds_read_b128 v[52:55], v5 offset:19072
    ds_read_b128 v[56:59], v5 offset:23104
    ds_read_b128 v[60:63], v5 offset:23680
    ds_read_b64_tr_b16 v[160:161], v6 offset:26112
    ds_read_b64_tr_b16 v[162:163], v6 offset:27200
    ds_read_b64_tr_b16 v[164:165], v6 offset:26120
    ds_read_b64_tr_b16 v[166:167], v6 offset:27208
    ds_read_b64_tr_b16 v[168:169], v6 offset:26176
    ds_read_b64_tr_b16 v[170:171], v6 offset:27264
    ds_read_b64_tr_b16 v[172:173], v6 offset:26184
    ds_read_b64_tr_b16 v[174:175], v6 offset:27272
    s_waitcnt lgkmcnt(12)
    v_mfma_f32_16x16x32_bf16 v[64:67], v[16:19], v[32:35], v[64:67]
    v_mfma_f32_16x16x32_bf16 v[68:71], v[20:23], v[32:35], v[68:71]
    v_mfma_f32_16x16x32_bf16 v[72:75], v[24:27], v[32:35], v[72:75]
    v_mfma_f32_16x16x32_bf16 v[76:79], v[28:31], v[32:35], v[76:79]
    v_mfma_f32_16x16x32_bf16 v[80:83], v[16:19], v[36:39], v[80:83]
    v_mfma_f32_16x16x32_bf16 v[84:87], v[20:23], v[36:39], v[84:87]
    v_mfma_f32_16x16x32_bf16 v[88:91], v[24:27], v[36:39], v[88:91]
    v_mfma_f32_16x16x32_bf16 v[92:95], v[28:31], v[36:39], v[92:95]
    v_mfma_f32_16x16x32_bf16 v[96:99], v[16:19], v[40:43], v[96:99]
    v_mfma_f32_16x16x32_bf16 v[100:103], v[20:23], v[40:43], v[100:103]
    v_mfma_f32_16x16x32_bf16 v[104:107], v[24:27], v[40:43], v[104:107]
    v_mfma_f32_16x16x32_bf16 v[108:111], v[28:31], v[40:43], v[108:111]
    v_mfma_f32_16x16x32_bf16 v[112:115], v[16:19], v[44:47], v[112:115]
    v_mfma_f32_16x16x32_bf16 v[116:119], v[20:23], v[44:47], v[116:119]
    v_mfma_f32_16x16x32_bf16 v[120:123], v[24:27], v[44:47], v[120:123]
    v_mfma_f32_16x16x32_bf16 v[124:127], v[28:31], v[44:47], v[124:127]
    s_waitcnt lgkmcnt(0)
    v_mfma_f32_16x16x32_bf16 v[64:67], v[48:51], v[160:163], v[64:67]
    v_mfma_f32_16x16x32_bf16 v[68:71], v[52:55], v[160:163], v[68:71]
    v_mfma_f32_16x16x32_bf16 v[72:75], v[56:59], v[160:163], v[72:75]
    v_mfma_f32_16x16x32_bf16 v[76:79], v[60:63], v[160:163], v[76:79]
    v_mfma_f32_16x16x32_bf16 v[80:83], v[48:51], v[164:167], v[80:83]
    v_mfma_f32_16x16x32_bf16 v[84:87], v[52:55], v[164:167], v[84:87]
    v_mfma_f32_16x16x32_bf16 v[88:91], v[56:59], v[164:167], v[88:91]
    v_mfma_f32_16x16x32_bf16 v[92:95], v[60:63], v[164:167], v[92:95]
    v_mfma_f32_16x16x32_bf16 v[96:99], v[48:51], v[168:171], v[96:99]
    v_mfma_f32_16x16x32_bf16 v[100:103], v[52:55], v[168:171], v[100:103]
    v_mfma_f32_16x16x32_bf16 v[104:107], v[56:59], v[168:171], v[104:107]
    v_mfma_f32_16x16x32_bf16 v[108:111], v[60:63], v[168:171], v[108:111]
    v_mfma_f32_16x16x32_bf16 v[112:115], v[48:51], v[172:175], v[112:115]
    v_mfma_f32_16x16x32_bf16 v[116:119], v[52:55], v[172:175], v[116:119]
    v_mfma_f32_16x16x32_bf16 v[120:123], v[56:59], v[172:175], v[120:123]
    v_mfma_f32_16x16x32_bf16 v[124:127], v[60:63], v[172:175], v[124:127]
    s_waitcnt vmcnt(0)
    ds_write_b128 v3, v[128:131] offset:0
    ds_write_b128 v3, v[132:135] offset:4608
    ds_write_b128 v3, v[136:139] offset:9216
    ds_write_b128 v3, v[140:143] offset:13824
    ds_write_b128 v4, v[144:147] offset:0
    ds_write_b128 v4, v[148:151] offset:4352
    ds_write_b128 v4, v[152:155] offset:8704
    ds_write_b128 v4, v[156:159] offset:13056
    s_waitcnt lgkmcnt(0)
    s_barrier
    s_add_u32 s5, s5, 2
    s_cmp_lt_u32 s5, 10
    s_cbranch_scc1 .glv_39
    s_nop 7
    s_nop 7
    v_and_b32 v24, 15, v7
    v_lshrrev_b32 v25, 4, v7
    v_lshrrev_b32 v26, 2, v24
    v_and_b32 v27, 3, v24
    v_lshl_add_u32 v28, v26, 3, v27
    s_and_b32 s36, s6, 1
    s_lshl_b32 s36, s36, 6
    v_add_u32 v28, s36, v28
    v_lshlrev_b32 v28, 6, v28
    v_lshl_add_u32 v28, v25, 4, v28
    s_lshl_b32 s7, s30, 2
    s_lshr_b32 s36, s6, 1
    s_lshl_b32 s36, s36, 1
    s_add_u32 s7, s7, s36
    s_lshl_b32 s7, s7, 5
    s_add_u32 s7, s7, s33
    s_lshl_b32 s7, s7, 13
    s_add_u32 s7, s7, 33554432
    v_add_u32 v28, s7, v28
    v_add_u32 v29, 0, v28
    v_cvt_pk_bf16_f32 v16, v64, v65
    v_cvt_pk_bf16_f32 v17, v66, v67
    v_cvt_pk_bf16_f32 v18, v68, v69
    v_cvt_pk_bf16_f32 v19, v70, v71
    buffer_store_dwordx4 v[16:19], v29, s[16:19], 0 offen offset:0 sc1
    s_nop 1
    v_cvt_pk_bf16_f32 v16, v80, v81
    v_cvt_pk_bf16_f32 v17, v82, v83
    v_cvt_pk_bf16_f32 v18, v84, v85
    v_cvt_pk_bf16_f32 v19, v86, v87
    buffer_store_dwordx4 v[16:19], v29, s[16:19], 0 offen offset:256 sc1
    s_nop 1
    v_cvt_pk_bf16_f32 v16, v96, v97
    v_cvt_pk_bf16_f32 v17, v98, v99
    v_cvt_pk_bf16_f32 v18, v100, v101
    v_cvt_pk_bf16_f32 v19, v102, v103
    buffer_store_dwordx4 v[16:19], v29, s[16:19], 0 offen offset:2048 sc1
    s_nop 1
    v_cvt_pk_bf16_f32 v16, v112, v113
    v_cvt_pk_bf16_f32 v17, v114, v115
    v_cvt_pk_bf16_f32 v18, v116, v117
    v_cvt_pk_bf16_f32 v19, v118, v119
    buffer_store_dwordx4 v[16:19], v29, s[16:19], 0 offen offset:2304 sc1
    s_nop 1
    v_add_u32 v29, 262144, v28
    v_cvt_pk_bf16_f32 v16, v72, v73
    v_cvt_pk_bf16_f32 v17, v74, v75
    v_cvt_pk_bf16_f32 v18, v76, v77
    v_cvt_pk_bf16_f32 v19, v78, v79
    buffer_store_dwordx4 v[16:19], v29, s[16:19], 0 offen offset:0 sc1
    s_nop 1
    v_cvt_pk_bf16_f32 v16, v88, v89
    v_cvt_pk_bf16_f32 v17, v90, v91
    v_cvt_pk_bf16_f32 v18, v92, v93
    v_cvt_pk_bf16_f32 v19, v94, v95
    buffer_store_dwordx4 v[16:19], v29, s[16:19], 0 offen offset:256 sc1
    s_nop 1
    v_cvt_pk_bf16_f32 v16, v104, v105
    v_cvt_pk_bf16_f32 v17, v106, v107
    v_cvt_pk_bf16_f32 v18, v108, v109
    v_cvt_pk_bf16_f32 v19, v110, v111
    buffer_store_dwordx4 v[16:19], v29, s[16:19], 0 offen offset:2048 sc1
    s_nop 1
    v_cvt_pk_bf16_f32 v16, v120, v121
    v_cvt_pk_bf16_f32 v17, v122, v123
    v_cvt_pk_bf16_f32 v18, v124, v125
    v_cvt_pk_bf16_f32 v19, v126, v127
    buffer_store_dwordx4 v[16:19], v29, s[16:19], 0 offen offset:2304 sc1
    s_nop 1
.Pend_36:
    s_branch .wloop_21
.tF1_26:
    s_cmp_lt_u32 s94, 1792
    s_cbranch_scc0 .tF2_27
    s_sub_u32 s3, s94, 1600
    s_mov_b32 s93, 109053952
    v_and_b32 v1, 63, v0
    v_lshrrev_b32 v2, 6, v0
    s_nop 0
    v_readfirstlane_b32 s6, v2
    v_and_b32 v3, 15, v1
    v_lshrrev_b32 v4, 4, v1
    s_mul_i32 s30, s3, 43691
    s_lshr_b32 s30, s30, 18
    s_mul_i32 s31, s30, 6
    s_sub_u32 s31, s3, s31
    v_add_u32 v10, 0, v0
    v_cvt_f32_u32 v11, v10
    v_mul_f32 v11, 0x3acccccd, v11
    v_cos_f32 v11, v11
    v_lshlrev_b32 v10, 2, v10
    v_cmp_gt_u32 vcc, 2560, v10
    s_and_saveexec_b64 s[84:85], vcc
    ds_write_b32 v10, v11 offset:0
    s_mov_b64 exec, s[84:85]
    v_add_u32 v10, 256, v0
    v_cvt_f32_u32 v11, v10
    v_mul_f32 v11, 0x3acccccd, v11
    v_cos_f32 v11, v11
    v_lshlrev_b32 v10, 2, v10
    v_cmp_gt_u32 vcc, 2560, v10
    s_and_saveexec_b64 s[84:85], vcc
    ds_write_b32 v10, v11 offset:0
    s_mov_b64 exec, s[84:85]
    v_add_u32 v10, 512, v0
    v_cvt_f32_u32 v11, v10
    v_mul_f32 v11, 0x3acccccd, v11
    v_cos_f32 v11, v11
    v_lshlrev_b32 v10, 2, v10
    v_cmp_gt_u32 vcc, 2560, v10
    s_and_saveexec_b64 s[84:85], vcc
    ds_write_b32 v10, v11 offset:0
    s_mov_b64 exec, s[84:85]
    s_lshl_b32 s7, s30, 6
    s_lshl_b32 s32, s6, 4
    s_add_u32 s7, s7, s32
    s_mul_i32 s7, s7, 1280
    v_lshlrev_b32 v10, 4, v1
    v_add_u32 v10, s7, v10
    v_lshlrev_b32 v11, 2, v1
    v_add_u32 v11, s7, v11
    v_add_u32 v11, 1024, v11
    s_mul_i32 s7, s32, 1296
    s_add_u32 s7, s7, 2560
    v_lshlrev_b32 v12, 4, v1
    v_add_u32 v12, s7, v12
    v_lshlrev_b32 v13, 2, v1
    v_add_u32 v13, s7, v13
    v_add_u32 v13, 1024, v13
    s_mov_b32 s33, 0
    buffer_load_dwordx4 v[64:67], v10, s[8:11], s33 offen
    buffer_load_dword v96, v11, s[8:11], s33 offen
    s_mov_b32 s33, 1280
    buffer_load_dwordx4 v[68:71], v10, s[8:11], s33 offen
    buffer_load_dword v97, v11, s[8:11], s33 offen
    s_mov_b32 s33, 2560
    buffer_load_dwordx4 v[72:75], v10, s[8:11], s33 offen
    buffer_load_dword v98, v11, s[8:11], s33 offen
    s_mov_b32 s33, 3840
    buffer_load_dwordx4 v[76:79], v10, s[8:11], s33 offen
    buffer_load_dword v99, v11, s[8:11], s33 offen
    s_mov_b32 s33, 5120
    buffer_load_dwordx4 v[80:83], v10, s[8:11], s33 offen
    buffer_load_dword v100, v11, s[8:11], s33 offen
    s_mov_b32 s33, 6400
    buffer_load_dwordx4 v[84:87], v10, s[8:11], s33 offen
    buffer_load_dword v101, v11, s[8:11], s33 offen
    s_mov_b32 s33, 7680
    buffer_load_dwordx4 v[88:91], v10, s[8:11], s33 offen
    buffer_load_dword v102, v11, s[8:11], s33 offen
    s_mov_b32 s33, 8960
    buffer_load_dwordx4 v[92:95], v10, s[8:11], s33 offen
    buffer_load_dword v103, v11, s[8:11], s33 offen
    s_waitcnt vmcnt(0)
    ds_write_b128 v12, v[64:67] offset:0
    ds_write_b32 v13, v96 offset:0
    ds_write_b128 v12, v[68:71] offset:1296
    ds_write_b32 v13, v97 offset:1296
    ds_write_b128 v12, v[72:75] offset:2592
    ds_write_b32 v13, v98 offset:2592
    ds_write_b128 v12, v[76:79] offset:3888
    ds_write_b32 v13, v99 offset:3888
    ds_write_b128 v12, v[80:83] offset:5184
    ds_write_b32 v13, v100 offset:5184
    ds_write_b128 v12, v[84:87] offset:6480
    ds_write_b32 v13, v101 offset:6480
    ds_write_b128 v12, v[88:91] offset:7776
    ds_write_b32 v13, v102 offset:7776
    ds_write_b128 v12, v[92:95] offset:9072
    ds_write_b32 v13, v103 offset:9072
    s_mov_b32 s33, 10240
    buffer_load_dwordx4 v[64:67], v10, s[8:11], s33 offen
    buffer_load_dword v96, v11, s[8:11], s33 offen
    s_mov_b32 s33, 11520
    buffer_load_dwordx4 v[68:71], v10, s[8:11], s33 offen
    buffer_load_dword v97, v11, s[8:11], s33 offen
    s_mov_b32 s33, 12800
    buffer_load_dwordx4 v[72:75], v10, s[8:11], s33 offen
    buffer_load_dword v98, v11, s[8:11], s33 offen
    s_mov_b32 s33, 14080
    buffer_load_dwordx4 v[76:79], v10, s[8:11], s33 offen
    buffer_load_dword v99, v11, s[8:11], s33 offen
    s_mov_b32 s33, 15360
    buffer_load_dwordx4 v[80:83], v10, s[8:11], s33 offen
    buffer_load_dword v100, v11, s[8:11], s33 offen
    s_mov_b32 s33, 16640
    buffer_load_dwordx4 v[84:87], v10, s[8:11], s33 offen
    buffer_load_dword v101, v11, s[8:11], s33 offen
    s_mov_b32 s33, 17920
    buffer_load_dwordx4 v[88:91], v10, s[8:11], s33 offen
    buffer_load_dword v102, v11, s[8:11], s33 offen
    s_mov_b32 s33, 19200
    buffer_load_dwordx4 v[92:95], v10, s[8:11], s33 offen
    buffer_load_dword v103, v11, s[8:11], s33 offen
    s_waitcnt vmcnt(0)
    ds_write_b128 v12, v[64:67] offset:10368
    ds_write_b32 v13, v96 offset:10368
    ds_write_b128 v12, v[68:71] offset:11664
    ds_write_b32 v13, v97 offset:11664
    ds_write_b128 v12, v[72:75] offset:12960
    ds_write_b32 v13, v98 offset:12960
    ds_write_b128 v12, v[76:79] offset:14256
    ds_write_b32 v13, v99 offset:14256
    ds_write_b128 v12, v[80:83] offset:15552
    ds_write_b32 v13, v100 offset:15552
    ds_write_b128 v12, v[84:87] offset:16848
    ds_write_b32 v13, v101 offset:16848
    ds_write_b128 v12, v[88:91] offset:18144
    ds_write_b32 v13, v102 offset:18144
    ds_write_b128 v12, v[92:95] offset:19440
    ds_write_b32 v13, v103 offset:19440
    v_lshrrev_b32 v5, 1, v3
    v_and_b32 v6, 1, v3
    s_mul_i32 s7, s31, 56
    v_add_u32 v5, s7, v5
    v_mul_u32_u24 v6, 640, v6
    v_add_u32 v7, 0, v5
    v_mul_u32_u24 v8, v7, v4
    v_lshl_add_u32 v16, v8, 2, v6
    v_lshlrev_b32 v24, 4, v7
    v_subrev_u32 v9, 2560, v16
    v_min_u32 v16, v16, v9
    v_subrev_u32 v9, 2560, v16
    v_min_u32 v16, v16, v9
    v_subrev_u32 v9, 2560, v24
    v_min_u32 v24, v24, v9
    v_subrev_u32 v9, 2560, v24
    v_min_u32 v24, v24, v9
    v_add_u32 v7, 8, v5
    v_mul_u32_u24 v8, v7, v4
    v_lshl_add_u32 v17, v8, 2, v6
    v_lshlrev_b32 v25, 4, v7
    v_subrev_u32 v9, 2560, v17
    v_min_u32 v17, v17, v9
    v_subrev_u32 v9, 2560, v17
    v_min_u32 v17, v17, v9
    v_subrev_u32 v9, 2560, v25
    v_min_u32 v25, v25, v9
    v_subrev_u32 v9, 2560, v25
    v_min_u32 v25, v25, v9
    v_add_u32 v7, 16, v5
    v_mul_u32_u24 v8, v7, v4
    v_lshl_add_u32 v18, v8, 2, v6
    v_lshlrev_b32 v26, 4, v7
    v_subrev_u32 v9, 2560, v18
    v_min_u32 v18, v18, v9
    v_subrev_u32 v9, 2560, v18
    v_min_u32 v18, v18, v9
    v_subrev_u32 v9, 2560, v26
    v_min_u32 v26, v26, v9
    v_subrev_u32 v9, 2560, v26
    v_min_u32 v26, v26, v9
    v_add_u32 v7, 24, v5
    v_mul_u32_u24 v8, v7, v4
    v_lshl_add_u32 v19, v8, 2, v6
    v_lshlrev_b32 v27, 4, v7
    v_subrev_u32 v9, 2560, v19
    v_min_u32 v19, v19, v9
    v_subrev_u32 v9, 2560, v19
    v_min_u32 v19, v19, v9
    v_subrev_u32 v9, 2560, v27
    v_min_u32 v27, v27, v9
    v_subrev_u32 v9, 2560, v27
    v_min_u32 v27, v27, v9
    v_add_u32 v7, 32, v5
    v_mul_u32_u24 v8, v7, v4
    v_lshl_add_u32 v20, v8, 2, v6
    v_lshlrev_b32 v28, 4, v7
    v_subrev_u32 v9, 2560, v20
    v_min_u32 v20, v20, v9
    v_subrev_u32 v9, 2560, v20
    v_min_u32 v20, v20, v9
    v_subrev_u32 v9, 2560, v28
    v_min_u32 v28, v28, v9
    v_subrev_u32 v9, 2560, v28
    v_min_u32 v28, v28, v9
    v_add_u32 v7, 40, v5
    v_mul_u32_u24 v8, v7, v4
    v_lshl_add_u32 v21, v8, 2, v6
    v_lshlrev_b32 v29, 4, v7
    v_subrev_u32 v9, 2560, v21
    v_min_u32 v21, v21, v9
    v_subrev_u32 v9, 2560, v21
    v_min_u32 v21, v21, v9
    v_subrev_u32 v9, 2560, v29
    v_min_u32 v29, v29, v9
    v_subrev_u32 v9, 2560, v29
    v_min_u32 v29, v29, v9
    v_add_u32 v7, 48, v5
    v_mul_u32_u24 v8, v7, v4
    v_lshl_add_u32 v22, v8, 2, v6
    v_lshlrev_b32 v30, 4, v7
    v_subrev_u32 v9, 2560, v22
    v_min_u32 v22, v22, v9
    v_subrev_u32 v9, 2560, v22
    v_min_u32 v22, v22, v9
    v_subrev_u32 v9, 2560, v30
    v_min_u32 v30, v30, v9
    v_subrev_u32 v9, 2560, v30
    v_min_u32 v30, v30, v9
    s_mul_i32 s7, s32, 1296
    s_add_u32 s7, s7, 2560
    v_mul_u32_u24 v14, 1296, v3
    v_lshl_add_u32 v14, v4, 1, v14
    v_add_u32 v14, s7, v14
    v_mov_b32 v46, 0
    v_mov_b32 v47, 0
    v_mov_b32 v64, 0
    v_mov_b32 v65, 0
    v_mov_b32 v66, 0
    v_mov_b32 v67, 0
    v_mov_b32 v68, 0
    v_mov_b32 v69, 0
    v_mov_b32 v70, 0
    v_mov_b32 v71, 0
    v_mov_b32 v72, 0
    v_mov_b32 v73, 0
    v_mov_b32 v74, 0
    v_mov_b32 v75, 0
    v_mov_b32 v76, 0
    v_mov_b32 v77, 0
    v_mov_b32 v78, 0
    v_mov_b32 v79, 0
    v_mov_b32 v80, 0
    v_mov_b32 v81, 0
    v_mov_b32 v82, 0
    v_mov_b32 v83, 0
    v_mov_b32 v84, 0
    v_mov_b32 v85, 0
    v_mov_b32 v86, 0
    v_mov_b32 v87, 0
    v_mov_b32 v88, 0
    v_mov_b32 v89, 0
    v_mov_b32 v90, 0
    v_mov_b32 v91, 0
    s_waitcnt lgkmcnt(0)
    s_barrier
    ds_read_b32 v32, v16 offset:0
    ds_read_b32 v33, v17 offset:0
    ds_read_b32 v34, v18 offset:0
    ds_read_b32 v35, v19 offset:0
    ds_read_b32 v36, v20 offset:0
    ds_read_b32 v37, v21 offset:0
    ds_read_b32 v38, v22 offset:0
    ds_read_u16_d16_hi v46, v14 offset:0
    v_add_u32 v16, v16, v24
    v_subrev_u32 v9, 2560, v16
    v_min_u32 v16, v16, v9
    v_add_u32 v17, v17, v25
    v_subrev_u32 v9, 2560, v17
    v_min_u32 v17, v17, v9
    v_add_u32 v18, v18, v26
    v_subrev_u32 v9, 2560, v18
    v_min_u32 v18, v18, v9
    v_add_u32 v19, v19, v27
    v_subrev_u32 v9, 2560, v19
    v_min_u32 v19, v19, v9
    v_add_u32 v20, v20, v28
    v_subrev_u32 v9, 2560, v20
    v_min_u32 v20, v20, v9
    v_add_u32 v21, v21, v29
    v_subrev_u32 v9, 2560, v21
    v_min_u32 v21, v21, v9
    v_add_u32 v22, v22, v30
    v_subrev_u32 v9, 2560, v22
    v_min_u32 v22, v22, v9
    s_mov_b32 s33, 0
.f1l_40:
    ds_read_b32 v39, v16 offset:0
    ds_read_b32 v40, v17 offset:0
    ds_read_b32 v41, v18 offset:0
    ds_read_b32 v42, v19 offset:0
    ds_read_b32 v43, v20 offset:0
    ds_read_b32 v44, v21 offset:0
    ds_read_b32 v45, v22 offset:0
    ds_read_u16_d16_hi v47, v14 offset:8
    v_add_u32 v16, v16, v24
    v_subrev_u32 v9, 2560, v16
    v_min_u32 v16, v16, v9
    v_add_u32 v17, v17, v25
    v_subrev_u32 v9, 2560, v17
    v_min_u32 v17, v17, v9
    v_add_u32 v18, v18, v26
    v_subrev_u32 v9, 2560, v18
    v_min_u32 v18, v18, v9
    v_add_u32 v19, v19, v27
    v_subrev_u32 v9, 2560, v19
    v_min_u32 v19, v19, v9
    v_add_u32 v20, v20, v28
    v_subrev_u32 v9, 2560, v20
    v_min_u32 v20, v20, v9
    v_add_u32 v21, v21, v29
    v_subrev_u32 v9, 2560, v21
    v_min_u32 v21, v21, v9
    v_add_u32 v22, v22, v30
    v_subrev_u32 v9, 2560, v22
    v_min_u32 v22, v22, v9
    s_waitcnt lgkmcnt(8)
    v_mfma_f32_16x16x4_f32 v[64:67], v32, v46, v[64:67]
    v_mfma_f32_16x16x4_f32 v[68:71], v33, v46, v[68:71]
    v_mfma_f32_16x16x4_f32 v[72:75], v34, v46, v[72:75]
    v_mfma_f32_16x16x4_f32 v[76:79], v35, v46, v[76:79]
    v_mfma_f32_16x16x4_f32 v[80:83], v36, v46, v[80:83]
    v_mfma_f32_16x16x4_f32 v[84:87], v37, v46, v[84:87]
    v_mfma_f32_16x16x4_f32 v[88:91], v38, v46, v[88:91]
    ds_read_b32 v32, v16 offset:0
    ds_read_b32 v33, v17 offset:0
    ds_read_b32 v34, v18 offset:0
    ds_read_b32 v35, v19 offset:0
    ds_read_b32 v36, v20 offset:0
    ds_read_b32 v37, v21 offset:0
    ds_read_b32 v38, v22 offset:0
    ds_read_u16_d16_hi v46, v14 offset:16
    v_add_u32 v16, v16, v24
    v_subrev_u32 v9, 2560, v16
    v_min_u32 v16, v16, v9
    v_add_u32 v17, v17, v25
    v_subrev_u32 v9, 2560, v17
    v_min_u32 v17, v17, v9
    v_add_u32 v18, v18, v26
    v_subrev_u32 v9, 2560, v18
    v_min_u32 v18, v18, v9
    v_add_u32 v19, v19, v27
    v_subrev_u32 v9, 2560, v19
    v_min_u32 v19, v19, v9
    v_add_u32 v20, v20, v28
    v_subrev_u32 v9, 2560, v20
    v_min_u32 v20, v20, v9
    v_add_u32 v21, v21, v29
    v_subrev_u32 v9, 2560, v21
    v_min_u32 v21, v21, v9
    v_add_u32 v22, v22, v30
    v_subrev_u32 v9, 2560, v22
    v_min_u32 v22, v22, v9
    s_waitcnt lgkmcnt(8)
    v_mfma_f32_16x16x4_f32 v[64:67], v39, v47, v[64:67]
    v_mfma_f32_16x16x4_f32 v[68:71], v40, v47, v[68:71]
    v_mfma_f32_16x16x4_f32 v[72:75], v41, v47, v[72:75]
    v_mfma_f32_16x16x4_f32 v[76:79], v42, v47, v[76:79]
    v_mfma_f32_16x16x4_f32 v[80:83], v43, v47, v[80:83]
    v_mfma_f32_16x16x4_f32 v[84:87], v44, v47, v[84:87]
    v_mfma_f32_16x16x4_f32 v[88:91], v45, v47, v[88:91]
    ds_read_b32 v39, v16 offset:0
    ds_read_b32 v40, v17 offset:0
    ds_read_b32 v41, v18 offset:0
    ds_read_b32 v42, v19 offset:0
    ds_read_b32 v43, v20 offset:0
    ds_read_b32 v44, v21 offset:0
    ds_read_b32 v45, v22 offset:0
    ds_read_u16_d16_hi v47, v14 offset:24
    v_add_u32 v16, v16, v24
    v_subrev_u32 v9, 2560, v16
    v_min_u32 v16, v16, v9
    v_add_u32 v17, v17, v25
    v_subrev_u32 v9, 2560, v17
    v_min_u32 v17, v17, v9
    v_add_u32 v18, v18, v26
    v_subrev_u32 v9, 2560, v18
    v_min_u32 v18, v18, v9
    v_add_u32 v19, v19, v27
    v_subrev_u32 v9, 2560, v19
    v_min_u32 v19, v19, v9
    v_add_u32 v20, v20, v28
    v_subrev_u32 v9, 2560, v20
    v_min_u32 v20, v20, v9
    v_add_u32 v21, v21, v29
    v_subrev_u32 v9, 2560, v21
    v_min_u32 v21, v21, v9
    v_add_u32 v22, v22, v30
    v_subrev_u32 v9, 2560, v22
    v_min_u32 v22, v22, v9
    s_waitcnt lgkmcnt(8)
    v_mfma_f32_16x16x4_f32 v[64:67], v32, v46, v[64:67]
    v_mfma_f32_16x16x4_f32 v[68:71], v33, v46, v[68:71]
    v_mfma_f32_16x16x4_f32 v[72:75], v34, v46, v[72:75]
    v_mfma_f32_16x16x4_f32 v[76:79], v35, v46, v[76:79]
    v_mfma_f32_16x16x4_f32 v[80:83], v36, v46, v[80:83]
    v_mfma_f32_16x16x4_f32 v[84:87], v37, v46, v[84:87]
    v_mfma_f32_16x16x4_f32 v[88:91], v38, v46, v[88:91]
    ds_read_b32 v32, v16 offset:0
    ds_read_b32 v33, v17 offset:0
    ds_read_b32 v34, v18 offset:0
    ds_read_b32 v35, v19 offset:0
    ds_read_b32 v36, v20 offset:0
    ds_read_b32 v37, v21 offset:0
    ds_read_b32 v38, v22 offset:0
    ds_read_u16_d16_hi v46, v14 offset:32
    v_add_u32 v16, v16, v24
    v_subrev_u32 v9, 2560, v16
    v_min_u32 v16, v16, v9
    v_add_u32 v17, v17, v25
    v_subrev_u32 v9, 2560, v17
    v_min_u32 v17, v17, v9
    v_add_u32 v18, v18, v26
    v_subrev_u32 v9, 2560, v18
    v_min_u32 v18, v18, v9
    v_add_u32 v19, v19, v27
    v_subrev_u32 v9, 2560, v19
    v_min_u32 v19, v19, v9
    v_add_u32 v20, v20, v28
    v_subrev_u32 v9, 2560, v20
    v_min_u32 v20, v20, v9
    v_add_u32 v21, v21, v29
    v_subrev_u32 v9, 2560, v21
    v_min_u32 v21, v21, v9
    v_add_u32 v22, v22, v30
    v_subrev_u32 v9, 2560, v22
    v_min_u32 v22, v22, v9
    s_waitcnt lgkmcnt(8)
    v_mfma_f32_16x16x4_f32 v[64:67], v39, v47, v[64:67]
    v_mfma_f32_16x16x4_f32 v[68:71], v40, v47, v[68:71]
    v_mfma_f32_16x16x4_f32 v[72:75], v41, v47, v[72:75]
    v_mfma_f32_16x16x4_f32 v[76:79], v42, v47, v[76:79]
    v_mfma_f32_16x16x4_f32 v[80:83], v43, v47, v[80:83]
    v_mfma_f32_16x16x4_f32 v[84:87], v44, v47, v[84:87]
    v_mfma_f32_16x16x4_f32 v[88:91], v45, v47, v[88:91]
    v_add_u32 v14, 32, v14
    s_add_u32 s33, s33, 1
    s_cmp_lt_u32 s33, 40
    s_cbranch_scc1 .f1l_40
    s_waitcnt lgkmcnt(0)
    s_nop 7
    s_nop 3
    s_mul_i32 s7, s31, 56
    v_lshl_add_u32 v5, v4, 1, s7
    s_lshl_b32 s7, s30, 6
    s_add_u32 s7, s7, s32
    s_lshl_b32 s7, s7, 3
    s_add_u32 s7, s7, 75497472
    v_lshlrev_b32 v6, 3, v3
    v_add_u32 v6, s7, v6
    v_mov_b32 v9, 0x7ff00000
    v_add_u32 v7, 0, v5
    v_lshl_add_u32 v8, v7, 14, v6
    v_cmp_lt_u32 vcc, 320, v7
    s_nop 1
    v_cndmask_b32 v8, v8, v9, vcc
    buffer_store_dwordx2 v[64:65], v8, s[16:19], 0 offen sc1
    v_add_u32 v7, 1, v5
    v_lshl_add_u32 v8, v7, 14, v6
    v_cmp_lt_u32 vcc, 320, v7
    s_nop 1
    v_cndmask_b32 v8, v8, v9, vcc
    buffer_store_dwordx2 v[66:67], v8, s[16:19], 0 offen sc1
    v_add_u32 v7, 8, v5
    v_lshl_add_u32 v8, v7, 14, v6
    v_cmp_lt_u32 vcc, 320, v7
    s_nop 1
    v_cndmask_b32 v8, v8, v9, vcc
    buffer_store_dwordx2 v[68:69], v8, s[16:19], 0 offen sc1
    v_add_u32 v7, 9, v5
    v_lshl_add_u32 v8, v7, 14, v6
    v_cmp_lt_u32 vcc, 320, v7
    s_nop 1
    v_cndmask_b32 v8, v8, v9, vcc
    buffer_store_dwordx2 v[70:71], v8, s[16:19], 0 offen sc1
    v_add_u32 v7, 16, v5
    v_lshl_add_u32 v8, v7, 14, v6
    v_cmp_lt_u32 vcc, 320, v7
    s_nop 1
    v_cndmask_b32 v8, v8, v9, vcc
    buffer_store_dwordx2 v[72:73], v8, s[16:19], 0 offen sc1
    v_add_u32 v7, 17, v5
    v_lshl_add_u32 v8, v7, 14, v6
    v_cmp_lt_u32 vcc, 320, v7
    s_nop 1
    v_cndmask_b32 v8, v8, v9, vcc
    buffer_store_dwordx2 v[74:75], v8, s[16:19], 0 offen sc1
    v_add_u32 v7, 24, v5
    v_lshl_add_u32 v8, v7, 14, v6
    v_cmp_lt_u32 vcc, 320, v7
    s_nop 1
    v_cndmask_b32 v8, v8, v9, vcc
    buffer_store_dwordx2 v[76:77], v8, s[16:19], 0 offen sc1
    v_add_u32 v7, 25, v5
    v_lshl_add_u32 v8, v7, 14, v6
    v_cmp_lt_u32 vcc, 320, v7
    s_nop 1
    v_cndmask_b32 v8, v8, v9, vcc
    buffer_store_dwordx2 v[78:79], v8, s[16:19], 0 offen sc1
    v_add_u32 v7, 32, v5
    v_lshl_add_u32 v8, v7, 14, v6
    v_cmp_lt_u32 vcc, 320, v7
    s_nop 1
    v_cndmask_b32 v8, v8, v9, vcc
    buffer_store_dwordx2 v[80:81], v8, s[16:19], 0 offen sc1
    v_add_u32 v7, 33, v5
    v_lshl_add_u32 v8, v7, 14, v6
    v_cmp_lt_u32 vcc, 320, v7
    s_nop 1
    v_cndmask_b32 v8, v8, v9, vcc
    buffer_store_dwordx2 v[82:83], v8, s[16:19], 0 offen sc1
    v_add_u32 v7, 40, v5
    v_lshl_add_u32 v8, v7, 14, v6
    v_cmp_lt_u32 vcc, 320, v7
    s_nop 1
    v_cndmask_b32 v8, v8, v9, vcc
    buffer_store_dwordx2 v[84:85], v8, s[16:19], 0 offen sc1
    v_add_u32 v7, 41, v5
    v_lshl_add_u32 v8, v7, 14, v6
    v_cmp_lt_u32 vcc, 320, v7
    s_nop 1
    v_cndmask_b32 v8, v8, v9, vcc
    buffer_store_dwordx2 v[86:87], v8, s[16:19], 0 offen sc1
    v_add_u32 v7, 48, v5
    v_lshl_add_u32 v8, v7, 14, v6
    v_cmp_lt_u32 vcc, 320, v7
    s_nop 1
    v_cndmask_b32 v8, v8, v9, vcc
    buffer_store_dwordx2 v[88:89], v8, s[16:19], 0 offen sc1
    v_add_u32 v7, 49, v5
    v_lshl_add_u32 v8, v7, 14, v6
    v_cmp_lt_u32 vcc, 320, v7
    s_nop 1
    v_cndmask_b32 v8, v8, v9, vcc
    buffer_store_dwordx2 v[90:91], v8, s[16:19], 0 offen sc1
    s_branch .wloop_21
.tF2_27:
    s_cmp_lt_u32 s94, 2113
    s_cbranch_scc0 .tF3_28
    s_sub_u32 s3, s94, 1792
    s_mov_b32 s93, 109054016
    s_cmp_lg_u32 s39, 0
    s_cbranch_scc1 .wsk_41
    s_mov_b32 s100, 109053952
    v_mov_b32 v250, s100
    s_mov_b32 s101, 0
.ww_42:
    buffer_load_dword v251, v250, s[16:19], 0 offen sc1
    s_waitcnt vmcnt(0)
    v_readfirstlane_b32 s100, v251
    s_cmp_ge_u32 s100, 192
    s_cbranch_scc1 .wok_43
    s_add_u32 s101, s101, 1
    s_cmp_gt_u32 s101, 200000
    s_cbranch_scc1 .fexit_3
    s_sleep 40
    s_branch .ww_42
.wok_43:
.wsk_41:
    s_barrier
    s_mov_b32 s24, s42
    s_and_b32 s25, s43, 0xffff
    s_mov_b32 s26, 1314816
    s_mov_b32 s27, 0x00020000
    s_mov_b32 s28, s44
    s_and_b32 s29, s45, 0xffff
    s_mov_b32 s30, 1314816
    s_mov_b32 s31, 0x00020000
    v_and_b32 v1, 63, v0
    v_lshrrev_b32 v2, 6, v0
    s_nop 0
    v_readfirstlane_b32 s6, v2
    v_and_b32 v3, 15, v1
    v_lshrrev_b32 v4, 4, v1
    s_lshl_b32 s30, s3, 14
    s_add_u32 s30, s30, 75497472
    v_lshlrev_b32 v10, 4, v0
    s_add_u32 s7, s30, 0
    buffer_load_dwordx4 v[16:19], v10, s[16:19], s7 offen sc1
    s_add_u32 s7, s30, 4096
    buffer_load_dwordx4 v[20:23], v10, s[16:19], s7 offen sc1
    s_add_u32 s7, s30, 8192
    buffer_load_dwordx4 v[24:27], v10, s[16:19], s7 offen sc1
    s_add_u32 s7, s30, 12288
    buffer_load_dwordx4 v[28:31], v10, s[16:19], s7 offen sc1
    s_lshl_b32 s7, s6, 4
    v_lshl_add_u32 v11, v4, 1, s7
    v_lshl_add_u32 v11, v11, 5, v3
    v_mul_u32_u24 v11, 642, v11
    s_lshl_b32 s7, s3, 1
    v_add_u32 v11, s7, v11
    s_mov_b32 s7, 0
    buffer_load_short_d16_hi v200, v11, s[24:27], s7 offen
    buffer_load_short_d16_hi v208, v11, s[28:31], s7 offen
    s_mov_b32 s7, 20544
    buffer_load_short_d16_hi v201, v11, s[24:27], s7 offen
    buffer_load_short_d16_hi v209, v11, s[28:31], s7 offen
    s_mov_b32 s7, 10272
    buffer_load_short_d16_hi v202, v11, s[24:27], s7 offen
    buffer_load_short_d16_hi v210, v11, s[28:31], s7 offen
    s_mov_b32 s7, 30816
    buffer_load_short_d16_hi v203, v11, s[24:27], s7 offen
    buffer_load_short_d16_hi v211, v11, s[28:31], s7 offen
    s_mov_b32 s7, 164352
    buffer_load_short_d16_hi v204, v11, s[24:27], s7 offen
    buffer_load_short_d16_hi v212, v11, s[28:31], s7 offen
    s_mov_b32 s7, 184896
    buffer_load_short_d16_hi v205, v11, s[24:27], s7 offen
    buffer_load_short_d16_hi v213, v11, s[28:31], s7 offen
    s_mov_b32 s7, 174624
    buffer_load_short_d16_hi v206, v11, s[24:27], s7 offen
    buffer_load_short_d16_hi v214, v11, s[28:31], s7 offen
    s_mov_b32 s7, 195168
    buffer_load_short_d16_hi v207, v11, s[24:27], s7 offen
    buffer_load_short_d16_hi v215, v11, s[28:31], s7 offen
    v_lshrrev_b32 v5, 1, v3
    v_lshrrev_b32 v6, 1, v4
    v_and_b32 v7, 1, v3
    v_and_b32 v8, 1, v4
    v_sub_u32 v9, v7, v8
    v_cvt_f32_i32 v9, v9
    v_mul_f32 v15, 0.25, v9
    s_mov_b32 s34, 0x3d000000
    s_mov_b32 s35, 0x3c800000
    s_mov_b32 s36, 0x3a000000
    s_lshl_b32 s37, s6, 3
    s_lshl_b32 s38, s6, 4
    v_add_u32 v7, s37, v5
    v_add_u32 v8, 0, v6
    v_mul_u32_u24 v8, v8, v7
    v_and_b32 v8, 31, v8
    v_cvt_f32_u32 v8, v8
    v_fma_f32 v8, v8, s34, v15
    v_cos_f32 v112, v8
    v_add_u32 v8, 2, v6
    v_mul_u32_u24 v8, v8, v7
    v_and_b32 v8, 31, v8
    v_cvt_f32_u32 v8, v8
    v_fma_f32 v8, v8, s34, v15
    v_cos_f32 v113, v8
    v_add_u32 v8, 4, v6
    v_mul_u32_u24 v8, v8, v7
    v_and_b32 v8, 31, v8
    v_cvt_f32_u32 v8, v8
    v_fma_f32 v8, v8, s34, v15
    v_cos_f32 v114, v8
    v_add_u32 v8, 6, v6
    v_mul_u32_u24 v8, v8, v7
    v_and_b32 v8, 31, v8
    v_cvt_f32_u32 v8, v8
    v_fma_f32 v8, v8, s34, v15
    v_cos_f32 v115, v8
    v_add_u32 v8, 8, v6
    v_mul_u32_u24 v8, v8, v7
    v_and_b32 v8, 31, v8
    v_cvt_f32_u32 v8, v8
    v_fma_f32 v8, v8, s34, v15
    v_cos_f32 v116, v8
    v_add_u32 v8, 10, v6
    v_mul_u32_u24 v8, v8, v7
    v_and_b32 v8, 31, v8
    v_cvt_f32_u32 v8, v8
    v_fma_f32 v8, v8, s34, v15
    v_cos_f32 v117, v8
    v_add_u32 v8, 12, v6
    v_mul_u32_u24 v8, v8, v7
    v_and_b32 v8, 31, v8
    v_cvt_f32_u32 v8, v8
    v_fma_f32 v8, v8, s34, v15
    v_cos_f32 v118, v8
    v_add_u32 v8, 14, v6
    v_mul_u32_u24 v8, v8, v7
    v_and_b32 v8, 31, v8
    v_cvt_f32_u32 v8, v8
    v_fma_f32 v8, v8, s34, v15
    v_cos_f32 v119, v8
    v_add_u32 v8, 16, v6
    v_mul_u32_u24 v8, v8, v7
    v_and_b32 v8, 31, v8
    v_cvt_f32_u32 v8, v8
    v_fma_f32 v8, v8, s34, v15
    v_cos_f32 v120, v8
    v_add_u32 v8, 18, v6
    v_mul_u32_u24 v8, v8, v7
    v_and_b32 v8, 31, v8
    v_cvt_f32_u32 v8, v8
    v_fma_f32 v8, v8, s34, v15
    v_cos_f32 v121, v8
    v_add_u32 v8, 20, v6
    v_mul_u32_u24 v8, v8, v7
    v_and_b32 v8, 31, v8
    v_cvt_f32_u32 v8, v8
    v_fma_f32 v8, v8, s34, v15
    v_cos_f32 v122, v8
    v_add_u32 v8, 22, v6
    v_mul_u32_u24 v8, v8, v7
    v_and_b32 v8, 31, v8
    v_cvt_f32_u32 v8, v8
    v_fma_f32 v8, v8, s34, v15
    v_cos_f32 v123, v8
    v_add_u32 v8, 24, v6
    v_mul_u32_u24 v8, v8, v7
    v_and_b32 v8, 31, v8
    v_cvt_f32_u32 v8, v8
    v_fma_f32 v8, v8, s34, v15
    v_cos_f32 v124, v8
    v_add_u32 v8, 26, v6
    v_mul_u32_u24 v8, v8, v7
    v_and_b32 v8, 31, v8
    v_cvt_f32_u32 v8, v8
    v_fma_f32 v8, v8, s34, v15
    v_cos_f32 v125, v8
    v_add_u32 v8, 28, v6
    v_mul_u32_u24 v8, v8, v7
    v_and_b32 v8, 31, v8
    v_cvt_f32_u32 v8, v8
    v_fma_f32 v8, v8, s34, v15
    v_cos_f32 v126, v8
    v_add_u32 v8, 30, v6
    v_mul_u32_u24 v8, v8, v7
    v_and_b32 v8, 31, v8
    v_cvt_f32_u32 v8, v8
    v_fma_f32 v8, v8, s34, v15
    v_cos_f32 v127, v8
    v_add_u32 v7, s38, v5
    v_add_u32 v8, 0, v6
    v_mul_u32_u24 v8, v8, v7
    v_and_b32 v8, 63, v8
    v_cvt_f32_u32 v8, v8
    v_fma_f32 v8, v8, s35, v15
    v_cos_f32 v128, v8
    v_add_u32 v8, 2, v6
    v_mul_u32_u24 v8, v8, v7
    v_and_b32 v8, 63, v8
    v_cvt_f32_u32 v8, v8
    v_fma_f32 v8, v8, s35, v15
    v_cos_f32 v129, v8
    v_add_u32 v8, 4, v6
    v_mul_u32_u24 v8, v8, v7
    v_and_b32 v8, 63, v8
    v_cvt_f32_u32 v8, v8
    v_fma_f32 v8, v8, s35, v15
    v_cos_f32 v130, v8
    v_add_u32 v8, 6, v6
    v_mul_u32_u24 v8, v8, v7
    v_and_b32 v8, 63, v8
    v_cvt_f32_u32 v8, v8
    v_fma_f32 v8, v8, s35, v15
    v_cos_f32 v131, v8
    v_add_u32 v8, 8, v6
    v_mul_u32_u24 v8, v8, v7
    v_and_b32 v8, 63, v8
    v_cvt_f32_u32 v8, v8
    v_fma_f32 v8, v8, s35, v15
    v_cos_f32 v132, v8
    v_add_u32 v8, 10, v6
    v_mul_u32_u24 v8, v8, v7
    v_and_b32 v8, 63, v8
    v_cvt_f32_u32 v8, v8
    v_fma_f32 v8, v8, s35, v15
    v_cos_f32 v133, v8
    v_add_u32 v8, 12, v6
    v_mul_u32_u24 v8, v8, v7
    v_and_b32 v8, 63, v8
    v_cvt_f32_u32 v8, v8
    v_fma_f32 v8, v8, s35, v15
    v_cos_f32 v134, v8
    v_add_u32 v8, 14, v6
    v_mul_u32_u24 v8, v8, v7
    v_and_b32 v8, 63, v8
    v_cvt_f32_u32 v8, v8
    v_fma_f32 v8, v8, s35, v15
    v_cos_f32 v135, v8
    v_add_u32 v8, 16, v6
    v_mul_u32_u24 v8, v8, v7
    v_and_b32 v8, 63, v8
    v_cvt_f32_u32 v8, v8
    v_fma_f32 v8, v8, s35, v15
    v_cos_f32 v136, v8
    v_add_u32 v8, 18, v6
    v_mul_u32_u24 v8, v8, v7
    v_and_b32 v8, 63, v8
    v_cvt_f32_u32 v8, v8
    v_fma_f32 v8, v8, s35, v15
    v_cos_f32 v137, v8
    v_add_u32 v8, 20, v6
    v_mul_u32_u24 v8, v8, v7
    v_and_b32 v8, 63, v8
    v_cvt_f32_u32 v8, v8
    v_fma_f32 v8, v8, s35, v15
    v_cos_f32 v138, v8
    v_add_u32 v8, 22, v6
    v_mul_u32_u24 v8, v8, v7
    v_and_b32 v8, 63, v8
    v_cvt_f32_u32 v8, v8
    v_fma_f32 v8, v8, s35, v15
    v_cos_f32 v139, v8
    v_add_u32 v8, 24, v6
    v_mul_u32_u24 v8, v8, v7
    v_and_b32 v8, 63, v8
    v_cvt_f32_u32 v8, v8
    v_fma_f32 v8, v8, s35, v15
    v_cos_f32 v140, v8
    v_add_u32 v8, 26, v6
    v_mul_u32_u24 v8, v8, v7
    v_and_b32 v8, 63, v8
    v_cvt_f32_u32 v8, v8
    v_fma_f32 v8, v8, s35, v15
    v_cos_f32 v141, v8
    v_add_u32 v8, 28, v6
    v_mul_u32_u24 v8, v8, v7
    v_and_b32 v8, 63, v8
    v_cvt_f32_u32 v8, v8
    v_fma_f32 v8, v8, s35, v15
    v_cos_f32 v142, v8
    v_add_u32 v8, 30, v6
    v_mul_u32_u24 v8, v8, v7
    v_and_b32 v8, 63, v8
    v_cvt_f32_u32 v8, v8
    v_fma_f32 v8, v8, s35, v15
    v_cos_f32 v143, v8
    v_add_u32 v8, 32, v6
    v_mul_u32_u24 v8, v8, v7
    v_and_b32 v8, 63, v8
    v_cvt_f32_u32 v8, v8
    v_fma_f32 v8, v8, s35, v15
    v_cos_f32 v144, v8
    v_add_u32 v8, 34, v6
    v_mul_u32_u24 v8, v8, v7
    v_and_b32 v8, 63, v8
    v_cvt_f32_u32 v8, v8
    v_fma_f32 v8, v8, s35, v15
    v_cos_f32 v145, v8
    v_add_u32 v8, 36, v6
    v_mul_u32_u24 v8, v8, v7
    v_and_b32 v8, 63, v8
    v_cvt_f32_u32 v8, v8
    v_fma_f32 v8, v8, s35, v15
    v_cos_f32 v146, v8
    v_add_u32 v8, 38, v6
    v_mul_u32_u24 v8, v8, v7
    v_and_b32 v8, 63, v8
    v_cvt_f32_u32 v8, v8
    v_fma_f32 v8, v8, s35, v15
    v_cos_f32 v147, v8
    v_add_u32 v8, 40, v6
    v_mul_u32_u24 v8, v8, v7
    v_and_b32 v8, 63, v8
    v_cvt_f32_u32 v8, v8
    v_fma_f32 v8, v8, s35, v15
    v_cos_f32 v148, v8
    v_add_u32 v8, 42, v6
    v_mul_u32_u24 v8, v8, v7
    v_and_b32 v8, 63, v8
    v_cvt_f32_u32 v8, v8
    v_fma_f32 v8, v8, s35, v15
    v_cos_f32 v149, v8
    v_add_u32 v8, 44, v6
    v_mul_u32_u24 v8, v8, v7
    v_and_b32 v8, 63, v8
    v_cvt_f32_u32 v8, v8
    v_fma_f32 v8, v8, s35, v15
    v_cos_f32 v150, v8
    v_add_u32 v8, 46, v6
    v_mul_u32_u24 v8, v8, v7
    v_and_b32 v8, 63, v8
    v_cvt_f32_u32 v8, v8
    v_fma_f32 v8, v8, s35, v15
    v_cos_f32 v151, v8
    v_add_u32 v8, 48, v6
    v_mul_u32_u24 v8, v8, v7
    v_and_b32 v8, 63, v8
    v_cvt_f32_u32 v8, v8
    v_fma_f32 v8, v8, s35, v15
    v_cos_f32 v152, v8
    v_add_u32 v8, 50, v6
    v_mul_u32_u24 v8, v8, v7
    v_and_b32 v8, 63, v8
    v_cvt_f32_u32 v8, v8
    v_fma_f32 v8, v8, s35, v15
    v_cos_f32 v153, v8
    v_add_u32 v8, 52, v6
    v_mul_u32_u24 v8, v8, v7
    v_and_b32 v8, 63, v8
    v_cvt_f32_u32 v8, v8
    v_fma_f32 v8, v8, s35, v15
    v_cos_f32 v154, v8
    v_add_u32 v8, 54, v6
    v_mul_u32_u24 v8, v8, v7
    v_and_b32 v8, 63, v8
    v_cvt_f32_u32 v8, v8
    v_fma_f32 v8, v8, s35, v15
    v_cos_f32 v155, v8
    v_add_u32 v8, 56, v6
    v_mul_u32_u24 v8, v8, v7
    v_and_b32 v8, 63, v8
    v_cvt_f32_u32 v8, v8
    v_fma_f32 v8, v8, s35, v15
    v_cos_f32 v156, v8
    v_add_u32 v8, 58, v6
    v_mul_u32_u24 v8, v8, v7
    v_and_b32 v8, 63, v8
    v_cvt_f32_u32 v8, v8
    v_fma_f32 v8, v8, s35, v15
    v_cos_f32 v157, v8
    v_add_u32 v8, 60, v6
    v_mul_u32_u24 v8, v8, v7
    v_and_b32 v8, 63, v8
    v_cvt_f32_u32 v8, v8
    v_fma_f32 v8, v8, s35, v15
    v_cos_f32 v158, v8
    v_add_u32 v8, 62, v6
    v_mul_u32_u24 v8, v8, v7
    v_and_b32 v8, 63, v8
    v_cvt_f32_u32 v8, v8
    v_fma_f32 v8, v8, s35, v15
    v_cos_f32 v159, v8
    v_add_u32 v7, s38, v5
    v_add_u32 v7, 8, v7
    v_add_u32 v8, 0, v6
    v_mul_u32_u24 v8, v8, v7
    v_and_b32 v8, 63, v8
    v_cvt_f32_u32 v8, v8
    v_fma_f32 v8, v8, s35, v15
    v_cos_f32 v160, v8
    v_add_u32 v8, 2, v6
    v_mul_u32_u24 v8, v8, v7
    v_and_b32 v8, 63, v8
    v_cvt_f32_u32 v8, v8
    v_fma_f32 v8, v8, s35, v15
    v_cos_f32 v161, v8
    v_add_u32 v8, 4, v6
    v_mul_u32_u24 v8, v8, v7
    v_and_b32 v8, 63, v8
    v_cvt_f32_u32 v8, v8
    v_fma_f32 v8, v8, s35, v15
    v_cos_f32 v162, v8
    v_add_u32 v8, 6, v6
    v_mul_u32_u24 v8, v8, v7
    v_and_b32 v8, 63, v8
    v_cvt_f32_u32 v8, v8
    v_fma_f32 v8, v8, s35, v15
    v_cos_f32 v163, v8
    v_add_u32 v8, 8, v6
    v_mul_u32_u24 v8, v8, v7
    v_and_b32 v8, 63, v8
    v_cvt_f32_u32 v8, v8
    v_fma_f32 v8, v8, s35, v15
    v_cos_f32 v164, v8
    v_add_u32 v8, 10, v6
    v_mul_u32_u24 v8, v8, v7
    v_and_b32 v8, 63, v8
    v_cvt_f32_u32 v8, v8
    v_fma_f32 v8, v8, s35, v15
    v_cos_f32 v165, v8
    v_add_u32 v8, 12, v6
    v_mul_u32_u24 v8, v8, v7
    v_and_b32 v8, 63, v8
    v_cvt_f32_u32 v8, v8
    v_fma_f32 v8, v8, s35, v15
    v_cos_f32 v166, v8
    v_add_u32 v8, 14, v6
    v_mul_u32_u24 v8, v8, v7
    v_and_b32 v8, 63, v8
    v_cvt_f32_u32 v8, v8
    v_fma_f32 v8, v8, s35, v15
    v_cos_f32 v167, v8
    v_add_u32 v8, 16, v6
    v_mul_u32_u24 v8, v8, v7
    v_and_b32 v8, 63, v8
    v_cvt_f32_u32 v8, v8
    v_fma_f32 v8, v8, s35, v15
    v_cos_f32 v168, v8
    v_add_u32 v8, 18, v6
    v_mul_u32_u24 v8, v8, v7
    v_and_b32 v8, 63, v8
    v_cvt_f32_u32 v8, v8
    v_fma_f32 v8, v8, s35, v15
    v_cos_f32 v169, v8
    v_add_u32 v8, 20, v6
    v_mul_u32_u24 v8, v8, v7
    v_and_b32 v8, 63, v8
    v_cvt_f32_u32 v8, v8
    v_fma_f32 v8, v8, s35, v15
    v_cos_f32 v170, v8
    v_add_u32 v8, 22, v6
    v_mul_u32_u24 v8, v8, v7
    v_and_b32 v8, 63, v8
    v_cvt_f32_u32 v8, v8
    v_fma_f32 v8, v8, s35, v15
    v_cos_f32 v171, v8
    v_add_u32 v8, 24, v6
    v_mul_u32_u24 v8, v8, v7
    v_and_b32 v8, 63, v8
    v_cvt_f32_u32 v8, v8
    v_fma_f32 v8, v8, s35, v15
    v_cos_f32 v172, v8
    v_add_u32 v8, 26, v6
    v_mul_u32_u24 v8, v8, v7
    v_and_b32 v8, 63, v8
    v_cvt_f32_u32 v8, v8
    v_fma_f32 v8, v8, s35, v15
    v_cos_f32 v173, v8
    v_add_u32 v8, 28, v6
    v_mul_u32_u24 v8, v8, v7
    v_and_b32 v8, 63, v8
    v_cvt_f32_u32 v8, v8
    v_fma_f32 v8, v8, s35, v15
    v_cos_f32 v174, v8
    v_add_u32 v8, 30, v6
    v_mul_u32_u24 v8, v8, v7
    v_and_b32 v8, 63, v8
    v_cvt_f32_u32 v8, v8
    v_fma_f32 v8, v8, s35, v15
    v_cos_f32 v175, v8
    v_add_u32 v8, 32, v6
    v_mul_u32_u24 v8, v8, v7
    v_and_b32 v8, 63, v8
    v_cvt_f32_u32 v8, v8
    v_fma_f32 v8, v8, s35, v15
    v_cos_f32 v176, v8
    v_add_u32 v8, 34, v6
    v_mul_u32_u24 v8, v8, v7
    v_and_b32 v8, 63, v8
    v_cvt_f32_u32 v8, v8
    v_fma_f32 v8, v8, s35, v15
    v_cos_f32 v177, v8
    v_add_u32 v8, 36, v6
    v_mul_u32_u24 v8, v8, v7
    v_and_b32 v8, 63, v8
    v_cvt_f32_u32 v8, v8
    v_fma_f32 v8, v8, s35, v15
    v_cos_f32 v178, v8
    v_add_u32 v8, 38, v6
    v_mul_u32_u24 v8, v8, v7
    v_and_b32 v8, 63, v8
    v_cvt_f32_u32 v8, v8
    v_fma_f32 v8, v8, s35, v15
    v_cos_f32 v179, v8
    v_add_u32 v8, 40, v6
    v_mul_u32_u24 v8, v8, v7
    v_and_b32 v8, 63, v8
    v_cvt_f32_u32 v8, v8
    v_fma_f32 v8, v8, s35, v15
    v_cos_f32 v180, v8
    v_add_u32 v8, 42, v6
    v_mul_u32_u24 v8, v8, v7
    v_and_b32 v8, 63, v8
    v_cvt_f32_u32 v8, v8
    v_fma_f32 v8, v8, s35, v15
    v_cos_f32 v181, v8
    v_add_u32 v8, 44, v6
    v_mul_u32_u24 v8, v8, v7
    v_and_b32 v8, 63, v8
    v_cvt_f32_u32 v8, v8
    v_fma_f32 v8, v8, s35, v15
    v_cos_f32 v182, v8
    v_add_u32 v8, 46, v6
    v_mul_u32_u24 v8, v8, v7
    v_and_b32 v8, 63, v8
    v_cvt_f32_u32 v8, v8
    v_fma_f32 v8, v8, s35, v15
    v_cos_f32 v183, v8
    v_add_u32 v8, 48, v6
    v_mul_u32_u24 v8, v8, v7
    v_and_b32 v8, 63, v8
    v_cvt_f32_u32 v8, v8
    v_fma_f32 v8, v8, s35, v15
    v_cos_f32 v184, v8
    v_add_u32 v8, 50, v6
    v_mul_u32_u24 v8, v8, v7
    v_and_b32 v8, 63, v8
    v_cvt_f32_u32 v8, v8
    v_fma_f32 v8, v8, s35, v15
    v_cos_f32 v185, v8
    v_add_u32 v8, 52, v6
    v_mul_u32_u24 v8, v8, v7
    v_and_b32 v8, 63, v8
    v_cvt_f32_u32 v8, v8
    v_fma_f32 v8, v8, s35, v15
    v_cos_f32 v186, v8
    v_add_u32 v8, 54, v6
    v_mul_u32_u24 v8, v8, v7
    v_and_b32 v8, 63, v8
    v_cvt_f32_u32 v8, v8
    v_fma_f32 v8, v8, s35, v15
    v_cos_f32 v187, v8
    v_add_u32 v8, 56, v6
    v_mul_u32_u24 v8, v8, v7
    v_and_b32 v8, 63, v8
    v_cvt_f32_u32 v8, v8
    v_fma_f32 v8, v8, s35, v15
    v_cos_f32 v188, v8
    v_add_u32 v8, 58, v6
    v_mul_u32_u24 v8, v8, v7
    v_and_b32 v8, 63, v8
    v_cvt_f32_u32 v8, v8
    v_fma_f32 v8, v8, s35, v15
    v_cos_f32 v189, v8
    v_add_u32 v8, 60, v6
    v_mul_u32_u24 v8, v8, v7
    v_and_b32 v8, 63, v8
    v_cvt_f32_u32 v8, v8
    v_fma_f32 v8, v8, s35, v15
    v_cos_f32 v190, v8
    v_add_u32 v8, 62, v6
    v_mul_u32_u24 v8, v8, v7
    v_and_b32 v8, 63, v8
    v_cvt_f32_u32 v8, v8
    v_fma_f32 v8, v8, s35, v15
    v_cos_f32 v191, v8
    s_waitcnt vmcnt(16)
    ds_write_b128 v10, v[16:19] offset:0
    ds_write_b128 v10, v[20:23] offset:4096
    ds_write_b128 v10, v[24:27] offset:8192
    ds_write_b128 v10, v[28:31] offset:12288
    v_and_b32 v8, 1, v4
    v_lshl_add_u32 v12, v6, 6, v3
    v_lshlrev_b32 v12, 3, v12
    v_lshl_add_u32 v12, v8, 2, v12
    v_lshl_add_u32 v13, v6, 5, v3
    v_lshlrev_b32 v13, 3, v13
    v_lshl_add_u32 v13, v8, 2, v13
    s_waitcnt lgkmcnt(0)
    s_barrier
    v_mov_b32 v16, 0
    v_mov_b32 v17, 0
    v_mov_b32 v18, 0
    v_mov_b32 v19, 0
    v_mov_b32 v20, 0
    v_mov_b32 v21, 0
    v_mov_b32 v22, 0
    v_mov_b32 v23, 0
    v_mov_b32 v24, 0
    v_mov_b32 v25, 0
    v_mov_b32 v26, 0
    v_mov_b32 v27, 0
    v_mov_b32 v28, 0
    v_mov_b32 v29, 0
    v_mov_b32 v30, 0
    v_mov_b32 v31, 0
    ds_read_b32 v32, v12 offset:0
    ds_read_b32 v33, v12 offset:128
    ds_read_b32 v34, v12 offset:256
    ds_read_b32 v35, v12 offset:384
    ds_read_b32 v36, v12 offset:1024
    ds_read_b32 v37, v12 offset:1152
    ds_read_b32 v38, v12 offset:1280
    ds_read_b32 v39, v12 offset:1408
    ds_read_b32 v40, v12 offset:2048
    ds_read_b32 v41, v12 offset:2176
    ds_read_b32 v42, v12 offset:2304
    ds_read_b32 v43, v12 offset:2432
    ds_read_b32 v44, v12 offset:3072
    ds_read_b32 v45, v12 offset:3200
    ds_read_b32 v46, v12 offset:3328
    ds_read_b32 v47, v12 offset:3456
    ds_read_b32 v48, v12 offset:4096
    ds_read_b32 v49, v12 offset:4224
    ds_read_b32 v50, v12 offset:4352
    ds_read_b32 v51, v12 offset:4480
    ds_read_b32 v52, v12 offset:5120
    ds_read_b32 v53, v12 offset:5248
    ds_read_b32 v54, v12 offset:5376
    ds_read_b32 v55, v12 offset:5504
    ds_read_b32 v56, v12 offset:6144
    ds_read_b32 v57, v12 offset:6272
    ds_read_b32 v58, v12 offset:6400
    ds_read_b32 v59, v12 offset:6528
    ds_read_b32 v60, v12 offset:7168
    ds_read_b32 v61, v12 offset:7296
    ds_read_b32 v62, v12 offset:7424
    ds_read_b32 v63, v12 offset:7552
    s_waitcnt lgkmcnt(15)
    v_mfma_f32_16x16x4_f32 v[16:19], v112, v32, v[16:19]
    v_mfma_f32_16x16x4_f32 v[20:23], v112, v33, v[20:23]
    v_mfma_f32_16x16x4_f32 v[24:27], v112, v34, v[24:27]
    v_mfma_f32_16x16x4_f32 v[28:31], v112, v35, v[28:31]
    s_waitcnt lgkmcnt(15)
    v_mfma_f32_16x16x4_f32 v[16:19], v113, v36, v[16:19]
    v_mfma_f32_16x16x4_f32 v[20:23], v113, v37, v[20:23]
    v_mfma_f32_16x16x4_f32 v[24:27], v113, v38, v[24:27]
    v_mfma_f32_16x16x4_f32 v[28:31], v113, v39, v[28:31]
    s_waitcnt lgkmcnt(15)
    v_mfma_f32_16x16x4_f32 v[16:19], v114, v40, v[16:19]
    v_mfma_f32_16x16x4_f32 v[20:23], v114, v41, v[20:23]
    v_mfma_f32_16x16x4_f32 v[24:27], v114, v42, v[24:27]
    v_mfma_f32_16x16x4_f32 v[28:31], v114, v43, v[28:31]
    s_waitcnt lgkmcnt(15)
    v_mfma_f32_16x16x4_f32 v[16:19], v115, v44, v[16:19]
    v_mfma_f32_16x16x4_f32 v[20:23], v115, v45, v[20:23]
    v_mfma_f32_16x16x4_f32 v[24:27], v115, v46, v[24:27]
    v_mfma_f32_16x16x4_f32 v[28:31], v115, v47, v[28:31]
    s_waitcnt lgkmcnt(12)
    v_mfma_f32_16x16x4_f32 v[16:19], v116, v48, v[16:19]
    v_mfma_f32_16x16x4_f32 v[20:23], v116, v49, v[20:23]
    v_mfma_f32_16x16x4_f32 v[24:27], v116, v50, v[24:27]
    v_mfma_f32_16x16x4_f32 v[28:31], v116, v51, v[28:31]
    s_waitcnt lgkmcnt(8)
    v_mfma_f32_16x16x4_f32 v[16:19], v117, v52, v[16:19]
    v_mfma_f32_16x16x4_f32 v[20:23], v117, v53, v[20:23]
    v_mfma_f32_16x16x4_f32 v[24:27], v117, v54, v[24:27]
    v_mfma_f32_16x16x4_f32 v[28:31], v117, v55, v[28:31]
    s_waitcnt lgkmcnt(4)
    v_mfma_f32_16x16x4_f32 v[16:19], v118, v56, v[16:19]
    v_mfma_f32_16x16x4_f32 v[20:23], v118, v57, v[20:23]
    v_mfma_f32_16x16x4_f32 v[24:27], v118, v58, v[24:27]
    v_mfma_f32_16x16x4_f32 v[28:31], v118, v59, v[28:31]
    s_waitcnt lgkmcnt(0)
    v_mfma_f32_16x16x4_f32 v[16:19], v119, v60, v[16:19]
    v_mfma_f32_16x16x4_f32 v[20:23], v119, v61, v[20:23]
    v_mfma_f32_16x16x4_f32 v[24:27], v119, v62, v[24:27]
    v_mfma_f32_16x16x4_f32 v[28:31], v119, v63, v[28:31]
    ds_read_b32 v32, v12 offset:8192
    ds_read_b32 v33, v12 offset:8320
    ds_read_b32 v34, v12 offset:8448
    ds_read_b32 v35, v12 offset:8576
    ds_read_b32 v36, v12 offset:9216
    ds_read_b32 v37, v12 offset:9344
    ds_read_b32 v38, v12 offset:9472
    ds_read_b32 v39, v12 offset:9600
    ds_read_b32 v40, v12 offset:10240
    ds_read_b32 v41, v12 offset:10368
    ds_read_b32 v42, v12 offset:10496
    ds_read_b32 v43, v12 offset:10624
    ds_read_b32 v44, v12 offset:11264
    ds_read_b32 v45, v12 offset:11392
    ds_read_b32 v46, v12 offset:11520
    ds_read_b32 v47, v12 offset:11648
    ds_read_b32 v48, v12 offset:12288
    ds_read_b32 v49, v12 offset:12416
    ds_read_b32 v50, v12 offset:12544
    ds_read_b32 v51, v12 offset:12672
    ds_read_b32 v52, v12 offset:13312
    ds_read_b32 v53, v12 offset:13440
    ds_read_b32 v54, v12 offset:13568
    ds_read_b32 v55, v12 offset:13696
    ds_read_b32 v56, v12 offset:14336
    ds_read_b32 v57, v12 offset:14464
    ds_read_b32 v58, v12 offset:14592
    ds_read_b32 v59, v12 offset:14720
    ds_read_b32 v60, v12 offset:15360
    ds_read_b32 v61, v12 offset:15488
    ds_read_b32 v62, v12 offset:15616
    ds_read_b32 v63, v12 offset:15744
    s_waitcnt lgkmcnt(15)
    v_mfma_f32_16x16x4_f32 v[16:19], v120, v32, v[16:19]
    v_mfma_f32_16x16x4_f32 v[20:23], v120, v33, v[20:23]
    v_mfma_f32_16x16x4_f32 v[24:27], v120, v34, v[24:27]
    v_mfma_f32_16x16x4_f32 v[28:31], v120, v35, v[28:31]
    s_waitcnt lgkmcnt(15)
    v_mfma_f32_16x16x4_f32 v[16:19], v121, v36, v[16:19]
    v_mfma_f32_16x16x4_f32 v[20:23], v121, v37, v[20:23]
    v_mfma_f32_16x16x4_f32 v[24:27], v121, v38, v[24:27]
    v_mfma_f32_16x16x4_f32 v[28:31], v121, v39, v[28:31]
    s_waitcnt lgkmcnt(15)
    v_mfma_f32_16x16x4_f32 v[16:19], v122, v40, v[16:19]
    v_mfma_f32_16x16x4_f32 v[20:23], v122, v41, v[20:23]
    v_mfma_f32_16x16x4_f32 v[24:27], v122, v42, v[24:27]
    v_mfma_f32_16x16x4_f32 v[28:31], v122, v43, v[28:31]
    s_waitcnt lgkmcnt(15)
    v_mfma_f32_16x16x4_f32 v[16:19], v123, v44, v[16:19]
    v_mfma_f32_16x16x4_f32 v[20:23], v123, v45, v[20:23]
    v_mfma_f32_16x16x4_f32 v[24:27], v123, v46, v[24:27]
    v_mfma_f32_16x16x4_f32 v[28:31], v123, v47, v[28:31]
    s_waitcnt lgkmcnt(12)
    v_mfma_f32_16x16x4_f32 v[16:19], v124, v48, v[16:19]
    v_mfma_f32_16x16x4_f32 v[20:23], v124, v49, v[20:23]
    v_mfma_f32_16x16x4_f32 v[24:27], v124, v50, v[24:27]
    v_mfma_f32_16x16x4_f32 v[28:31], v124, v51, v[28:31]
    s_waitcnt lgkmcnt(8)
    v_mfma_f32_16x16x4_f32 v[16:19], v125, v52, v[16:19]
    v_mfma_f32_16x16x4_f32 v[20:23], v125, v53, v[20:23]
    v_mfma_f32_16x16x4_f32 v[24:27], v125, v54, v[24:27]
    v_mfma_f32_16x16x4_f32 v[28:31], v125, v55, v[28:31]
    s_waitcnt lgkmcnt(4)
    v_mfma_f32_16x16x4_f32 v[16:19], v126, v56, v[16:19]
    v_mfma_f32_16x16x4_f32 v[20:23], v126, v57, v[20:23]
    v_mfma_f32_16x16x4_f32 v[24:27], v126, v58, v[24:27]
    v_mfma_f32_16x16x4_f32 v[28:31], v126, v59, v[28:31]
    s_waitcnt lgkmcnt(0)
    v_mfma_f32_16x16x4_f32 v[16:19], v127, v60, v[16:19]
    v_mfma_f32_16x16x4_f32 v[20:23], v127, v61, v[20:23]
    v_mfma_f32_16x16x4_f32 v[24:27], v127, v62, v[24:27]
    v_mfma_f32_16x16x4_f32 v[28:31], v127, v63, v[28:31]
    s_nop 7
    s_nop 3
    v_lshl_add_u32 v64, v4, 1, s37
    v_lshlrev_b32 v65, 8, v3
    v_lshl_add_u32 v65, v64, 3, v65
    v_add_u32 v66, 0, v3
    v_add_u32 v67, 0, v64
    v_mul_u32_u24 v66, v66, v67
    v_cvt_f32_u32 v66, v66
    v_mul_f32 v66, s36, v66
    v_cos_f32 v68, v66
    v_sin_f32 v69, v66
    s_nop 0
    v_mul_f32 v70, v16, v68
    v_mul_f32 v71, v17, v68
    v_fma_f32 v70, v17, v69, v70
    v_fma_f32 v17, -v16, v69, v71
    v_mov_b32 v16, v70
    v_add_u32 v66, 0, v3
    v_add_u32 v67, 1, v64
    v_mul_u32_u24 v66, v66, v67
    v_cvt_f32_u32 v66, v66
    v_mul_f32 v66, s36, v66
    v_cos_f32 v68, v66
    v_sin_f32 v69, v66
    s_nop 0
    v_mul_f32 v70, v18, v68
    v_mul_f32 v71, v19, v68
    v_fma_f32 v70, v19, v69, v70
    v_fma_f32 v19, -v18, v69, v71
    v_mov_b32 v18, v70
    ds_write_b128 v65, v[16:19] offset:16384
    v_add_u32 v66, 16, v3
    v_add_u32 v67, 0, v64
    v_mul_u32_u24 v66, v66, v67
    v_cvt_f32_u32 v66, v66
    v_mul_f32 v66, s36, v66
    v_cos_f32 v68, v66
    v_sin_f32 v69, v66
    s_nop 0
    v_mul_f32 v70, v20, v68
    v_mul_f32 v71, v21, v68
    v_fma_f32 v70, v21, v69, v70
    v_fma_f32 v21, -v20, v69, v71
    v_mov_b32 v20, v70
    v_add_u32 v66, 16, v3
    v_add_u32 v67, 1, v64
    v_mul_u32_u24 v66, v66, v67
    v_cvt_f32_u32 v66, v66
    v_mul_f32 v66, s36, v66
    v_cos_f32 v68, v66
    v_sin_f32 v69, v66
    s_nop 0
    v_mul_f32 v70, v22, v68
    v_mul_f32 v71, v23, v68
    v_fma_f32 v70, v23, v69, v70
    v_fma_f32 v23, -v22, v69, v71
    v_mov_b32 v22, v70
    ds_write_b128 v65, v[20:23] offset:20480
    v_add_u32 v66, 32, v3
    v_add_u32 v67, 0, v64
    v_mul_u32_u24 v66, v66, v67
    v_cvt_f32_u32 v66, v66
    v_mul_f32 v66, s36, v66
    v_cos_f32 v68, v66
    v_sin_f32 v69, v66
    s_nop 0
    v_mul_f32 v70, v24, v68
    v_mul_f32 v71, v25, v68
    v_fma_f32 v70, v25, v69, v70
    v_fma_f32 v25, -v24, v69, v71
    v_mov_b32 v24, v70
    v_add_u32 v66, 32, v3
    v_add_u32 v67, 1, v64
    v_mul_u32_u24 v66, v66, v67
    v_cvt_f32_u32 v66, v66
    v_mul_f32 v66, s36, v66
    v_cos_f32 v68, v66
    v_sin_f32 v69, v66
    s_nop 0
    v_mul_f32 v70, v26, v68
    v_mul_f32 v71, v27, v68
    v_fma_f32 v70, v27, v69, v70
    v_fma_f32 v27, -v26, v69, v71
    v_mov_b32 v26, v70
    ds_write_b128 v65, v[24:27] offset:24576
    v_add_u32 v66, 48, v3
    v_add_u32 v67, 0, v64
    v_mul_u32_u24 v66, v66, v67
    v_cvt_f32_u32 v66, v66
    v_mul_f32 v66, s36, v66
    v_cos_f32 v68, v66
    v_sin_f32 v69, v66
    s_nop 0
    v_mul_f32 v70, v28, v68
    v_mul_f32 v71, v29, v68
    v_fma_f32 v70, v29, v69, v70
    v_fma_f32 v29, -v28, v69, v71
    v_mov_b32 v28, v70
    v_add_u32 v66, 48, v3
    v_add_u32 v67, 1, v64
    v_mul_u32_u24 v66, v66, v67
    v_cvt_f32_u32 v66, v66
    v_mul_f32 v66, s36, v66
    v_cos_f32 v68, v66
    v_sin_f32 v69, v66
    s_nop 0
    v_mul_f32 v70, v30, v68
    v_mul_f32 v71, v31, v68
    v_fma_f32 v70, v31, v69, v70
    v_fma_f32 v31, -v30, v69, v71
    v_mov_b32 v30, v70
    ds_write_b128 v65, v[28:31] offset:28672
    s_waitcnt lgkmcnt(0)
    s_barrier
    v_mov_b32 v16, 0
    v_mov_b32 v17, 0
    v_mov_b32 v18, 0
    v_mov_b32 v19, 0
    v_mov_b32 v20, 0
    v_mov_b32 v21, 0
    v_mov_b32 v22, 0
    v_mov_b32 v23, 0
    v_mov_b32 v24, 0
    v_mov_b32 v25, 0
    v_mov_b32 v26, 0
    v_mov_b32 v27, 0
    v_mov_b32 v28, 0
    v_mov_b32 v29, 0
    v_mov_b32 v30, 0
    v_mov_b32 v31, 0
    ds_read_b32 v32, v13 offset:16384
    ds_read_b32 v33, v13 offset:16512
    ds_read_b32 v34, v13 offset:16896
    ds_read_b32 v35, v13 offset:17024
    ds_read_b32 v36, v13 offset:17408
    ds_read_b32 v37, v13 offset:17536
    ds_read_b32 v38, v13 offset:17920
    ds_read_b32 v39, v13 offset:18048
    ds_read_b32 v40, v13 offset:18432
    ds_read_b32 v41, v13 offset:18560
    ds_read_b32 v42, v13 offset:18944
    ds_read_b32 v43, v13 offset:19072
    ds_read_b32 v44, v13 offset:19456
    ds_read_b32 v45, v13 offset:19584
    ds_read_b32 v46, v13 offset:19968
    ds_read_b32 v47, v13 offset:20096
    ds_read_b32 v48, v13 offset:20480
    ds_read_b32 v49, v13 offset:20608
    ds_read_b32 v50, v13 offset:20992
    ds_read_b32 v51, v13 offset:21120
    ds_read_b32 v52, v13 offset:21504
    ds_read_b32 v53, v13 offset:21632
    ds_read_b32 v54, v13 offset:22016
    ds_read_b32 v55, v13 offset:22144
    ds_read_b32 v56, v13 offset:22528
    ds_read_b32 v57, v13 offset:22656
    ds_read_b32 v58, v13 offset:23040
    ds_read_b32 v59, v13 offset:23168
    ds_read_b32 v60, v13 offset:23552
    ds_read_b32 v61, v13 offset:23680
    ds_read_b32 v62, v13 offset:24064
    ds_read_b32 v63, v13 offset:24192
    s_waitcnt lgkmcnt(15)
    v_mfma_f32_16x16x4_f32 v[16:19], v128, v32, v[16:19]
    v_mfma_f32_16x16x4_f32 v[20:23], v128, v33, v[20:23]
    v_mfma_f32_16x16x4_f32 v[24:27], v160, v32, v[24:27]
    v_mfma_f32_16x16x4_f32 v[28:31], v160, v33, v[28:31]
    s_waitcnt lgkmcnt(15)
    v_mfma_f32_16x16x4_f32 v[16:19], v129, v34, v[16:19]
    v_mfma_f32_16x16x4_f32 v[20:23], v129, v35, v[20:23]
    v_mfma_f32_16x16x4_f32 v[24:27], v161, v34, v[24:27]
    v_mfma_f32_16x16x4_f32 v[28:31], v161, v35, v[28:31]
    s_waitcnt lgkmcnt(15)
    v_mfma_f32_16x16x4_f32 v[16:19], v130, v36, v[16:19]
    v_mfma_f32_16x16x4_f32 v[20:23], v130, v37, v[20:23]
    v_mfma_f32_16x16x4_f32 v[24:27], v162, v36, v[24:27]
    v_mfma_f32_16x16x4_f32 v[28:31], v162, v37, v[28:31]
    s_waitcnt lgkmcnt(15)
    v_mfma_f32_16x16x4_f32 v[16:19], v131, v38, v[16:19]
    v_mfma_f32_16x16x4_f32 v[20:23], v131, v39, v[20:23]
    v_mfma_f32_16x16x4_f32 v[24:27], v163, v38, v[24:27]
    v_mfma_f32_16x16x4_f32 v[28:31], v163, v39, v[28:31]
    s_waitcnt lgkmcnt(15)
    v_mfma_f32_16x16x4_f32 v[16:19], v132, v40, v[16:19]
    v_mfma_f32_16x16x4_f32 v[20:23], v132, v41, v[20:23]
    v_mfma_f32_16x16x4_f32 v[24:27], v164, v40, v[24:27]
    v_mfma_f32_16x16x4_f32 v[28:31], v164, v41, v[28:31]
    s_waitcnt lgkmcnt(15)
    v_mfma_f32_16x16x4_f32 v[16:19], v133, v42, v[16:19]
    v_mfma_f32_16x16x4_f32 v[20:23], v133, v43, v[20:23]
    v_mfma_f32_16x16x4_f32 v[24:27], v165, v42, v[24:27]
    v_mfma_f32_16x16x4_f32 v[28:31], v165, v43, v[28:31]
    s_waitcnt lgkmcnt(15)
    v_mfma_f32_16x16x4_f32 v[16:19], v134, v44, v[16:19]
    v_mfma_f32_16x16x4_f32 v[20:23], v134, v45, v[20:23]
    v_mfma_f32_16x16x4_f32 v[24:27], v166, v44, v[24:27]
    v_mfma_f32_16x16x4_f32 v[28:31], v166, v45, v[28:31]
    s_waitcnt lgkmcnt(15)
    v_mfma_f32_16x16x4_f32 v[16:19], v135, v46, v[16:19]
    v_mfma_f32_16x16x4_f32 v[20:23], v135, v47, v[20:23]
    v_mfma_f32_16x16x4_f32 v[24:27], v167, v46, v[24:27]
    v_mfma_f32_16x16x4_f32 v[28:31], v167, v47, v[28:31]
    s_waitcnt lgkmcnt(14)
    v_mfma_f32_16x16x4_f32 v[16:19], v136, v48, v[16:19]
    v_mfma_f32_16x16x4_f32 v[20:23], v136, v49, v[20:23]
    v_mfma_f32_16x16x4_f32 v[24:27], v168, v48, v[24:27]
    v_mfma_f32_16x16x4_f32 v[28:31], v168, v49, v[28:31]
    s_waitcnt lgkmcnt(12)
    v_mfma_f32_16x16x4_f32 v[16:19], v137, v50, v[16:19]
    v_mfma_f32_16x16x4_f32 v[20:23], v137, v51, v[20:23]
    v_mfma_f32_16x16x4_f32 v[24:27], v169, v50, v[24:27]
    v_mfma_f32_16x16x4_f32 v[28:31], v169, v51, v[28:31]
    s_waitcnt lgkmcnt(10)
    v_mfma_f32_16x16x4_f32 v[16:19], v138, v52, v[16:19]
    v_mfma_f32_16x16x4_f32 v[20:23], v138, v53, v[20:23]
    v_mfma_f32_16x16x4_f32 v[24:27], v170, v52, v[24:27]
    v_mfma_f32_16x16x4_f32 v[28:31], v170, v53, v[28:31]
    s_waitcnt lgkmcnt(8)
    v_mfma_f32_16x16x4_f32 v[16:19], v139, v54, v[16:19]
    v_mfma_f32_16x16x4_f32 v[20:23], v139, v55, v[20:23]
    v_mfma_f32_16x16x4_f32 v[24:27], v171, v54, v[24:27]
    v_mfma_f32_16x16x4_f32 v[28:31], v171, v55, v[28:31]
    s_waitcnt lgkmcnt(6)
    v_mfma_f32_16x16x4_f32 v[16:19], v140, v56, v[16:19]
    v_mfma_f32_16x16x4_f32 v[20:23], v140, v57, v[20:23]
    v_mfma_f32_16x16x4_f32 v[24:27], v172, v56, v[24:27]
    v_mfma_f32_16x16x4_f32 v[28:31], v172, v57, v[28:31]
    s_waitcnt lgkmcnt(4)
    v_mfma_f32_16x16x4_f32 v[16:19], v141, v58, v[16:19]
    v_mfma_f32_16x16x4_f32 v[20:23], v141, v59, v[20:23]
    v_mfma_f32_16x16x4_f32 v[24:27], v173, v58, v[24:27]
    v_mfma_f32_16x16x4_f32 v[28:31], v173, v59, v[28:31]
    s_waitcnt lgkmcnt(2)
    v_mfma_f32_16x16x4_f32 v[16:19], v142, v60, v[16:19]
    v_mfma_f32_16x16x4_f32 v[20:23], v142, v61, v[20:23]
    v_mfma_f32_16x16x4_f32 v[24:27], v174, v60, v[24:27]
    v_mfma_f32_16x16x4_f32 v[28:31], v174, v61, v[28:31]
    s_waitcnt lgkmcnt(0)
    v_mfma_f32_16x16x4_f32 v[16:19], v143, v62, v[16:19]
    v_mfma_f32_16x16x4_f32 v[20:23], v143, v63, v[20:23]
    v_mfma_f32_16x16x4_f32 v[24:27], v175, v62, v[24:27]
    v_mfma_f32_16x16x4_f32 v[28:31], v175, v63, v[28:31]
    ds_read_b32 v32, v13 offset:24576
    ds_read_b32 v33, v13 offset:24704
    ds_read_b32 v34, v13 offset:25088
    ds_read_b32 v35, v13 offset:25216
    ds_read_b32 v36, v13 offset:25600
    ds_read_b32 v37, v13 offset:25728
    ds_read_b32 v38, v13 offset:26112
    ds_read_b32 v39, v13 offset:26240
    ds_read_b32 v40, v13 offset:26624
    ds_read_b32 v41, v13 offset:26752
    ds_read_b32 v42, v13 offset:27136
    ds_read_b32 v43, v13 offset:27264
    ds_read_b32 v44, v13 offset:27648
    ds_read_b32 v45, v13 offset:27776
    ds_read_b32 v46, v13 offset:28160
    ds_read_b32 v47, v13 offset:28288
    ds_read_b32 v48, v13 offset:28672
    ds_read_b32 v49, v13 offset:28800
    ds_read_b32 v50, v13 offset:29184
    ds_read_b32 v51, v13 offset:29312
    ds_read_b32 v52, v13 offset:29696
    ds_read_b32 v53, v13 offset:29824
    ds_read_b32 v54, v13 offset:30208
    ds_read_b32 v55, v13 offset:30336
    ds_read_b32 v56, v13 offset:30720
    ds_read_b32 v57, v13 offset:30848
    ds_read_b32 v58, v13 offset:31232
    ds_read_b32 v59, v13 offset:31360
    ds_read_b32 v60, v13 offset:31744
    ds_read_b32 v61, v13 offset:31872
    ds_read_b32 v62, v13 offset:32256
    ds_read_b32 v63, v13 offset:32384
    s_waitcnt lgkmcnt(15)
    v_mfma_f32_16x16x4_f32 v[16:19], v144, v32, v[16:19]
    v_mfma_f32_16x16x4_f32 v[20:23], v144, v33, v[20:23]
    v_mfma_f32_16x16x4_f32 v[24:27], v176, v32, v[24:27]
    v_mfma_f32_16x16x4_f32 v[28:31], v176, v33, v[28:31]
    s_waitcnt lgkmcnt(15)
    v_mfma_f32_16x16x4_f32 v[16:19], v145, v34, v[16:19]
    v_mfma_f32_16x16x4_f32 v[20:23], v145, v35, v[20:23]
    v_mfma_f32_16x16x4_f32 v[24:27], v177, v34, v[24:27]
    v_mfma_f32_16x16x4_f32 v[28:31], v177, v35, v[28:31]
    s_waitcnt lgkmcnt(15)
    v_mfma_f32_16x16x4_f32 v[16:19], v146, v36, v[16:19]
    v_mfma_f32_16x16x4_f32 v[20:23], v146, v37, v[20:23]
    v_mfma_f32_16x16x4_f32 v[24:27], v178, v36, v[24:27]
    v_mfma_f32_16x16x4_f32 v[28:31], v178, v37, v[28:31]
    s_waitcnt lgkmcnt(15)
    v_mfma_f32_16x16x4_f32 v[16:19], v147, v38, v[16:19]
    v_mfma_f32_16x16x4_f32 v[20:23], v147, v39, v[20:23]
    v_mfma_f32_16x16x4_f32 v[24:27], v179, v38, v[24:27]
    v_mfma_f32_16x16x4_f32 v[28:31], v179, v39, v[28:31]
    s_waitcnt lgkmcnt(15)
    v_mfma_f32_16x16x4_f32 v[16:19], v148, v40, v[16:19]
    v_mfma_f32_16x16x4_f32 v[20:23], v148, v41, v[20:23]
    v_mfma_f32_16x16x4_f32 v[24:27], v180, v40, v[24:27]
    v_mfma_f32_16x16x4_f32 v[28:31], v180, v41, v[28:31]
    s_waitcnt lgkmcnt(15)
    v_mfma_f32_16x16x4_f32 v[16:19], v149, v42, v[16:19]
    v_mfma_f32_16x16x4_f32 v[20:23], v149, v43, v[20:23]
    v_mfma_f32_16x16x4_f32 v[24:27], v181, v42, v[24:27]
    v_mfma_f32_16x16x4_f32 v[28:31], v181, v43, v[28:31]
    s_waitcnt lgkmcnt(15)
    v_mfma_f32_16x16x4_f32 v[16:19], v150, v44, v[16:19]
    v_mfma_f32_16x16x4_f32 v[20:23], v150, v45, v[20:23]
    v_mfma_f32_16x16x4_f32 v[24:27], v182, v44, v[24:27]
    v_mfma_f32_16x16x4_f32 v[28:31], v182, v45, v[28:31]
    s_waitcnt lgkmcnt(15)
    v_mfma_f32_16x16x4_f32 v[16:19], v151, v46, v[16:19]
    v_mfma_f32_16x16x4_f32 v[20:23], v151, v47, v[20:23]
    v_mfma_f32_16x16x4_f32 v[24:27], v183, v46, v[24:27]
    v_mfma_f32_16x16x4_f32 v[28:31], v183, v47, v[28:31]
    s_waitcnt lgkmcnt(14)
    v_mfma_f32_16x16x4_f32 v[16:19], v152, v48, v[16:19]
    v_mfma_f32_16x16x4_f32 v[20:23], v152, v49, v[20:23]
    v_mfma_f32_16x16x4_f32 v[24:27], v184, v48, v[24:27]
    v_mfma_f32_16x16x4_f32 v[28:31], v184, v49, v[28:31]
    s_waitcnt lgkmcnt(12)
    v_mfma_f32_16x16x4_f32 v[16:19], v153, v50, v[16:19]
    v_mfma_f32_16x16x4_f32 v[20:23], v153, v51, v[20:23]
    v_mfma_f32_16x16x4_f32 v[24:27], v185, v50, v[24:27]
    v_mfma_f32_16x16x4_f32 v[28:31], v185, v51, v[28:31]
    s_waitcnt lgkmcnt(10)
    v_mfma_f32_16x16x4_f32 v[16:19], v154, v52, v[16:19]
    v_mfma_f32_16x16x4_f32 v[20:23], v154, v53, v[20:23]
    v_mfma_f32_16x16x4_f32 v[24:27], v186, v52, v[24:27]
    v_mfma_f32_16x16x4_f32 v[28:31], v186, v53, v[28:31]
    s_waitcnt lgkmcnt(8)
    v_mfma_f32_16x16x4_f32 v[16:19], v155, v54, v[16:19]
    v_mfma_f32_16x16x4_f32 v[20:23], v155, v55, v[20:23]
    v_mfma_f32_16x16x4_f32 v[24:27], v187, v54, v[24:27]
    v_mfma_f32_16x16x4_f32 v[28:31], v187, v55, v[28:31]
    s_waitcnt lgkmcnt(6)
    v_mfma_f32_16x16x4_f32 v[16:19], v156, v56, v[16:19]
    v_mfma_f32_16x16x4_f32 v[20:23], v156, v57, v[20:23]
    v_mfma_f32_16x16x4_f32 v[24:27], v188, v56, v[24:27]
    v_mfma_f32_16x16x4_f32 v[28:31], v188, v57, v[28:31]
    s_waitcnt lgkmcnt(4)
    v_mfma_f32_16x16x4_f32 v[16:19], v157, v58, v[16:19]
    v_mfma_f32_16x16x4_f32 v[20:23], v157, v59, v[20:23]
    v_mfma_f32_16x16x4_f32 v[24:27], v189, v58, v[24:27]
    v_mfma_f32_16x16x4_f32 v[28:31], v189, v59, v[28:31]
    s_waitcnt lgkmcnt(2)
    v_mfma_f32_16x16x4_f32 v[16:19], v158, v60, v[16:19]
    v_mfma_f32_16x16x4_f32 v[20:23], v158, v61, v[20:23]
    v_mfma_f32_16x16x4_f32 v[24:27], v190, v60, v[24:27]
    v_mfma_f32_16x16x4_f32 v[28:31], v190, v61, v[28:31]
    s_waitcnt lgkmcnt(0)
    v_mfma_f32_16x16x4_f32 v[16:19], v159, v62, v[16:19]
    v_mfma_f32_16x16x4_f32 v[20:23], v159, v63, v[20:23]
    v_mfma_f32_16x16x4_f32 v[24:27], v191, v62, v[24:27]
    v_mfma_f32_16x16x4_f32 v[28:31], v191, v63, v[28:31]
    s_nop 7
    s_nop 3
    s_waitcnt vmcnt(0)
    v_lshl_add_u32 v64, v4, 1, s38
    v_lshlrev_b32 v65, 8, v64
    v_lshl_add_u32 v65, v3, 3, v65
    v_and_b32 v66, 0xffff0000, v200
    v_and_b32 v67, 0xffff0000, v208
    v_mul_f32 v68, v16, v66
    v_mul_f32 v69, v16, v67
    v_fma_f32 v68, -v17, v67, v68
    v_fma_f32 v69, v17, v66, v69
    v_mov_b32 v16, v68
    v_xor_b32 v17, 0x80000000, v69
    ds_write_b64 v65, v[16:17] offset:0
    v_and_b32 v66, 0xffff0000, v201
    v_and_b32 v67, 0xffff0000, v209
    v_mul_f32 v68, v18, v66
    v_mul_f32 v69, v18, v67
    v_fma_f32 v68, -v19, v67, v68
    v_fma_f32 v69, v19, v66, v69
    v_mov_b32 v18, v68
    v_xor_b32 v19, 0x80000000, v69
    ds_write_b64 v65, v[18:19] offset:256
    v_and_b32 v66, 0xffff0000, v202
    v_and_b32 v67, 0xffff0000, v210
    v_mul_f32 v68, v20, v66
    v_mul_f32 v69, v20, v67
    v_fma_f32 v68, -v21, v67, v68
    v_fma_f32 v69, v21, v66, v69
    v_mov_b32 v20, v68
    v_xor_b32 v21, 0x80000000, v69
    ds_write_b64 v65, v[20:21] offset:128
    v_and_b32 v66, 0xffff0000, v203
    v_and_b32 v67, 0xffff0000, v211
    v_mul_f32 v68, v22, v66
    v_mul_f32 v69, v22, v67
    v_fma_f32 v68, -v23, v67, v68
    v_fma_f32 v69, v23, v66, v69
    v_mov_b32 v22, v68
    v_xor_b32 v23, 0x80000000, v69
    ds_write_b64 v65, v[22:23] offset:384
    v_and_b32 v66, 0xffff0000, v204
    v_and_b32 v67, 0xffff0000, v212
    v_mul_f32 v68, v24, v66
    v_mul_f32 v69, v24, v67
    v_fma_f32 v68, -v25, v67, v68
    v_fma_f32 v69, v25, v66, v69
    v_mov_b32 v24, v68
    v_xor_b32 v25, 0x80000000, v69
    ds_write_b64 v65, v[24:25] offset:2048
    v_and_b32 v66, 0xffff0000, v205
    v_and_b32 v67, 0xffff0000, v213
    v_mul_f32 v68, v26, v66
    v_mul_f32 v69, v26, v67
    v_fma_f32 v68, -v27, v67, v68
    v_fma_f32 v69, v27, v66, v69
    v_mov_b32 v26, v68
    v_xor_b32 v27, 0x80000000, v69
    ds_write_b64 v65, v[26:27] offset:2304
    v_and_b32 v66, 0xffff0000, v206
    v_and_b32 v67, 0xffff0000, v214
    v_mul_f32 v68, v28, v66
    v_mul_f32 v69, v28, v67
    v_fma_f32 v68, -v29, v67, v68
    v_fma_f32 v69, v29, v66, v69
    v_mov_b32 v28, v68
    v_xor_b32 v29, 0x80000000, v69
    ds_write_b64 v65, v[28:29] offset:2176
    v_and_b32 v66, 0xffff0000, v207
    v_and_b32 v67, 0xffff0000, v215
    v_mul_f32 v68, v30, v66
    v_mul_f32 v69, v30, v67
    v_fma_f32 v68, -v31, v67, v68
    v_fma_f32 v69, v31, v66, v69
    v_mov_b32 v30, v68
    v_xor_b32 v31, 0x80000000, v69
    ds_write_b64 v65, v[30:31] offset:2432
    s_waitcnt lgkmcnt(0)
    s_barrier
    v_mov_b32 v16, 0
    v_mov_b32 v17, 0
    v_mov_b32 v18, 0
    v_mov_b32 v19, 0
    v_mov_b32 v20, 0
    v_mov_b32 v21, 0
    v_mov_b32 v22, 0
    v_mov_b32 v23, 0
    v_mov_b32 v24, 0
    v_mov_b32 v25, 0
    v_mov_b32 v26, 0
    v_mov_b32 v27, 0
    v_mov_b32 v28, 0
    v_mov_b32 v29, 0
    v_mov_b32 v30, 0
    v_mov_b32 v31, 0
    ds_read_b32 v32, v13 offset:0
    ds_read_b32 v33, v13 offset:128
    ds_read_b32 v34, v13 offset:512
    ds_read_b32 v35, v13 offset:640
    ds_read_b32 v36, v13 offset:1024
    ds_read_b32 v37, v13 offset:1152
    ds_read_b32 v38, v13 offset:1536
    ds_read_b32 v39, v13 offset:1664
    ds_read_b32 v40, v13 offset:2048
    ds_read_b32 v41, v13 offset:2176
    ds_read_b32 v42, v13 offset:2560
    ds_read_b32 v43, v13 offset:2688
    ds_read_b32 v44, v13 offset:3072
    ds_read_b32 v45, v13 offset:3200
    ds_read_b32 v46, v13 offset:3584
    ds_read_b32 v47, v13 offset:3712
    ds_read_b32 v48, v13 offset:4096
    ds_read_b32 v49, v13 offset:4224
    ds_read_b32 v50, v13 offset:4608
    ds_read_b32 v51, v13 offset:4736
    ds_read_b32 v52, v13 offset:5120
    ds_read_b32 v53, v13 offset:5248
    ds_read_b32 v54, v13 offset:5632
    ds_read_b32 v55, v13 offset:5760
    ds_read_b32 v56, v13 offset:6144
    ds_read_b32 v57, v13 offset:6272
    ds_read_b32 v58, v13 offset:6656
    ds_read_b32 v59, v13 offset:6784
    ds_read_b32 v60, v13 offset:7168
    ds_read_b32 v61, v13 offset:7296
    ds_read_b32 v62, v13 offset:7680
    ds_read_b32 v63, v13 offset:7808
    s_waitcnt lgkmcnt(15)
    v_mfma_f32_16x16x4_f32 v[16:19], v128, v32, v[16:19]
    v_mfma_f32_16x16x4_f32 v[20:23], v128, v33, v[20:23]
    v_mfma_f32_16x16x4_f32 v[24:27], v160, v32, v[24:27]
    v_mfma_f32_16x16x4_f32 v[28:31], v160, v33, v[28:31]
    s_waitcnt lgkmcnt(15)
    v_mfma_f32_16x16x4_f32 v[16:19], v129, v34, v[16:19]
    v_mfma_f32_16x16x4_f32 v[20:23], v129, v35, v[20:23]
    v_mfma_f32_16x16x4_f32 v[24:27], v161, v34, v[24:27]
    v_mfma_f32_16x16x4_f32 v[28:31], v161, v35, v[28:31]
    s_waitcnt lgkmcnt(15)
    v_mfma_f32_16x16x4_f32 v[16:19], v130, v36, v[16:19]
    v_mfma_f32_16x16x4_f32 v[20:23], v130, v37, v[20:23]
    v_mfma_f32_16x16x4_f32 v[24:27], v162, v36, v[24:27]
    v_mfma_f32_16x16x4_f32 v[28:31], v162, v37, v[28:31]
    s_waitcnt lgkmcnt(15)
    v_mfma_f32_16x16x4_f32 v[16:19], v131, v38, v[16:19]
    v_mfma_f32_16x16x4_f32 v[20:23], v131, v39, v[20:23]
    v_mfma_f32_16x16x4_f32 v[24:27], v163, v38, v[24:27]
    v_mfma_f32_16x16x4_f32 v[28:31], v163, v39, v[28:31]
    s_waitcnt lgkmcnt(15)
    v_mfma_f32_16x16x4_f32 v[16:19], v132, v40, v[16:19]
    v_mfma_f32_16x16x4_f32 v[20:23], v132, v41, v[20:23]
    v_mfma_f32_16x16x4_f32 v[24:27], v164, v40, v[24:27]
    v_mfma_f32_16x16x4_f32 v[28:31], v164, v41, v[28:31]
    s_waitcnt lgkmcnt(15)
    v_mfma_f32_16x16x4_f32 v[16:19], v133, v42, v[16:19]
    v_mfma_f32_16x16x4_f32 v[20:23], v133, v43, v[20:23]
    v_mfma_f32_16x16x4_f32 v[24:27], v165, v42, v[24:27]
    v_mfma_f32_16x16x4_f32 v[28:31], v165, v43, v[28:31]
    s_waitcnt lgkmcnt(15)
    v_mfma_f32_16x16x4_f32 v[16:19], v134, v44, v[16:19]
    v_mfma_f32_16x16x4_f32 v[20:23], v134, v45, v[20:23]
    v_mfma_f32_16x16x4_f32 v[24:27], v166, v44, v[24:27]
    v_mfma_f32_16x16x4_f32 v[28:31], v166, v45, v[28:31]
    s_waitcnt lgkmcnt(15)
    v_mfma_f32_16x16x4_f32 v[16:19], v135, v46, v[16:19]
    v_mfma_f32_16x16x4_f32 v[20:23], v135, v47, v[20:23]
    v_mfma_f32_16x16x4_f32 v[24:27], v167, v46, v[24:27]
    v_mfma_f32_16x16x4_f32 v[28:31], v167, v47, v[28:31]
    s_waitcnt lgkmcnt(14)
    v_mfma_f32_16x16x4_f32 v[16:19], v136, v48, v[16:19]
    v_mfma_f32_16x16x4_f32 v[20:23], v136, v49, v[20:23]
    v_mfma_f32_16x16x4_f32 v[24:27], v168, v48, v[24:27]
    v_mfma_f32_16x16x4_f32 v[28:31], v168, v49, v[28:31]
    s_waitcnt lgkmcnt(12)
    v_mfma_f32_16x16x4_f32 v[16:19], v137, v50, v[16:19]
    v_mfma_f32_16x16x4_f32 v[20:23], v137, v51, v[20:23]
    v_mfma_f32_16x16x4_f32 v[24:27], v169, v50, v[24:27]
    v_mfma_f32_16x16x4_f32 v[28:31], v169, v51, v[28:31]
    s_waitcnt lgkmcnt(10)
    v_mfma_f32_16x16x4_f32 v[16:19], v138, v52, v[16:19]
    v_mfma_f32_16x16x4_f32 v[20:23], v138, v53, v[20:23]
    v_mfma_f32_16x16x4_f32 v[24:27], v170, v52, v[24:27]
    v_mfma_f32_16x16x4_f32 v[28:31], v170, v53, v[28:31]
    s_waitcnt lgkmcnt(8)
    v_mfma_f32_16x16x4_f32 v[16:19], v139, v54, v[16:19]
    v_mfma_f32_16x16x4_f32 v[20:23], v139, v55, v[20:23]
    v_mfma_f32_16x16x4_f32 v[24:27], v171, v54, v[24:27]
    v_mfma_f32_16x16x4_f32 v[28:31], v171, v55, v[28:31]
    s_waitcnt lgkmcnt(6)
    v_mfma_f32_16x16x4_f32 v[16:19], v140, v56, v[16:19]
    v_mfma_f32_16x16x4_f32 v[20:23], v140, v57, v[20:23]
    v_mfma_f32_16x16x4_f32 v[24:27], v172, v56, v[24:27]
    v_mfma_f32_16x16x4_f32 v[28:31], v172, v57, v[28:31]
    s_waitcnt lgkmcnt(4)
    v_mfma_f32_16x16x4_f32 v[16:19], v141, v58, v[16:19]
    v_mfma_f32_16x16x4_f32 v[20:23], v141, v59, v[20:23]
    v_mfma_f32_16x16x4_f32 v[24:27], v173, v58, v[24:27]
    v_mfma_f32_16x16x4_f32 v[28:31], v173, v59, v[28:31]
    s_waitcnt lgkmcnt(2)
    v_mfma_f32_16x16x4_f32 v[16:19], v142, v60, v[16:19]
    v_mfma_f32_16x16x4_f32 v[20:23], v142, v61, v[20:23]
    v_mfma_f32_16x16x4_f32 v[24:27], v174, v60, v[24:27]
    v_mfma_f32_16x16x4_f32 v[28:31], v174, v61, v[28:31]
    s_waitcnt lgkmcnt(0)
    v_mfma_f32_16x16x4_f32 v[16:19], v143, v62, v[16:19]
    v_mfma_f32_16x16x4_f32 v[20:23], v143, v63, v[20:23]
    v_mfma_f32_16x16x4_f32 v[24:27], v175, v62, v[24:27]
    v_mfma_f32_16x16x4_f32 v[28:31], v175, v63, v[28:31]
    ds_read_b32 v32, v13 offset:8192
    ds_read_b32 v33, v13 offset:8320
    ds_read_b32 v34, v13 offset:8704
    ds_read_b32 v35, v13 offset:8832
    ds_read_b32 v36, v13 offset:9216
    ds_read_b32 v37, v13 offset:9344
    ds_read_b32 v38, v13 offset:9728
    ds_read_b32 v39, v13 offset:9856
    ds_read_b32 v40, v13 offset:10240
    ds_read_b32 v41, v13 offset:10368
    ds_read_b32 v42, v13 offset:10752
    ds_read_b32 v43, v13 offset:10880
    ds_read_b32 v44, v13 offset:11264
    ds_read_b32 v45, v13 offset:11392
    ds_read_b32 v46, v13 offset:11776
    ds_read_b32 v47, v13 offset:11904
    ds_read_b32 v48, v13 offset:12288
    ds_read_b32 v49, v13 offset:12416
    ds_read_b32 v50, v13 offset:12800
    ds_read_b32 v51, v13 offset:12928
    ds_read_b32 v52, v13 offset:13312
    ds_read_b32 v53, v13 offset:13440
    ds_read_b32 v54, v13 offset:13824
    ds_read_b32 v55, v13 offset:13952
    ds_read_b32 v56, v13 offset:14336
    ds_read_b32 v57, v13 offset:14464
    ds_read_b32 v58, v13 offset:14848
    ds_read_b32 v59, v13 offset:14976
    ds_read_b32 v60, v13 offset:15360
    ds_read_b32 v61, v13 offset:15488
    ds_read_b32 v62, v13 offset:15872
    ds_read_b32 v63, v13 offset:16000
    s_waitcnt lgkmcnt(15)
    v_mfma_f32_16x16x4_f32 v[16:19], v144, v32, v[16:19]
    v_mfma_f32_16x16x4_f32 v[20:23], v144, v33, v[20:23]
    v_mfma_f32_16x16x4_f32 v[24:27], v176, v32, v[24:27]
    v_mfma_f32_16x16x4_f32 v[28:31], v176, v33, v[28:31]
    s_waitcnt lgkmcnt(15)
    v_mfma_f32_16x16x4_f32 v[16:19], v145, v34, v[16:19]
    v_mfma_f32_16x16x4_f32 v[20:23], v145, v35, v[20:23]
    v_mfma_f32_16x16x4_f32 v[24:27], v177, v34, v[24:27]
    v_mfma_f32_16x16x4_f32 v[28:31], v177, v35, v[28:31]
    s_waitcnt lgkmcnt(15)
    v_mfma_f32_16x16x4_f32 v[16:19], v146, v36, v[16:19]
    v_mfma_f32_16x16x4_f32 v[20:23], v146, v37, v[20:23]
    v_mfma_f32_16x16x4_f32 v[24:27], v178, v36, v[24:27]
    v_mfma_f32_16x16x4_f32 v[28:31], v178, v37, v[28:31]
    s_waitcnt lgkmcnt(15)
    v_mfma_f32_16x16x4_f32 v[16:19], v147, v38, v[16:19]
    v_mfma_f32_16x16x4_f32 v[20:23], v147, v39, v[20:23]
    v_mfma_f32_16x16x4_f32 v[24:27], v179, v38, v[24:27]
    v_mfma_f32_16x16x4_f32 v[28:31], v179, v39, v[28:31]
    s_waitcnt lgkmcnt(15)
    v_mfma_f32_16x16x4_f32 v[16:19], v148, v40, v[16:19]
    v_mfma_f32_16x16x4_f32 v[20:23], v148, v41, v[20:23]
    v_mfma_f32_16x16x4_f32 v[24:27], v180, v40, v[24:27]
    v_mfma_f32_16x16x4_f32 v[28:31], v180, v41, v[28:31]
    s_waitcnt lgkmcnt(15)
    v_mfma_f32_16x16x4_f32 v[16:19], v149, v42, v[16:19]
    v_mfma_f32_16x16x4_f32 v[20:23], v149, v43, v[20:23]
    v_mfma_f32_16x16x4_f32 v[24:27], v181, v42, v[24:27]
    v_mfma_f32_16x16x4_f32 v[28:31], v181, v43, v[28:31]
    s_waitcnt lgkmcnt(15)
    v_mfma_f32_16x16x4_f32 v[16:19], v150, v44, v[16:19]
    v_mfma_f32_16x16x4_f32 v[20:23], v150, v45, v[20:23]
    v_mfma_f32_16x16x4_f32 v[24:27], v182, v44, v[24:27]
    v_mfma_f32_16x16x4_f32 v[28:31], v182, v45, v[28:31]
    s_waitcnt lgkmcnt(15)
    v_mfma_f32_16x16x4_f32 v[16:19], v151, v46, v[16:19]
    v_mfma_f32_16x16x4_f32 v[20:23], v151, v47, v[20:23]
    v_mfma_f32_16x16x4_f32 v[24:27], v183, v46, v[24:27]
    v_mfma_f32_16x16x4_f32 v[28:31], v183, v47, v[28:31]
    s_waitcnt lgkmcnt(14)
    v_mfma_f32_16x16x4_f32 v[16:19], v152, v48, v[16:19]
    v_mfma_f32_16x16x4_f32 v[20:23], v152, v49, v[20:23]
    v_mfma_f32_16x16x4_f32 v[24:27], v184, v48, v[24:27]
    v_mfma_f32_16x16x4_f32 v[28:31], v184, v49, v[28:31]
    s_waitcnt lgkmcnt(12)
    v_mfma_f32_16x16x4_f32 v[16:19], v153, v50, v[16:19]
    v_mfma_f32_16x16x4_f32 v[20:23], v153, v51, v[20:23]
    v_mfma_f32_16x16x4_f32 v[24:27], v185, v50, v[24:27]
    v_mfma_f32_16x16x4_f32 v[28:31], v185, v51, v[28:31]
    s_waitcnt lgkmcnt(10)
    v_mfma_f32_16x16x4_f32 v[16:19], v154, v52, v[16:19]
    v_mfma_f32_16x16x4_f32 v[20:23], v154, v53, v[20:23]
    v_mfma_f32_16x16x4_f32 v[24:27], v186, v52, v[24:27]
    v_mfma_f32_16x16x4_f32 v[28:31], v186, v53, v[28:31]
    s_waitcnt lgkmcnt(8)
    v_mfma_f32_16x16x4_f32 v[16:19], v155, v54, v[16:19]
    v_mfma_f32_16x16x4_f32 v[20:23], v155, v55, v[20:23]
    v_mfma_f32_16x16x4_f32 v[24:27], v187, v54, v[24:27]
    v_mfma_f32_16x16x4_f32 v[28:31], v187, v55, v[28:31]
    s_waitcnt lgkmcnt(6)
    v_mfma_f32_16x16x4_f32 v[16:19], v156, v56, v[16:19]
    v_mfma_f32_16x16x4_f32 v[20:23], v156, v57, v[20:23]
    v_mfma_f32_16x16x4_f32 v[24:27], v188, v56, v[24:27]
    v_mfma_f32_16x16x4_f32 v[28:31], v188, v57, v[28:31]
    s_waitcnt lgkmcnt(4)
    v_mfma_f32_16x16x4_f32 v[16:19], v157, v58, v[16:19]
    v_mfma_f32_16x16x4_f32 v[20:23], v157, v59, v[20:23]
    v_mfma_f32_16x16x4_f32 v[24:27], v189, v58, v[24:27]
    v_mfma_f32_16x16x4_f32 v[28:31], v189, v59, v[28:31]
    s_waitcnt lgkmcnt(2)
    v_mfma_f32_16x16x4_f32 v[16:19], v158, v60, v[16:19]
    v_mfma_f32_16x16x4_f32 v[20:23], v158, v61, v[20:23]
    v_mfma_f32_16x16x4_f32 v[24:27], v190, v60, v[24:27]
    v_mfma_f32_16x16x4_f32 v[28:31], v190, v61, v[28:31]
    s_waitcnt lgkmcnt(0)
    v_mfma_f32_16x16x4_f32 v[16:19], v159, v62, v[16:19]
    v_mfma_f32_16x16x4_f32 v[20:23], v159, v63, v[20:23]
    v_mfma_f32_16x16x4_f32 v[24:27], v191, v62, v[24:27]
    v_mfma_f32_16x16x4_f32 v[28:31], v191, v63, v[28:31]
    s_nop 7
    s_nop 3
    v_lshlrev_b32 v65, 9, v3
    v_lshl_add_u32 v65, v64, 3, v65
    v_add_u32 v66, 0, v3
    v_add_u32 v67, 0, v64
    v_mul_u32_u24 v66, v66, v67
    v_cvt_f32_u32 v66, v66
    v_mul_f32 v66, s36, v66
    v_cos_f32 v68, v66
    v_sin_f32 v69, v66
    s_nop 0
    v_mul_f32 v70, v16, v68
    v_mul_f32 v71, v17, v68
    v_fma_f32 v70, v17, v69, v70
    v_fma_f32 v17, -v16, v69, v71
    v_mov_b32 v16, v70
    v_add_u32 v66, 0, v3
    v_add_u32 v67, 1, v64
    v_mul_u32_u24 v66, v66, v67
    v_cvt_f32_u32 v66, v66
    v_mul_f32 v66, s36, v66
    v_cos_f32 v68, v66
    v_sin_f32 v69, v66
    s_nop 0
    v_mul_f32 v70, v18, v68
    v_mul_f32 v71, v19, v68
    v_fma_f32 v70, v19, v69, v70
    v_fma_f32 v19, -v18, v69, v71
    v_mov_b32 v18, v70
    ds_write_b128 v65, v[16:19] offset:16384
    v_add_u32 v66, 16, v3
    v_add_u32 v67, 0, v64
    v_mul_u32_u24 v66, v66, v67
    v_cvt_f32_u32 v66, v66
    v_mul_f32 v66, s36, v66
    v_cos_f32 v68, v66
    v_sin_f32 v69, v66
    s_nop 0
    v_mul_f32 v70, v20, v68
    v_mul_f32 v71, v21, v68
    v_fma_f32 v70, v21, v69, v70
    v_fma_f32 v21, -v20, v69, v71
    v_mov_b32 v20, v70
    v_add_u32 v66, 16, v3
    v_add_u32 v67, 1, v64
    v_mul_u32_u24 v66, v66, v67
    v_cvt_f32_u32 v66, v66
    v_mul_f32 v66, s36, v66
    v_cos_f32 v68, v66
    v_sin_f32 v69, v66
    s_nop 0
    v_mul_f32 v70, v22, v68
    v_mul_f32 v71, v23, v68
    v_fma_f32 v70, v23, v69, v70
    v_fma_f32 v23, -v22, v69, v71
    v_mov_b32 v22, v70
    ds_write_b128 v65, v[20:23] offset:24576
    v_add_u32 v66, 0, v3
    v_add_u32 v67, 8, v64
    v_mul_u32_u24 v66, v66, v67
    v_cvt_f32_u32 v66, v66
    v_mul_f32 v66, s36, v66
    v_cos_f32 v68, v66
    v_sin_f32 v69, v66
    s_nop 0
    v_mul_f32 v70, v24, v68
    v_mul_f32 v71, v25, v68
    v_fma_f32 v70, v25, v69, v70
    v_fma_f32 v25, -v24, v69, v71
    v_mov_b32 v24, v70
    v_add_u32 v66, 0, v3
    v_add_u32 v67, 9, v64
    v_mul_u32_u24 v66, v66, v67
    v_cvt_f32_u32 v66, v66
    v_mul_f32 v66, s36, v66
    v_cos_f32 v68, v66
    v_sin_f32 v69, v66
    s_nop 0
    v_mul_f32 v70, v26, v68
    v_mul_f32 v71, v27, v68
    v_fma_f32 v70, v27, v69, v70
    v_fma_f32 v27, -v26, v69, v71
    v_mov_b32 v26, v70
    ds_write_b128 v65, v[24:27] offset:16448
    v_add_u32 v66, 16, v3
    v_add_u32 v67, 8, v64
    v_mul_u32_u24 v66, v66, v67
    v_cvt_f32_u32 v66, v66
    v_mul_f32 v66, s36, v66
    v_cos_f32 v68, v66
    v_sin_f32 v69, v66
    s_nop 0
    v_mul_f32 v70, v28, v68
    v_mul_f32 v71, v29, v68
    v_fma_f32 v70, v29, v69, v70
    v_fma_f32 v29, -v28, v69, v71
    v_mov_b32 v28, v70
    v_add_u32 v66, 16, v3
    v_add_u32 v67, 9, v64
    v_mul_u32_u24 v66, v66, v67
    v_cvt_f32_u32 v66, v66
    v_mul_f32 v66, s36, v66
    v_cos_f32 v68, v66
    v_sin_f32 v69, v66
    s_nop 0
    v_mul_f32 v70, v30, v68
    v_mul_f32 v71, v31, v68
    v_fma_f32 v70, v31, v69, v70
    v_fma_f32 v31, -v30, v69, v71
    v_mov_b32 v30, v70
    ds_write_b128 v65, v[28:31] offset:24640
    s_waitcnt lgkmcnt(0)
    s_barrier
    v_mov_b32 v16, 0
    v_mov_b32 v17, 0
    v_mov_b32 v18, 0
    v_mov_b32 v19, 0
    v_mov_b32 v20, 0
    v_mov_b32 v21, 0
    v_mov_b32 v22, 0
    v_mov_b32 v23, 0
    v_mov_b32 v24, 0
    v_mov_b32 v25, 0
    v_mov_b32 v26, 0
    v_mov_b32 v27, 0
    v_mov_b32 v28, 0
    v_mov_b32 v29, 0
    v_mov_b32 v30, 0
    v_mov_b32 v31, 0
    ds_read_b32 v32, v12 offset:16384
    ds_read_b32 v33, v12 offset:16512
    ds_read_b32 v34, v12 offset:16640
    ds_read_b32 v35, v12 offset:16768
    ds_read_b32 v36, v12 offset:17408
    ds_read_b32 v37, v12 offset:17536
    ds_read_b32 v38, v12 offset:17664
    ds_read_b32 v39, v12 offset:17792
    ds_read_b32 v40, v12 offset:18432
    ds_read_b32 v41, v12 offset:18560
    ds_read_b32 v42, v12 offset:18688
    ds_read_b32 v43, v12 offset:18816
    ds_read_b32 v44, v12 offset:19456
    ds_read_b32 v45, v12 offset:19584
    ds_read_b32 v46, v12 offset:19712
    ds_read_b32 v47, v12 offset:19840
    ds_read_b32 v48, v12 offset:20480
    ds_read_b32 v49, v12 offset:20608
    ds_read_b32 v50, v12 offset:20736
    ds_read_b32 v51, v12 offset:20864
    ds_read_b32 v52, v12 offset:21504
    ds_read_b32 v53, v12 offset:21632
    ds_read_b32 v54, v12 offset:21760
    ds_read_b32 v55, v12 offset:21888
    ds_read_b32 v56, v12 offset:22528
    ds_read_b32 v57, v12 offset:22656
    ds_read_b32 v58, v12 offset:22784
    ds_read_b32 v59, v12 offset:22912
    ds_read_b32 v60, v12 offset:23552
    ds_read_b32 v61, v12 offset:23680
    ds_read_b32 v62, v12 offset:23808
    ds_read_b32 v63, v12 offset:23936
    s_waitcnt lgkmcnt(15)
    v_mfma_f32_16x16x4_f32 v[16:19], v112, v32, v[16:19]
    v_mfma_f32_16x16x4_f32 v[20:23], v112, v33, v[20:23]
    v_mfma_f32_16x16x4_f32 v[24:27], v112, v34, v[24:27]
    v_mfma_f32_16x16x4_f32 v[28:31], v112, v35, v[28:31]
    s_waitcnt lgkmcnt(15)
    v_mfma_f32_16x16x4_f32 v[16:19], v113, v36, v[16:19]
    v_mfma_f32_16x16x4_f32 v[20:23], v113, v37, v[20:23]
    v_mfma_f32_16x16x4_f32 v[24:27], v113, v38, v[24:27]
    v_mfma_f32_16x16x4_f32 v[28:31], v113, v39, v[28:31]
    s_waitcnt lgkmcnt(15)
    v_mfma_f32_16x16x4_f32 v[16:19], v114, v40, v[16:19]
    v_mfma_f32_16x16x4_f32 v[20:23], v114, v41, v[20:23]
    v_mfma_f32_16x16x4_f32 v[24:27], v114, v42, v[24:27]
    v_mfma_f32_16x16x4_f32 v[28:31], v114, v43, v[28:31]
    s_waitcnt lgkmcnt(15)
    v_mfma_f32_16x16x4_f32 v[16:19], v115, v44, v[16:19]
    v_mfma_f32_16x16x4_f32 v[20:23], v115, v45, v[20:23]
    v_mfma_f32_16x16x4_f32 v[24:27], v115, v46, v[24:27]
    v_mfma_f32_16x16x4_f32 v[28:31], v115, v47, v[28:31]
    s_waitcnt lgkmcnt(12)
    v_mfma_f32_16x16x4_f32 v[16:19], v116, v48, v[16:19]
    v_mfma_f32_16x16x4_f32 v[20:23], v116, v49, v[20:23]
    v_mfma_f32_16x16x4_f32 v[24:27], v116, v50, v[24:27]
    v_mfma_f32_16x16x4_f32 v[28:31], v116, v51, v[28:31]
    s_waitcnt lgkmcnt(8)
    v_mfma_f32_16x16x4_f32 v[16:19], v117, v52, v[16:19]
    v_mfma_f32_16x16x4_f32 v[20:23], v117, v53, v[20:23]
    v_mfma_f32_16x16x4_f32 v[24:27], v117, v54, v[24:27]
    v_mfma_f32_16x16x4_f32 v[28:31], v117, v55, v[28:31]
    s_waitcnt lgkmcnt(4)
    v_mfma_f32_16x16x4_f32 v[16:19], v118, v56, v[16:19]
    v_mfma_f32_16x16x4_f32 v[20:23], v118, v57, v[20:23]
    v_mfma_f32_16x16x4_f32 v[24:27], v118, v58, v[24:27]
    v_mfma_f32_16x16x4_f32 v[28:31], v118, v59, v[28:31]
    s_waitcnt lgkmcnt(0)
    v_mfma_f32_16x16x4_f32 v[16:19], v119, v60, v[16:19]
    v_mfma_f32_16x16x4_f32 v[20:23], v119, v61, v[20:23]
    v_mfma_f32_16x16x4_f32 v[24:27], v119, v62, v[24:27]
    v_mfma_f32_16x16x4_f32 v[28:31], v119, v63, v[28:31]
    ds_read_b32 v32, v12 offset:24576
    ds_read_b32 v33, v12 offset:24704
    ds_read_b32 v34, v12 offset:24832
    ds_read_b32 v35, v12 offset:24960
    ds_read_b32 v36, v12 offset:25600
    ds_read_b32 v37, v12 offset:25728
    ds_read_b32 v38, v12 offset:25856
    ds_read_b32 v39, v12 offset:25984
    ds_read_b32 v40, v12 offset:26624
    ds_read_b32 v41, v12 offset:26752
    ds_read_b32 v42, v12 offset:26880
    ds_read_b32 v43, v12 offset:27008
    ds_read_b32 v44, v12 offset:27648
    ds_read_b32 v45, v12 offset:27776
    ds_read_b32 v46, v12 offset:27904
    ds_read_b32 v47, v12 offset:28032
    ds_read_b32 v48, v12 offset:28672
    ds_read_b32 v49, v12 offset:28800
    ds_read_b32 v50, v12 offset:28928
    ds_read_b32 v51, v12 offset:29056
    ds_read_b32 v52, v12 offset:29696
    ds_read_b32 v53, v12 offset:29824
    ds_read_b32 v54, v12 offset:29952
    ds_read_b32 v55, v12 offset:30080
    ds_read_b32 v56, v12 offset:30720
    ds_read_b32 v57, v12 offset:30848
    ds_read_b32 v58, v12 offset:30976
    ds_read_b32 v59, v12 offset:31104
    ds_read_b32 v60, v12 offset:31744
    ds_read_b32 v61, v12 offset:31872
    ds_read_b32 v62, v12 offset:32000
    ds_read_b32 v63, v12 offset:32128
    s_waitcnt lgkmcnt(15)
    v_mfma_f32_16x16x4_f32 v[16:19], v120, v32, v[16:19]
    v_mfma_f32_16x16x4_f32 v[20:23], v120, v33, v[20:23]
    v_mfma_f32_16x16x4_f32 v[24:27], v120, v34, v[24:27]
    v_mfma_f32_16x16x4_f32 v[28:31], v120, v35, v[28:31]
    s_waitcnt lgkmcnt(15)
    v_mfma_f32_16x16x4_f32 v[16:19], v121, v36, v[16:19]
    v_mfma_f32_16x16x4_f32 v[20:23], v121, v37, v[20:23]
    v_mfma_f32_16x16x4_f32 v[24:27], v121, v38, v[24:27]
    v_mfma_f32_16x16x4_f32 v[28:31], v121, v39, v[28:31]
    s_waitcnt lgkmcnt(15)
    v_mfma_f32_16x16x4_f32 v[16:19], v122, v40, v[16:19]
    v_mfma_f32_16x16x4_f32 v[20:23], v122, v41, v[20:23]
    v_mfma_f32_16x16x4_f32 v[24:27], v122, v42, v[24:27]
    v_mfma_f32_16x16x4_f32 v[28:31], v122, v43, v[28:31]
    s_waitcnt lgkmcnt(15)
    v_mfma_f32_16x16x4_f32 v[16:19], v123, v44, v[16:19]
    v_mfma_f32_16x16x4_f32 v[20:23], v123, v45, v[20:23]
    v_mfma_f32_16x16x4_f32 v[24:27], v123, v46, v[24:27]
    v_mfma_f32_16x16x4_f32 v[28:31], v123, v47, v[28:31]
    s_waitcnt lgkmcnt(12)
    v_mfma_f32_16x16x4_f32 v[16:19], v124, v48, v[16:19]
    v_mfma_f32_16x16x4_f32 v[20:23], v124, v49, v[20:23]
    v_mfma_f32_16x16x4_f32 v[24:27], v124, v50, v[24:27]
    v_mfma_f32_16x16x4_f32 v[28:31], v124, v51, v[28:31]
    s_waitcnt lgkmcnt(8)
    v_mfma_f32_16x16x4_f32 v[16:19], v125, v52, v[16:19]
    v_mfma_f32_16x16x4_f32 v[20:23], v125, v53, v[20:23]
    v_mfma_f32_16x16x4_f32 v[24:27], v125, v54, v[24:27]
    v_mfma_f32_16x16x4_f32 v[28:31], v125, v55, v[28:31]
    s_waitcnt lgkmcnt(4)
    v_mfma_f32_16x16x4_f32 v[16:19], v126, v56, v[16:19]
    v_mfma_f32_16x16x4_f32 v[20:23], v126, v57, v[20:23]
    v_mfma_f32_16x16x4_f32 v[24:27], v126, v58, v[24:27]
    v_mfma_f32_16x16x4_f32 v[28:31], v126, v59, v[28:31]
    s_waitcnt lgkmcnt(0)
    v_mfma_f32_16x16x4_f32 v[16:19], v127, v60, v[16:19]
    v_mfma_f32_16x16x4_f32 v[20:23], v127, v61, v[20:23]
    v_mfma_f32_16x16x4_f32 v[24:27], v127, v62, v[24:27]
    v_mfma_f32_16x16x4_f32 v[28:31], v127, v63, v[28:31]
    s_nop 7
    s_nop 3
    v_lshl_add_u32 v64, v4, 1, s37
    v_lshlrev_b32 v65, 9, v64
    v_lshl_add_u32 v65, v3, 3, v65
    v_xor_b32 v17, 0x80000000, v17
    buffer_store_dwordx2 v[16:17], v65, s[16:19], s30 offen offset:0 sc1
    v_xor_b32 v19, 0x80000000, v19
    buffer_store_dwordx2 v[18:19], v65, s[16:19], s30 offen offset:512 sc1
    v_xor_b32 v21, 0x80000000, v21
    buffer_store_dwordx2 v[20:21], v65, s[16:19], s30 offen offset:128 sc1
    v_xor_b32 v23, 0x80000000, v23
    buffer_store_dwordx2 v[22:23], v65, s[16:19], s30 offen offset:640 sc1
    v_xor_b32 v25, 0x80000000, v25
    buffer_store_dwordx2 v[24:25], v65, s[16:19], s30 offen offset:256 sc1
    v_xor_b32 v27, 0x80000000, v27
    buffer_store_dwordx2 v[26:27], v65, s[16:19], s30 offen offset:768 sc1
    v_xor_b32 v29, 0x80000000, v29
    buffer_store_dwordx2 v[28:29], v65, s[16:19], s30 offen offset:384 sc1
    v_xor_b32 v31, 0x80000000, v31
    buffer_store_dwordx2 v[30:31], v65, s[16:19], s30 offen offset:896 sc1
    s_branch .wloop_21
.tF3_28:
    s_cmp_lt_u32 s94, 2273
    s_cbranch_scc0 .tTO_32
    s_sub_u32 s3, s94, 2113
    s_mul_i32 s93, s3, 52429
    s_lshr_b32 s93, s93, 18
    s_lshl_b32 s93, s93, 6
    s_add_u32 s93, s93, 109054080
    s_cmp_lg_u32 s39, 0
    s_cbranch_scc1 .wsk_44
    s_mov_b32 s100, 109054016
    v_mov_b32 v250, s100
    s_mov_b32 s101, 0
.ww_45:
    buffer_load_dword v251, v250, s[16:19], 0 offen sc1
    s_waitcnt vmcnt(0)
    v_readfirstlane_b32 s100, v251
    s_cmp_ge_u32 s100, 321
    s_cbranch_scc1 .wok_46
    s_add_u32 s101, s101, 1
    s_cmp_gt_u32 s101, 200000
    s_cbranch_scc1 .fexit_3
    s_sleep 40
    s_branch .ww_45
.wok_46:
.wsk_44:
    s_barrier
    v_and_b32 v1, 63, v0
    v_lshrrev_b32 v2, 6, v0
    s_nop 0
    v_readfirstlane_b32 s6, v2
    v_and_b32 v3, 15, v1
    v_lshrrev_b32 v4, 4, v1
    s_mul_i32 s30, s3, 52429
    s_lshr_b32 s30, s30, 18
    s_mul_i32 s31, s30, 5
    s_sub_u32 s31, s3, s31
    v_add_u32 v10, 0, v0
    v_cvt_f32_u32 v11, v10
    v_mul_f32 v11, 0x3acccccd, v11
    v_cos_f32 v11, v11
    v_lshlrev_b32 v10, 2, v10
    v_cmp_gt_u32 vcc, 2560, v10
    s_and_saveexec_b64 s[84:85], vcc
    ds_write_b32 v10, v11 offset:0
    s_mov_b64 exec, s[84:85]
    v_add_u32 v10, 256, v0
    v_cvt_f32_u32 v11, v10
    v_mul_f32 v11, 0x3acccccd, v11
    v_cos_f32 v11, v11
    v_lshlrev_b32 v10, 2, v10
    v_cmp_gt_u32 vcc, 2560, v10
    s_and_saveexec_b64 s[84:85], vcc
    ds_write_b32 v10, v11 offset:0
    s_mov_b64 exec, s[84:85]
    v_add_u32 v10, 512, v0
    v_cvt_f32_u32 v11, v10
    v_mul_f32 v11, 0x3acccccd, v11
    v_cos_f32 v11, v11
    v_lshlrev_b32 v10, 2, v10
    v_cmp_gt_u32 vcc, 2560, v10
    s_and_saveexec_b64 s[84:85], vcc
    ds_write_b32 v10, v11 offset:0
    s_mov_b64 exec, s[84:85]
    v_lshrrev_b32 v5, 2, v3
    v_and_b32 v6, 3, v3
    v_lshl_add_u32 v5, v5, 3, v6
    s_lshl_b32 s7, s31, 7
    v_add_u32 v5, s7, v5
    v_lshrrev_b32 v6, 1, v4
    v_and_b32 v7, 1, v4
    v_mul_u32_u24 v7, 640, v7
    v_add_u32 v8, 0, v5
    v_mul_u32_u24 v9, v8, v6
    v_lshl_add_u32 v16, v9, 2, v7
    v_lshlrev_b32 v24, 3, v8
    v_subrev_u32 v9, 2560, v16
    v_min_u32 v16, v16, v9
    v_subrev_u32 v9, 2560, v24
    v_min_u32 v24, v24, v9
    v_add_u32 v8, 4, v5
    v_mul_u32_u24 v9, v8, v6
    v_lshl_add_u32 v17, v9, 2, v7
    v_lshlrev_b32 v25, 3, v8
    v_subrev_u32 v9, 2560, v17
    v_min_u32 v17, v17, v9
    v_subrev_u32 v9, 2560, v25
    v_min_u32 v25, v25, v9
    v_add_u32 v8, 32, v5
    v_mul_u32_u24 v9, v8, v6
    v_lshl_add_u32 v18, v9, 2, v7
    v_lshlrev_b32 v26, 3, v8
    v_subrev_u32 v9, 2560, v18
    v_min_u32 v18, v18, v9
    v_subrev_u32 v9, 2560, v26
    v_min_u32 v26, v26, v9
    v_add_u32 v8, 36, v5
    v_mul_u32_u24 v9, v8, v6
    v_lshl_add_u32 v19, v9, 2, v7
    v_lshlrev_b32 v27, 3, v8
    v_subrev_u32 v9, 2560, v19
    v_min_u32 v19, v19, v9
    v_subrev_u32 v9, 2560, v27
    v_min_u32 v27, v27, v9
    v_add_u32 v8, 64, v5
    v_mul_u32_u24 v9, v8, v6
    v_lshl_add_u32 v20, v9, 2, v7
    v_lshlrev_b32 v28, 3, v8
    v_subrev_u32 v9, 2560, v20
    v_min_u32 v20, v20, v9
    v_subrev_u32 v9, 2560, v28
    v_min_u32 v28, v28, v9
    v_add_u32 v8, 68, v5
    v_mul_u32_u24 v9, v8, v6
    v_lshl_add_u32 v21, v9, 2, v7
    v_lshlrev_b32 v29, 3, v8
    v_subrev_u32 v9, 2560, v21
    v_min_u32 v21, v21, v9
    v_subrev_u32 v9, 2560, v29
    v_min_u32 v29, v29, v9
    v_add_u32 v8, 96, v5
    v_mul_u32_u24 v9, v8, v6
    v_lshl_add_u32 v22, v9, 2, v7
    v_lshlrev_b32 v30, 3, v8
    v_subrev_u32 v9, 2560, v22
    v_min_u32 v22, v22, v9
    v_subrev_u32 v9, 2560, v30
    v_min_u32 v30, v30, v9
    v_add_u32 v8, 100, v5
    v_mul_u32_u24 v9, v8, v6
    v_lshl_add_u32 v23, v9, 2, v7
    v_lshlrev_b32 v31, 3, v8
    v_subrev_u32 v9, 2560, v23
    v_min_u32 v23, v23, v9
    v_subrev_u32 v9, 2560, v31
    v_min_u32 v31, v31, v9
    s_lshl_b32 s7, s30, 6
    s_lshl_b32 s32, s6, 4
    s_add_u32 s7, s7, s32
    s_lshl_b32 s33, s7, 3
    s_add_u32 s33, s33, 75497472
    v_lshlrev_b32 v14, 14, v6
    v_lshl_add_u32 v14, v3, 3, v14
    v_and_b32 v8, 1, v4
    v_lshl_add_u32 v14, v8, 2, v14
    v_add_u32 v14, s33, v14
    v_cmp_eq_u32 vcc, 0, v6
    v_mov_b32 v9, 1.0
    s_nop 0
    v_cndmask_b32 v12, v9, 0.5, vcc
    v_cndmask_b32 v13, 0, 0.5, vcc
    s_mov_b32 s34, 0
    v_mov_b32 v64, 0
    v_mov_b32 v65, 0
    v_mov_b32 v66, 0
    v_mov_b32 v67, 0
    v_mov_b32 v68, 0
    v_mov_b32 v69, 0
    v_mov_b32 v70, 0
    v_mov_b32 v71, 0
    v_mov_b32 v72, 0
    v_mov_b32 v73, 0
    v_mov_b32 v74, 0
    v_mov_b32 v75, 0
    v_mov_b32 v76, 0
    v_mov_b32 v77, 0
    v_mov_b32 v78, 0
    v_mov_b32 v79, 0
    v_mov_b32 v80, 0
    v_mov_b32 v81, 0
    v_mov_b32 v82, 0
    v_mov_b32 v83, 0
    v_mov_b32 v84, 0
    v_mov_b32 v85, 0
    v_mov_b32 v86, 0
    v_mov_b32 v87, 0
    v_mov_b32 v88, 0
    v_mov_b32 v89, 0
    v_mov_b32 v90, 0
    v_mov_b32 v91, 0
    v_mov_b32 v92, 0
    v_mov_b32 v93, 0
    v_mov_b32 v94, 0
    v_mov_b32 v95, 0
    buffer_load_dword v96, v14, s[16:19], s34 offen sc1
    s_add_u32 s34, s34, 32768
    buffer_load_dword v97, v14, s[16:19], s34 offen sc1
    s_add_u32 s34, s34, 32768
    buffer_load_dword v98, v14, s[16:19], s34 offen sc1
    s_add_u32 s34, s34, 32768
    buffer_load_dword v99, v14, s[16:19], s34 offen sc1
    s_add_u32 s34, s34, 32768
    buffer_load_dword v100, v14, s[16:19], s34 offen sc1
    s_add_u32 s34, s34, 32768
    buffer_load_dword v101, v14, s[16:19], s34 offen sc1
    s_add_u32 s34, s34, 32768
    buffer_load_dword v102, v14, s[16:19], s34 offen sc1
    s_add_u32 s34, s34, 32768
    buffer_load_dword v103, v14, s[16:19], s34 offen sc1
    s_add_u32 s34, s34, 32768
    s_waitcnt lgkmcnt(0)
    s_barrier
    ds_read_b32 v32, v16
    ds_read_b32 v33, v17
    ds_read_b32 v34, v18
    ds_read_b32 v35, v19
    ds_read_b32 v36, v20
    ds_read_b32 v37, v21
    ds_read_b32 v38, v22
    ds_read_b32 v39, v23
    v_add_u32 v16, v16, v24
    v_subrev_u32 v9, 2560, v16
    v_min_u32 v16, v16, v9
    v_add_u32 v17, v17, v25
    v_subrev_u32 v9, 2560, v17
    v_min_u32 v17, v17, v9
    v_add_u32 v18, v18, v26
    v_subrev_u32 v9, 2560, v18
    v_min_u32 v18, v18, v9
    v_add_u32 v19, v19, v27
    v_subrev_u32 v9, 2560, v19
    v_min_u32 v19, v19, v9
    v_add_u32 v20, v20, v28
    v_subrev_u32 v9, 2560, v20
    v_min_u32 v20, v20, v9
    v_add_u32 v21, v21, v29
    v_subrev_u32 v9, 2560, v21
    v_min_u32 v21, v21, v9
    v_add_u32 v22, v22, v30
    v_subrev_u32 v9, 2560, v22
    v_min_u32 v22, v22, v9
    v_add_u32 v23, v23, v31
    v_subrev_u32 v9, 2560, v23
    v_min_u32 v23, v23, v9
    s_mov_b32 s35, 0
    s_waitcnt vmcnt(0)
    v_mul_f32 v96, v96, v12
.f3l_47:
    buffer_load_dword v104, v14, s[16:19], s34 offen sc1
    s_add_u32 s34, s34, 32768
    buffer_load_dword v105, v14, s[16:19], s34 offen sc1
    s_add_u32 s34, s34, 32768
    buffer_load_dword v106, v14, s[16:19], s34 offen sc1
    s_add_u32 s34, s34, 32768
    buffer_load_dword v107, v14, s[16:19], s34 offen sc1
    s_add_u32 s34, s34, 32768
    buffer_load_dword v108, v14, s[16:19], s34 offen sc1
    s_add_u32 s34, s34, 32768
    buffer_load_dword v109, v14, s[16:19], s34 offen sc1
    s_add_u32 s34, s34, 32768
    buffer_load_dword v110, v14, s[16:19], s34 offen sc1
    s_add_u32 s34, s34, 32768
    buffer_load_dword v111, v14, s[16:19], s34 offen sc1
    s_add_u32 s34, s34, 32768
    ds_read_b32 v40, v16
    ds_read_b32 v41, v17
    ds_read_b32 v42, v18
    ds_read_b32 v43, v19
    ds_read_b32 v44, v20
    ds_read_b32 v45, v21
    ds_read_b32 v46, v22
    ds_read_b32 v47, v23
    v_add_u32 v16, v16, v24
    v_subrev_u32 v9, 2560, v16
    v_min_u32 v16, v16, v9
    v_add_u32 v17, v17, v25
    v_subrev_u32 v9, 2560, v17
    v_min_u32 v17, v17, v9
    v_add_u32 v18, v18, v26
    v_subrev_u32 v9, 2560, v18
    v_min_u32 v18, v18, v9
    v_add_u32 v19, v19, v27
    v_subrev_u32 v9, 2560, v19
    v_min_u32 v19, v19, v9
    v_add_u32 v20, v20, v28
    v_subrev_u32 v9, 2560, v20
    v_min_u32 v20, v20, v9
    v_add_u32 v21, v21, v29
    v_subrev_u32 v9, 2560, v21
    v_min_u32 v21, v21, v9
    v_add_u32 v22, v22, v30
    v_subrev_u32 v9, 2560, v22
    v_min_u32 v22, v22, v9
    v_add_u32 v23, v23, v31
    v_subrev_u32 v9, 2560, v23
    v_min_u32 v23, v23, v9
    s_waitcnt lgkmcnt(8)
    v_mfma_f32_16x16x4_f32 v[64:67], v32, v96, v[64:67]
    v_mfma_f32_16x16x4_f32 v[68:71], v33, v96, v[68:71]
    v_mfma_f32_16x16x4_f32 v[72:75], v34, v96, v[72:75]
    v_mfma_f32_16x16x4_f32 v[76:79], v35, v96, v[76:79]
    v_mfma_f32_16x16x4_f32 v[80:83], v36, v96, v[80:83]
    v_mfma_f32_16x16x4_f32 v[84:87], v37, v96, v[84:87]
    v_mfma_f32_16x16x4_f32 v[88:91], v38, v96, v[88:91]
    v_mfma_f32_16x16x4_f32 v[92:95], v39, v96, v[92:95]
    ds_read_b32 v32, v16
    ds_read_b32 v33, v17
    ds_read_b32 v34, v18
    ds_read_b32 v35, v19
    ds_read_b32 v36, v20
    ds_read_b32 v37, v21
    ds_read_b32 v38, v22
    ds_read_b32 v39, v23
    v_add_u32 v16, v16, v24
    v_subrev_u32 v9, 2560, v16
    v_min_u32 v16, v16, v9
    v_add_u32 v17, v17, v25
    v_subrev_u32 v9, 2560, v17
    v_min_u32 v17, v17, v9
    v_add_u32 v18, v18, v26
    v_subrev_u32 v9, 2560, v18
    v_min_u32 v18, v18, v9
    v_add_u32 v19, v19, v27
    v_subrev_u32 v9, 2560, v19
    v_min_u32 v19, v19, v9
    v_add_u32 v20, v20, v28
    v_subrev_u32 v9, 2560, v20
    v_min_u32 v20, v20, v9
    v_add_u32 v21, v21, v29
    v_subrev_u32 v9, 2560, v21
    v_min_u32 v21, v21, v9
    v_add_u32 v22, v22, v30
    v_subrev_u32 v9, 2560, v22
    v_min_u32 v22, v22, v9
    v_add_u32 v23, v23, v31
    v_subrev_u32 v9, 2560, v23
    v_min_u32 v23, v23, v9
    s_waitcnt lgkmcnt(8)
    v_mfma_f32_16x16x4_f32 v[64:67], v40, v97, v[64:67]
    v_mfma_f32_16x16x4_f32 v[68:71], v41, v97, v[68:71]
    v_mfma_f32_16x16x4_f32 v[72:75], v42, v97, v[72:75]
    v_mfma_f32_16x16x4_f32 v[76:79], v43, v97, v[76:79]
    v_mfma_f32_16x16x4_f32 v[80:83], v44, v97, v[80:83]
    v_mfma_f32_16x16x4_f32 v[84:87], v45, v97, v[84:87]
    v_mfma_f32_16x16x4_f32 v[88:91], v46, v97, v[88:91]
    v_mfma_f32_16x16x4_f32 v[92:95], v47, v97, v[92:95]
    ds_read_b32 v40, v16
    ds_read_b32 v41, v17
    ds_read_b32 v42, v18
    ds_read_b32 v43, v19
    ds_read_b32 v44, v20
    ds_read_b32 v45, v21
    ds_read_b32 v46, v22
    ds_read_b32 v47, v23
    v_add_u32 v16, v16, v24
    v_subrev_u32 v9, 2560, v16
    v_min_u32 v16, v16, v9
    v_add_u32 v17, v17, v25
    v_subrev_u32 v9, 2560, v17
    v_min_u32 v17, v17, v9
    v_add_u32 v18, v18, v26
    v_subrev_u32 v9, 2560, v18
    v_min_u32 v18, v18, v9
    v_add_u32 v19, v19, v27
    v_subrev_u32 v9, 2560, v19
    v_min_u32 v19, v19, v9
    v_add_u32 v20, v20, v28
    v_subrev_u32 v9, 2560, v20
    v_min_u32 v20, v20, v9
    v_add_u32 v21, v21, v29
    v_subrev_u32 v9, 2560, v21
    v_min_u32 v21, v21, v9
    v_add_u32 v22, v22, v30
    v_subrev_u32 v9, 2560, v22
    v_min_u32 v22, v22, v9
    v_add_u32 v23, v23, v31
    v_subrev_u32 v9, 2560, v23
    v_min_u32 v23, v23, v9
    s_waitcnt lgkmcnt(8)
    v_mfma_f32_16x16x4_f32 v[64:67], v32, v98, v[64:67]
    v_mfma_f32_16x16x4_f32 v[68:71], v33, v98, v[68:71]
    v_mfma_f32_16x16x4_f32 v[72:75], v34, v98, v[72:75]
    v_mfma_f32_16x16x4_f32 v[76:79], v35, v98, v[76:79]
    v_mfma_f32_16x16x4_f32 v[80:83], v36, v98, v[80:83]
    v_mfma_f32_16x16x4_f32 v[84:87], v37, v98, v[84:87]
    v_mfma_f32_16x16x4_f32 v[88:91], v38, v98, v[88:91]
    v_mfma_f32_16x16x4_f32 v[92:95], v39, v98, v[92:95]
    ds_read_b32 v32, v16
    ds_read_b32 v33, v17
    ds_read_b32 v34, v18
    ds_read_b32 v35, v19
    ds_read_b32 v36, v20
    ds_read_b32 v37, v21
    ds_read_b32 v38, v22
    ds_read_b32 v39, v23
    v_add_u32 v16, v16, v24
    v_subrev_u32 v9, 2560, v16
    v_min_u32 v16, v16, v9
    v_add_u32 v17, v17, v25
    v_subrev_u32 v9, 2560, v17
    v_min_u32 v17, v17, v9
    v_add_u32 v18, v18, v26
    v_subrev_u32 v9, 2560, v18
    v_min_u32 v18, v18, v9
    v_add_u32 v19, v19, v27
    v_subrev_u32 v9, 2560, v19
    v_min_u32 v19, v19, v9
    v_add_u32 v20, v20, v28
    v_subrev_u32 v9, 2560, v20
    v_min_u32 v20, v20, v9
    v_add_u32 v21, v21, v29
    v_subrev_u32 v9, 2560, v21
    v_min_u32 v21, v21, v9
    v_add_u32 v22, v22, v30
    v_subrev_u32 v9, 2560, v22
    v_min_u32 v22, v22, v9
    v_add_u32 v23, v23, v31
    v_subrev_u32 v9, 2560, v23
    v_min_u32 v23, v23, v9
    s_waitcnt lgkmcnt(8)
    v_mfma_f32_16x16x4_f32 v[64:67], v40, v99, v[64:67]
    v_mfma_f32_16x16x4_f32 v[68:71], v41, v99, v[68:71]
    v_mfma_f32_16x16x4_f32 v[72:75], v42, v99, v[72:75]
    v_mfma_f32_16x16x4_f32 v[76:79], v43, v99, v[76:79]
    v_mfma_f32_16x16x4_f32 v[80:83], v44, v99, v[80:83]
    v_mfma_f32_16x16x4_f32 v[84:87], v45, v99, v[84:87]
    v_mfma_f32_16x16x4_f32 v[88:91], v46, v99, v[88:91]
    v_mfma_f32_16x16x4_f32 v[92:95], v47, v99, v[92:95]
    ds_read_b32 v40, v16
    ds_read_b32 v41, v17
    ds_read_b32 v42, v18
    ds_read_b32 v43, v19
    ds_read_b32 v44, v20
    ds_read_b32 v45, v21
    ds_read_b32 v46, v22
    ds_read_b32 v47, v23
    v_add_u32 v16, v16, v24
    v_subrev_u32 v9, 2560, v16
    v_min_u32 v16, v16, v9
    v_add_u32 v17, v17, v25
    v_subrev_u32 v9, 2560, v17
    v_min_u32 v17, v17, v9
    v_add_u32 v18, v18, v26
    v_subrev_u32 v9, 2560, v18
    v_min_u32 v18, v18, v9
    v_add_u32 v19, v19, v27
    v_subrev_u32 v9, 2560, v19
    v_min_u32 v19, v19, v9
    v_add_u32 v20, v20, v28
    v_subrev_u32 v9, 2560, v20
    v_min_u32 v20, v20, v9
    v_add_u32 v21, v21, v29
    v_subrev_u32 v9, 2560, v21
    v_min_u32 v21, v21, v9
    v_add_u32 v22, v22, v30
    v_subrev_u32 v9, 2560, v22
    v_min_u32 v22, v22, v9
    v_add_u32 v23, v23, v31
    v_subrev_u32 v9, 2560, v23
    v_min_u32 v23, v23, v9
    s_waitcnt lgkmcnt(8)
    v_mfma_f32_16x16x4_f32 v[64:67], v32, v100, v[64:67]
    v_mfma_f32_16x16x4_f32 v[68:71], v33, v100, v[68:71]
    v_mfma_f32_16x16x4_f32 v[72:75], v34, v100, v[72:75]
    v_mfma_f32_16x16x4_f32 v[76:79], v35, v100, v[76:79]
    v_mfma_f32_16x16x4_f32 v[80:83], v36, v100, v[80:83]
    v_mfma_f32_16x16x4_f32 v[84:87], v37, v100, v[84:87]
    v_mfma_f32_16x16x4_f32 v[88:91], v38, v100, v[88:91]
    v_mfma_f32_16x16x4_f32 v[92:95], v39, v100, v[92:95]
    ds_read_b32 v32, v16
    ds_read_b32 v33, v17
    ds_read_b32 v34, v18
    ds_read_b32 v35, v19
    ds_read_b32 v36, v20
    ds_read_b32 v37, v21
    ds_read_b32 v38, v22
    ds_read_b32 v39, v23
    v_add_u32 v16, v16, v24
    v_subrev_u32 v9, 2560, v16
    v_min_u32 v16, v16, v9
    v_add_u32 v17, v17, v25
    v_subrev_u32 v9, 2560, v17
    v_min_u32 v17, v17, v9
    v_add_u32 v18, v18, v26
    v_subrev_u32 v9, 2560, v18
    v_min_u32 v18, v18, v9
    v_add_u32 v19, v19, v27
    v_subrev_u32 v9, 2560, v19
    v_min_u32 v19, v19, v9
    v_add_u32 v20, v20, v28
    v_subrev_u32 v9, 2560, v20
    v_min_u32 v20, v20, v9
    v_add_u32 v21, v21, v29
    v_subrev_u32 v9, 2560, v21
    v_min_u32 v21, v21, v9
    v_add_u32 v22, v22, v30
    v_subrev_u32 v9, 2560, v22
    v_min_u32 v22, v22, v9
    v_add_u32 v23, v23, v31
    v_subrev_u32 v9, 2560, v23
    v_min_u32 v23, v23, v9
    s_waitcnt lgkmcnt(8)
    v_mfma_f32_16x16x4_f32 v[64:67], v40, v101, v[64:67]
    v_mfma_f32_16x16x4_f32 v[68:71], v41, v101, v[68:71]
    v_mfma_f32_16x16x4_f32 v[72:75], v42, v101, v[72:75]
    v_mfma_f32_16x16x4_f32 v[76:79], v43, v101, v[76:79]
    v_mfma_f32_16x16x4_f32 v[80:83], v44, v101, v[80:83]
    v_mfma_f32_16x16x4_f32 v[84:87], v45, v101, v[84:87]
    v_mfma_f32_16x16x4_f32 v[88:91], v46, v101, v[88:91]
    v_mfma_f32_16x16x4_f32 v[92:95], v47, v101, v[92:95]
    ds_read_b32 v40, v16
    ds_read_b32 v41, v17
    ds_read_b32 v42, v18
    ds_read_b32 v43, v19
    ds_read_b32 v44, v20
    ds_read_b32 v45, v21
    ds_read_b32 v46, v22
    ds_read_b32 v47, v23
    v_add_u32 v16, v16, v24
    v_subrev_u32 v9, 2560, v16
    v_min_u32 v16, v16, v9
    v_add_u32 v17, v17, v25
    v_subrev_u32 v9, 2560, v17
    v_min_u32 v17, v17, v9
    v_add_u32 v18, v18, v26
    v_subrev_u32 v9, 2560, v18
    v_min_u32 v18, v18, v9
    v_add_u32 v19, v19, v27
    v_subrev_u32 v9, 2560, v19
    v_min_u32 v19, v19, v9
    v_add_u32 v20, v20, v28
    v_subrev_u32 v9, 2560, v20
    v_min_u32 v20, v20, v9
    v_add_u32 v21, v21, v29
    v_subrev_u32 v9, 2560, v21
    v_min_u32 v21, v21, v9
    v_add_u32 v22, v22, v30
    v_subrev_u32 v9, 2560, v22
    v_min_u32 v22, v22, v9
    v_add_u32 v23, v23, v31
    v_subrev_u32 v9, 2560, v23
    v_min_u32 v23, v23, v9
    s_waitcnt lgkmcnt(8)
    v_mfma_f32_16x16x4_f32 v[64:67], v32, v102, v[64:67]
    v_mfma_f32_16x16x4_f32 v[68:71], v33, v102, v[68:71]
    v_mfma_f32_16x16x4_f32 v[72:75], v34, v102, v[72:75]
    v_mfma_f32_16x16x4_f32 v[76:79], v35, v102, v[76:79]
    v_mfma_f32_16x16x4_f32 v[80:83], v36, v102, v[80:83]
    v_mfma_f32_16x16x4_f32 v[84:87], v37, v102, v[84:87]
    v_mfma_f32_16x16x4_f32 v[88:91], v38, v102, v[88:91]
    v_mfma_f32_16x16x4_f32 v[92:95], v39, v102, v[92:95]
    ds_read_b32 v32, v16
    ds_read_b32 v33, v17
    ds_read_b32 v34, v18
    ds_read_b32 v35, v19
    ds_read_b32 v36, v20
    ds_read_b32 v37, v21
    ds_read_b32 v38, v22
    ds_read_b32 v39, v23
    v_add_u32 v16, v16, v24
    v_subrev_u32 v9, 2560, v16
    v_min_u32 v16, v16, v9
    v_add_u32 v17, v17, v25
    v_subrev_u32 v9, 2560, v17
    v_min_u32 v17, v17, v9
    v_add_u32 v18, v18, v26
    v_subrev_u32 v9, 2560, v18
    v_min_u32 v18, v18, v9
    v_add_u32 v19, v19, v27
    v_subrev_u32 v9, 2560, v19
    v_min_u32 v19, v19, v9
    v_add_u32 v20, v20, v28
    v_subrev_u32 v9, 2560, v20
    v_min_u32 v20, v20, v9
    v_add_u32 v21, v21, v29
    v_subrev_u32 v9, 2560, v21
    v_min_u32 v21, v21, v9
    v_add_u32 v22, v22, v30
    v_subrev_u32 v9, 2560, v22
    v_min_u32 v22, v22, v9
    v_add_u32 v23, v23, v31
    v_subrev_u32 v9, 2560, v23
    v_min_u32 v23, v23, v9
    s_waitcnt lgkmcnt(8)
    v_mfma_f32_16x16x4_f32 v[64:67], v40, v103, v[64:67]
    v_mfma_f32_16x16x4_f32 v[68:71], v41, v103, v[68:71]
    v_mfma_f32_16x16x4_f32 v[72:75], v42, v103, v[72:75]
    v_mfma_f32_16x16x4_f32 v[76:79], v43, v103, v[76:79]
    v_mfma_f32_16x16x4_f32 v[80:83], v44, v103, v[80:83]
    v_mfma_f32_16x16x4_f32 v[84:87], v45, v103, v[84:87]
    v_mfma_f32_16x16x4_f32 v[88:91], v46, v103, v[88:91]
    v_mfma_f32_16x16x4_f32 v[92:95], v47, v103, v[92:95]
    s_waitcnt vmcnt(0)
    buffer_load_dword v96, v14, s[16:19], s34 offen sc1
    s_add_u32 s34, s34, 32768
    buffer_load_dword v97, v14, s[16:19], s34 offen sc1
    s_add_u32 s34, s34, 32768
    buffer_load_dword v98, v14, s[16:19], s34 offen sc1
    s_add_u32 s34, s34, 32768
    buffer_load_dword v99, v14, s[16:19], s34 offen sc1
    s_add_u32 s34, s34, 32768
    buffer_load_dword v100, v14, s[16:19], s34 offen sc1
    s_add_u32 s34, s34, 32768
    buffer_load_dword v101, v14, s[16:19], s34 offen sc1
    s_add_u32 s34, s34, 32768
    buffer_load_dword v102, v14, s[16:19], s34 offen sc1
    s_add_u32 s34, s34, 32768
    buffer_load_dword v103, v14, s[16:19], s34 offen sc1
    s_add_u32 s34, s34, 32768
    ds_read_b32 v40, v16
    ds_read_b32 v41, v17
    ds_read_b32 v42, v18
    ds_read_b32 v43, v19
    ds_read_b32 v44, v20
    ds_read_b32 v45, v21
    ds_read_b32 v46, v22
    ds_read_b32 v47, v23
    v_add_u32 v16, v16, v24
    v_subrev_u32 v9, 2560, v16
    v_min_u32 v16, v16, v9
    v_add_u32 v17, v17, v25
    v_subrev_u32 v9, 2560, v17
    v_min_u32 v17, v17, v9
    v_add_u32 v18, v18, v26
    v_subrev_u32 v9, 2560, v18
    v_min_u32 v18, v18, v9
    v_add_u32 v19, v19, v27
    v_subrev_u32 v9, 2560, v19
    v_min_u32 v19, v19, v9
    v_add_u32 v20, v20, v28
    v_subrev_u32 v9, 2560, v20
    v_min_u32 v20, v20, v9
    v_add_u32 v21, v21, v29
    v_subrev_u32 v9, 2560, v21
    v_min_u32 v21, v21, v9
    v_add_u32 v22, v22, v30
    v_subrev_u32 v9, 2560, v22
    v_min_u32 v22, v22, v9
    v_add_u32 v23, v23, v31
    v_subrev_u32 v9, 2560, v23
    v_min_u32 v23, v23, v9
    s_waitcnt lgkmcnt(8)
    v_mfma_f32_16x16x4_f32 v[64:67], v32, v104, v[64:67]
    v_mfma_f32_16x16x4_f32 v[68:71], v33, v104, v[68:71]
    v_mfma_f32_16x16x4_f32 v[72:75], v34, v104, v[72:75]
    v_mfma_f32_16x16x4_f32 v[76:79], v35, v104, v[76:79]
    v_mfma_f32_16x16x4_f32 v[80:83], v36, v104, v[80:83]
    v_mfma_f32_16x16x4_f32 v[84:87], v37, v104, v[84:87]
    v_mfma_f32_16x16x4_f32 v[88:91], v38, v104, v[88:91]
    v_mfma_f32_16x16x4_f32 v[92:95], v39, v104, v[92:95]
    ds_read_b32 v32, v16
    ds_read_b32 v33, v17
    ds_read_b32 v34, v18
    ds_read_b32 v35, v19
    ds_read_b32 v36, v20
    ds_read_b32 v37, v21
    ds_read_b32 v38, v22
    ds_read_b32 v39, v23
    v_add_u32 v16, v16, v24
    v_subrev_u32 v9, 2560, v16
    v_min_u32 v16, v16, v9
    v_add_u32 v17, v17, v25
    v_subrev_u32 v9, 2560, v17
    v_min_u32 v17, v17, v9
    v_add_u32 v18, v18, v26
    v_subrev_u32 v9, 2560, v18
    v_min_u32 v18, v18, v9
    v_add_u32 v19, v19, v27
    v_subrev_u32 v9, 2560, v19
    v_min_u32 v19, v19, v9
    v_add_u32 v20, v20, v28
    v_subrev_u32 v9, 2560, v20
    v_min_u32 v20, v20, v9
    v_add_u32 v21, v21, v29
    v_subrev_u32 v9, 2560, v21
    v_min_u32 v21, v21, v9
    v_add_u32 v22, v22, v30
    v_subrev_u32 v9, 2560, v22
    v_min_u32 v22, v22, v9
    v_add_u32 v23, v23, v31
    v_subrev_u32 v9, 2560, v23
    v_min_u32 v23, v23, v9
    s_waitcnt lgkmcnt(8)
    v_mfma_f32_16x16x4_f32 v[64:67], v40, v105, v[64:67]
    v_mfma_f32_16x16x4_f32 v[68:71], v41, v105, v[68:71]
    v_mfma_f32_16x16x4_f32 v[72:75], v42, v105, v[72:75]
    v_mfma_f32_16x16x4_f32 v[76:79], v43, v105, v[76:79]
    v_mfma_f32_16x16x4_f32 v[80:83], v44, v105, v[80:83]
    v_mfma_f32_16x16x4_f32 v[84:87], v45, v105, v[84:87]
    v_mfma_f32_16x16x4_f32 v[88:91], v46, v105, v[88:91]
    v_mfma_f32_16x16x4_f32 v[92:95], v47, v105, v[92:95]
    ds_read_b32 v40, v16
    ds_read_b32 v41, v17
    ds_read_b32 v42, v18
    ds_read_b32 v43, v19
    ds_read_b32 v44, v20
    ds_read_b32 v45, v21
    ds_read_b32 v46, v22
    ds_read_b32 v47, v23
    v_add_u32 v16, v16, v24
    v_subrev_u32 v9, 2560, v16
    v_min_u32 v16, v16, v9
    v_add_u32 v17, v17, v25
    v_subrev_u32 v9, 2560, v17
    v_min_u32 v17, v17, v9
    v_add_u32 v18, v18, v26
    v_subrev_u32 v9, 2560, v18
    v_min_u32 v18, v18, v9
    v_add_u32 v19, v19, v27
    v_subrev_u32 v9, 2560, v19
    v_min_u32 v19, v19, v9
    v_add_u32 v20, v20, v28
    v_subrev_u32 v9, 2560, v20
    v_min_u32 v20, v20, v9
    v_add_u32 v21, v21, v29
    v_subrev_u32 v9, 2560, v21
    v_min_u32 v21, v21, v9
    v_add_u32 v22, v22, v30
    v_subrev_u32 v9, 2560, v22
    v_min_u32 v22, v22, v9
    v_add_u32 v23, v23, v31
    v_subrev_u32 v9, 2560, v23
    v_min_u32 v23, v23, v9
    s_waitcnt lgkmcnt(8)
    v_mfma_f32_16x16x4_f32 v[64:67], v32, v106, v[64:67]
    v_mfma_f32_16x16x4_f32 v[68:71], v33, v106, v[68:71]
    v_mfma_f32_16x16x4_f32 v[72:75], v34, v106, v[72:75]
    v_mfma_f32_16x16x4_f32 v[76:79], v35, v106, v[76:79]
    v_mfma_f32_16x16x4_f32 v[80:83], v36, v106, v[80:83]
    v_mfma_f32_16x16x4_f32 v[84:87], v37, v106, v[84:87]
    v_mfma_f32_16x16x4_f32 v[88:91], v38, v106, v[88:91]
    v_mfma_f32_16x16x4_f32 v[92:95], v39, v106, v[92:95]
    ds_read_b32 v32, v16
    ds_read_b32 v33, v17
    ds_read_b32 v34, v18
    ds_read_b32 v35, v19
    ds_read_b32 v36, v20
    ds_read_b32 v37, v21
    ds_read_b32 v38, v22
    ds_read_b32 v39, v23
    v_add_u32 v16, v16, v24
    v_subrev_u32 v9, 2560, v16
    v_min_u32 v16, v16, v9
    v_add_u32 v17, v17, v25
    v_subrev_u32 v9, 2560, v17
    v_min_u32 v17, v17, v9
    v_add_u32 v18, v18, v26
    v_subrev_u32 v9, 2560, v18
    v_min_u32 v18, v18, v9
    v_add_u32 v19, v19, v27
    v_subrev_u32 v9, 2560, v19
    v_min_u32 v19, v19, v9
    v_add_u32 v20, v20, v28
    v_subrev_u32 v9, 2560, v20
    v_min_u32 v20, v20, v9
    v_add_u32 v21, v21, v29
    v_subrev_u32 v9, 2560, v21
    v_min_u32 v21, v21, v9
    v_add_u32 v22, v22, v30
    v_subrev_u32 v9, 2560, v22
    v_min_u32 v22, v22, v9
    v_add_u32 v23, v23, v31
    v_subrev_u32 v9, 2560, v23
    v_min_u32 v23, v23, v9
    s_waitcnt lgkmcnt(8)
    v_mfma_f32_16x16x4_f32 v[64:67], v40, v107, v[64:67]
    v_mfma_f32_16x16x4_f32 v[68:71], v41, v107, v[68:71]
    v_mfma_f32_16x16x4_f32 v[72:75], v42, v107, v[72:75]
    v_mfma_f32_16x16x4_f32 v[76:79], v43, v107, v[76:79]
    v_mfma_f32_16x16x4_f32 v[80:83], v44, v107, v[80:83]
    v_mfma_f32_16x16x4_f32 v[84:87], v45, v107, v[84:87]
    v_mfma_f32_16x16x4_f32 v[88:91], v46, v107, v[88:91]
    v_mfma_f32_16x16x4_f32 v[92:95], v47, v107, v[92:95]
    ds_read_b32 v40, v16
    ds_read_b32 v41, v17
    ds_read_b32 v42, v18
    ds_read_b32 v43, v19
    ds_read_b32 v44, v20
    ds_read_b32 v45, v21
    ds_read_b32 v46, v22
    ds_read_b32 v47, v23
    v_add_u32 v16, v16, v24
    v_subrev_u32 v9, 2560, v16
    v_min_u32 v16, v16, v9
    v_add_u32 v17, v17, v25
    v_subrev_u32 v9, 2560, v17
    v_min_u32 v17, v17, v9
    v_add_u32 v18, v18, v26
    v_subrev_u32 v9, 2560, v18
    v_min_u32 v18, v18, v9
    v_add_u32 v19, v19, v27
    v_subrev_u32 v9, 2560, v19
    v_min_u32 v19, v19, v9
    v_add_u32 v20, v20, v28
    v_subrev_u32 v9, 2560, v20
    v_min_u32 v20, v20, v9
    v_add_u32 v21, v21, v29
    v_subrev_u32 v9, 2560, v21
    v_min_u32 v21, v21, v9
    v_add_u32 v22, v22, v30
    v_subrev_u32 v9, 2560, v22
    v_min_u32 v22, v22, v9
    v_add_u32 v23, v23, v31
    v_subrev_u32 v9, 2560, v23
    v_min_u32 v23, v23, v9
    s_waitcnt lgkmcnt(8)
    v_mfma_f32_16x16x4_f32 v[64:67], v32, v108, v[64:67]
    v_mfma_f32_16x16x4_f32 v[68:71], v33, v108, v[68:71]
    v_mfma_f32_16x16x4_f32 v[72:75], v34, v108, v[72:75]
    v_mfma_f32_16x16x4_f32 v[76:79], v35, v108, v[76:79]
    v_mfma_f32_16x16x4_f32 v[80:83], v36, v108, v[80:83]
    v_mfma_f32_16x16x4_f32 v[84:87], v37, v108, v[84:87]
    v_mfma_f32_16x16x4_f32 v[88:91], v38, v108, v[88:91]
    v_mfma_f32_16x16x4_f32 v[92:95], v39, v108, v[92:95]
    ds_read_b32 v32, v16
    ds_read_b32 v33, v17
    ds_read_b32 v34, v18
    ds_read_b32 v35, v19
    ds_read_b32 v36, v20
    ds_read_b32 v37, v21
    ds_read_b32 v38, v22
    ds_read_b32 v39, v23
    v_add_u32 v16, v16, v24
    v_subrev_u32 v9, 2560, v16
    v_min_u32 v16, v16, v9
    v_add_u32 v17, v17, v25
    v_subrev_u32 v9, 2560, v17
    v_min_u32 v17, v17, v9
    v_add_u32 v18, v18, v26
    v_subrev_u32 v9, 2560, v18
    v_min_u32 v18, v18, v9
    v_add_u32 v19, v19, v27
    v_subrev_u32 v9, 2560, v19
    v_min_u32 v19, v19, v9
    v_add_u32 v20, v20, v28
    v_subrev_u32 v9, 2560, v20
    v_min_u32 v20, v20, v9
    v_add_u32 v21, v21, v29
    v_subrev_u32 v9, 2560, v21
    v_min_u32 v21, v21, v9
    v_add_u32 v22, v22, v30
    v_subrev_u32 v9, 2560, v22
    v_min_u32 v22, v22, v9
    v_add_u32 v23, v23, v31
    v_subrev_u32 v9, 2560, v23
    v_min_u32 v23, v23, v9
    s_waitcnt lgkmcnt(8)
    v_mfma_f32_16x16x4_f32 v[64:67], v40, v109, v[64:67]
    v_mfma_f32_16x16x4_f32 v[68:71], v41, v109, v[68:71]
    v_mfma_f32_16x16x4_f32 v[72:75], v42, v109, v[72:75]
    v_mfma_f32_16x16x4_f32 v[76:79], v43, v109, v[76:79]
    v_mfma_f32_16x16x4_f32 v[80:83], v44, v109, v[80:83]
    v_mfma_f32_16x16x4_f32 v[84:87], v45, v109, v[84:87]
    v_mfma_f32_16x16x4_f32 v[88:91], v46, v109, v[88:91]
    v_mfma_f32_16x16x4_f32 v[92:95], v47, v109, v[92:95]
    ds_read_b32 v40, v16
    ds_read_b32 v41, v17
    ds_read_b32 v42, v18
    ds_read_b32 v43, v19
    ds_read_b32 v44, v20
    ds_read_b32 v45, v21
    ds_read_b32 v46, v22
    ds_read_b32 v47, v23
    v_add_u32 v16, v16, v24
    v_subrev_u32 v9, 2560, v16
    v_min_u32 v16, v16, v9
    v_add_u32 v17, v17, v25
    v_subrev_u32 v9, 2560, v17
    v_min_u32 v17, v17, v9
    v_add_u32 v18, v18, v26
    v_subrev_u32 v9, 2560, v18
    v_min_u32 v18, v18, v9
    v_add_u32 v19, v19, v27
    v_subrev_u32 v9, 2560, v19
    v_min_u32 v19, v19, v9
    v_add_u32 v20, v20, v28
    v_subrev_u32 v9, 2560, v20
    v_min_u32 v20, v20, v9
    v_add_u32 v21, v21, v29
    v_subrev_u32 v9, 2560, v21
    v_min_u32 v21, v21, v9
    v_add_u32 v22, v22, v30
    v_subrev_u32 v9, 2560, v22
    v_min_u32 v22, v22, v9
    v_add_u32 v23, v23, v31
    v_subrev_u32 v9, 2560, v23
    v_min_u32 v23, v23, v9
    s_waitcnt lgkmcnt(8)
    v_mfma_f32_16x16x4_f32 v[64:67], v32, v110, v[64:67]
    v_mfma_f32_16x16x4_f32 v[68:71], v33, v110, v[68:71]
    v_mfma_f32_16x16x4_f32 v[72:75], v34, v110, v[72:75]
    v_mfma_f32_16x16x4_f32 v[76:79], v35, v110, v[76:79]
    v_mfma_f32_16x16x4_f32 v[80:83], v36, v110, v[80:83]
    v_mfma_f32_16x16x4_f32 v[84:87], v37, v110, v[84:87]
    v_mfma_f32_16x16x4_f32 v[88:91], v38, v110, v[88:91]
    v_mfma_f32_16x16x4_f32 v[92:95], v39, v110, v[92:95]
    ds_read_b32 v32, v16
    ds_read_b32 v33, v17
    ds_read_b32 v34, v18
    ds_read_b32 v35, v19
    ds_read_b32 v36, v20
    ds_read_b32 v37, v21
    ds_read_b32 v38, v22
    ds_read_b32 v39, v23
    v_add_u32 v16, v16, v24
    v_subrev_u32 v9, 2560, v16
    v_min_u32 v16, v16, v9
    v_add_u32 v17, v17, v25
    v_subrev_u32 v9, 2560, v17
    v_min_u32 v17, v17, v9
    v_add_u32 v18, v18, v26
    v_subrev_u32 v9, 2560, v18
    v_min_u32 v18, v18, v9
    v_add_u32 v19, v19, v27
    v_subrev_u32 v9, 2560, v19
    v_min_u32 v19, v19, v9
    v_add_u32 v20, v20, v28
    v_subrev_u32 v9, 2560, v20
    v_min_u32 v20, v20, v9
    v_add_u32 v21, v21, v29
    v_subrev_u32 v9, 2560, v21
    v_min_u32 v21, v21, v9
    v_add_u32 v22, v22, v30
    v_subrev_u32 v9, 2560, v22
    v_min_u32 v22, v22, v9
    v_add_u32 v23, v23, v31
    v_subrev_u32 v9, 2560, v23
    v_min_u32 v23, v23, v9
    s_waitcnt lgkmcnt(8)
    v_mfma_f32_16x16x4_f32 v[64:67], v40, v111, v[64:67]
    v_mfma_f32_16x16x4_f32 v[68:71], v41, v111, v[68:71]
    v_mfma_f32_16x16x4_f32 v[72:75], v42, v111, v[72:75]
    v_mfma_f32_16x16x4_f32 v[76:79], v43, v111, v[76:79]
    v_mfma_f32_16x16x4_f32 v[80:83], v44, v111, v[80:83]
    v_mfma_f32_16x16x4_f32 v[84:87], v45, v111, v[84:87]
    v_mfma_f32_16x16x4_f32 v[88:91], v46, v111, v[88:91]
    v_mfma_f32_16x16x4_f32 v[92:95], v47, v111, v[92:95]
    s_waitcnt vmcnt(0)
    s_add_u32 s35, s35, 1
    s_cmp_lt_u32 s35, 10
    s_cbranch_scc1 .f3l_47
    v_mul_f32 v97, 0.5, v96
    v_cmp_eq_u32 vcc, 0, v6
    s_nop 1
    v_cndmask_b32 v96, 0, v97, vcc
    s_waitcnt lgkmcnt(0)
    s_nop 1
    v_mfma_f32_16x16x4_f32 v[64:67], v32, v96, v[64:67]
    v_mfma_f32_16x16x4_f32 v[68:71], v33, v96, v[68:71]
    v_mfma_f32_16x16x4_f32 v[72:75], v34, v96, v[72:75]
    v_mfma_f32_16x16x4_f32 v[76:79], v35, v96, v[76:79]
    v_mfma_f32_16x16x4_f32 v[80:83], v36, v96, v[80:83]
    v_mfma_f32_16x16x4_f32 v[84:87], v37, v96, v[84:87]
    v_mfma_f32_16x16x4_f32 v[88:91], v38, v96, v[88:91]
    v_mfma_f32_16x16x4_f32 v[92:95], v39, v96, v[92:95]
    s_nop 7
    s_nop 3
    s_lshl_b32 s7, s30, 6
    s_add_u32 s7, s7, s32
    s_mul_i32 s7, s7, 1280
    s_lshl_b32 s33, s31, 8
    s_add_u32 s7, s7, s33
    s_add_u32 s7, s7, 100663296
    v_mul_u32_u24 v14, 1280, v3
    v_lshl_add_u32 v14, v4, 4, v14
    v_add_u32 v14, s7, v14
    s_mov_b32 s33, 902614221
    v_mul_f32 v64, s33, v64
    v_mul_f32 v65, s33, v65
    v_mul_f32 v66, s33, v66
    v_mul_f32 v67, s33, v67
    v_mul_f32 v68, s33, v68
    v_mul_f32 v69, s33, v69
    v_mul_f32 v70, s33, v70
    v_mul_f32 v71, s33, v71
    v_cvt_pk_bf16_f32 v16, v64, v65
    v_cvt_pk_bf16_f32 v17, v66, v67
    v_cvt_pk_bf16_f32 v18, v68, v69
    v_cvt_pk_bf16_f32 v19, v70, v71
    buffer_store_dwordx4 v[16:19], v14, s[16:19], 0 offen offset:0 sc1
    s_nop 1
    v_mul_f32 v72, s33, v72
    v_mul_f32 v73, s33, v73
    v_mul_f32 v74, s33, v74
    v_mul_f32 v75, s33, v75
    v_mul_f32 v76, s33, v76
    v_mul_f32 v77, s33, v77
    v_mul_f32 v78, s33, v78
    v_mul_f32 v79, s33, v79
    v_cvt_pk_bf16_f32 v16, v72, v73
    v_cvt_pk_bf16_f32 v17, v74, v75
    v_cvt_pk_bf16_f32 v18, v76, v77
    v_cvt_pk_bf16_f32 v19, v78, v79
    buffer_store_dwordx4 v[16:19], v14, s[16:19], 0 offen offset:64 sc1
    s_nop 1
    v_mul_f32 v80, s33, v80
    v_mul_f32 v81, s33, v81
    v_mul_f32 v82, s33, v82
    v_mul_f32 v83, s33, v83
    v_mul_f32 v84, s33, v84
    v_mul_f32 v85, s33, v85
    v_mul_f32 v86, s33, v86
    v_mul_f32 v87, s33, v87
    v_cvt_pk_bf16_f32 v16, v80, v81
    v_cvt_pk_bf16_f32 v17, v82, v83
    v_cvt_pk_bf16_f32 v18, v84, v85
    v_cvt_pk_bf16_f32 v19, v86, v87
    buffer_store_dwordx4 v[16:19], v14, s[16:19], 0 offen offset:128 sc1
    s_nop 1
    v_mul_f32 v88, s33, v88
    v_mul_f32 v89, s33, v89
    v_mul_f32 v90, s33, v90
    v_mul_f32 v91, s33, v91
    v_mul_f32 v92, s33, v92
    v_mul_f32 v93, s33, v93
    v_mul_f32 v94, s33, v94
    v_mul_f32 v95, s33, v95
    v_cvt_pk_bf16_f32 v16, v88, v89
    v_cvt_pk_bf16_f32 v17, v90, v91
    v_cvt_pk_bf16_f32 v18, v92, v93
    v_cvt_pk_bf16_f32 v19, v94, v95
    buffer_store_dwordx4 v[16:19], v14, s[16:19], 0 offen offset:192 sc1
    s_nop 1
    s_branch .wloop_21
.tTO_32:
    s_cmp_lt_u32 s94, 3281
    s_cbranch_scc0 .tTB_48
    s_sub_u32 s95, s94, 2273
    s_mul_i32 s4, s95, 3641
    s_lshr_b32 s4, s4, 16
    s_mul_i32 s5, s4, 18
    s_sub_u32 s5, s95, s5
    s_branch .tTC_49
.tTB_48:
    s_sub_u32 s95, s94, 3281
    s_mul_i32 s4, s95, 1366
    s_lshr_b32 s4, s4, 16
    s_mul_i32 s5, s4, 48
    s_sub_u32 s5, s95, s5
    s_add_u32 s4, s4, 56
.tTC_49:
    s_cmp_lt_u32 s5, 8
    s_cbranch_scc0 .tO_30
    s_cmp_ge_u32 s4, 64
    s_cbranch_scc1 .wloop_21
    s_lshl_b32 s3, s4, 3
    s_add_u32 s3, s3, s5
    s_lshl_b32 s93, s4, 6
    s_add_u32 s93, s93, 109060288
    s_mov_b32 s95, s4
    s_cmp_lg_u32 s39, 0
    s_cbranch_scc1 .wsk_50
    v_mov_b32 v250, 109064704
    s_mov_b32 s101, 0
.wp_51:
    buffer_load_dword v251, v250, s[16:19], 0 offen sc1
    s_waitcnt vmcnt(0)
    v_readfirstlane_b32 s100, v251
    s_add_u32 s100, s100, 1
    s_cmp_ge_u32 s100, s95
    s_cbranch_scc1 .wpok_52
    s_add_u32 s101, s101, 1
    s_cmp_gt_u32 s101, 100000
    s_cbranch_scc1 .fexit_3
    s_sub_u32 s100, s95, s100
.wps_53:
    s_sleep 110
    s_sub_u32 s100, s100, 1
    s_cmp_lg_u32 s100, 0
    s_cbranch_scc1 .wps_53
    s_branch .wp_51
.wpok_52:
    s_lshr_b32 s100, s95, 2
    s_lshl_b32 s100, s100, 6
    s_add_u32 s100, s100, 109051904
    v_mov_b32 v250, s100
    s_mov_b32 s101, 0
.ww_54:
    buffer_load_dword v251, v250, s[16:19], 0 offen sc1
    s_waitcnt vmcnt(0)
    v_readfirstlane_b32 s100, v251
    s_cmp_ge_u32 s100, 64
    s_cbranch_scc1 .wok_55
    s_add_u32 s101, s101, 1
    s_cmp_gt_u32 s101, 200000
    s_cbranch_scc1 .fexit_3
    s_sleep 24
    s_branch .ww_54
.wok_55:
    s_lshr_b32 s100, s95, 2
    s_lshl_b32 s100, s100, 6
    s_add_u32 s100, s100, 109052928
    v_mov_b32 v250, s100
    s_mov_b32 s101, 0
.ww_56:
    buffer_load_dword v251, v250, s[16:19], 0 offen sc1
    s_waitcnt vmcnt(0)
    v_readfirstlane_b32 s100, v251
    s_cmp_ge_u32 s100, 32
    s_cbranch_scc1 .wok_57
    s_add_u32 s101, s101, 1
    s_cmp_gt_u32 s101, 200000
    s_cbranch_scc1 .fexit_3
    s_sleep 24
    s_branch .ww_56
.wok_57:
.wsk_50:
    s_barrier
    s_mov_b32 s38, s5
    v_and_b32 v1, 63, v0
    v_lshrrev_b32 v2, 6, v0
    s_nop 0
    v_readfirstlane_b32 s6, v2
    v_and_b32 v3, 15, v1
    v_lshrrev_b32 v4, 4, v1
    v_lshrrev_b32 v5, 2, v3
    v_and_b32 v6, 3, v3
    v_lshl_add_u32 v7, v5, 3, v6
    s_lshr_b32 s4, s3, 3
    s_and_b32 s5, s3, 7
    s_lshl_b32 s5, s5, 2
    s_add_u32 s5, s5, s6
    s_lshl_b32 s7, s4, 18
    s_lshl_b32 s30, s5, 8
    s_add_u32 s7, s7, s30
    v_lshlrev_b32 v8, 13, v3
    v_lshl_add_u32 v8, v4, 4, v8
    v_add_u32 v8, s7, v8
    v_add_u32 v9, 131072, v8
    v_lshlrev_b32 v10, 13, v7
    v_lshl_add_u32 v10, v4, 4, v10
    s_add_u32 s30, s7, 16777216
    v_add_u32 v10, s30, v10
    v_add_u32 v11, 32768, v10
    buffer_load_dwordx4 v[16:19], v8, s[16:19], 0 offen offset:0 sc1
    buffer_load_dwordx4 v[32:35], v9, s[16:19], 0 offen offset:0 sc1
    buffer_load_dwordx4 v[64:67], v10, s[16:19], 0 offen offset:0 sc1
    buffer_load_dwordx4 v[80:83], v11, s[16:19], 0 offen offset:0 sc1
    buffer_load_dwordx4 v[20:23], v8, s[16:19], 0 offen offset:64 sc1
    buffer_load_dwordx4 v[36:39], v9, s[16:19], 0 offen offset:64 sc1
    buffer_load_dwordx4 v[68:71], v10, s[16:19], 0 offen offset:64 sc1
    buffer_load_dwordx4 v[84:87], v11, s[16:19], 0 offen offset:64 sc1
    buffer_load_dwordx4 v[24:27], v8, s[16:19], 0 offen offset:128 sc1
    buffer_load_dwordx4 v[40:43], v9, s[16:19], 0 offen offset:128 sc1
    buffer_load_dwordx4 v[72:75], v10, s[16:19], 0 offen offset:128 sc1
    buffer_load_dwordx4 v[88:91], v11, s[16:19], 0 offen offset:128 sc1
    buffer_load_dwordx4 v[28:31], v8, s[16:19], 0 offen offset:192 sc1
    buffer_load_dwordx4 v[44:47], v9, s[16:19], 0 offen offset:192 sc1
    buffer_load_dwordx4 v[76:79], v10, s[16:19], 0 offen offset:192 sc1
    buffer_load_dwordx4 v[92:95], v11, s[16:19], 0 offen offset:192 sc1
    s_lshl_b32 s7, s4, 5
    s_add_u32 s7, s7, s5
    s_lshl_b32 s30, s7, 11
    s_add_u32 s30, s30, 67108864
    v_and_b32 v12, 7, v3
    v_lshlrev_b32 v12, 8, v12
    v_lshl_add_u32 v12, v4, 4, v12
    v_add_u32 v12, s30, v12
    s_lshl_b32 s30, s7, 13
    s_add_u32 s30, s30, 33554432
    v_lshlrev_b32 v13, 6, v7
    v_lshl_add_u32 v13, v4, 4, v13
    v_add_u32 v13, s30, v13
    v_add_u32 v14, 4096, v13
    s_lshl_b32 s30, s7, 11
    s_add_u32 s30, s30, 71303168
    v_lshlrev_b32 v15, 4, v7
    v_and_b32 v2, 1, v4
    v_lshl_add_u32 v15, v2, 3, v15
    v_add_u32 v15, s30, v15
    buffer_load_dwordx4 v[96:99], v13, s[16:19], 0 offen offset:0 sc1
    buffer_load_dwordx4 v[100:103], v13, s[16:19], 0 offen offset:256 sc1
    buffer_load_dwordx4 v[104:107], v13, s[16:19], 0 offen offset:2048 sc1
    buffer_load_dwordx4 v[108:111], v13, s[16:19], 0 offen offset:2304 sc1
    buffer_load_dwordx4 v[112:115], v14, s[16:19], 0 offen offset:0 sc1
    buffer_load_dwordx4 v[116:119], v14, s[16:19], 0 offen offset:256 sc1
    buffer_load_dwordx4 v[120:123], v14, s[16:19], 0 offen offset:2048 sc1
    buffer_load_dwordx4 v[124:127], v14, s[16:19], 0 offen offset:2304 sc1
    s_mov_b32 s37, s5
    s_mov_b32 s5, s38
    s_cmp_lg_u32 s39, 0
    s_cbranch_scc1 .wsk_58
    v_and_b32 v250, 31, v0
    v_lshlrev_b32 v250, 2, v250
    s_lshl_b32 s100, s5, 7
    s_add_u32 s100, s100, 109056192
    v_add_u32 v250, s100, v250
    s_mov_b32 s101, 0
.wf_59:
    buffer_load_dword v251, v250, s[16:19], 0 offen sc1
    s_waitcnt vmcnt(0)
    v_cmp_ge_u32 vcc, s95, v251
    s_cbranch_vccz .wfok_60
    s_add_u32 s101, s101, 1
    s_cmp_gt_u32 s101, 200000
    s_cbranch_scc1 .fexit_3
    s_sleep 12
    s_branch .wf_59
.wfok_60:
.wsk_58:
    s_barrier
    s_mov_b32 s5, s37
    buffer_load_dwordx4 v[48:51], v12, s[16:19], 0 offen offset:0 sc1
    buffer_load_dwordx4 v[52:55], v12, s[16:19], 0 offen offset:64 sc1
    buffer_load_dwordx4 v[56:59], v12, s[16:19], 0 offen offset:128 sc1
    buffer_load_dwordx4 v[60:63], v12, s[16:19], 0 offen offset:192 sc1
    buffer_load_dwordx2 v[128:129], v15, s[16:19], 0 offen offset:0 sc1
    buffer_load_dwordx2 v[130:131], v15, s[16:19], 0 offen offset:64 sc1
    buffer_load_dwordx2 v[132:133], v15, s[16:19], 0 offen offset:512 sc1
    buffer_load_dwordx2 v[134:135], v15, s[16:19], 0 offen offset:576 sc1
    buffer_load_dwordx2 v[136:137], v15, s[16:19], 0 offen offset:1024 sc1
    buffer_load_dwordx2 v[138:139], v15, s[16:19], 0 offen offset:1088 sc1
    buffer_load_dwordx2 v[140:141], v15, s[16:19], 0 offen offset:1536 sc1
    buffer_load_dwordx2 v[142:143], v15, s[16:19], 0 offen offset:1600 sc1
    s_lshl_b32 s7, s4, 18
    s_lshl_b32 s30, s5, 8
    s_add_u32 s7, s7, s30
    s_add_u32 s7, s7, 50331648
    v_lshlrev_b32 v8, 13, v3
    v_lshl_add_u32 v8, v4, 4, v8
    v_add_u32 v8, s7, v8
    s_mov_b32 s76, 0
    s_mov_b32 s77, -1
    v_mov_b32 v9, 0xff800000
    v_lshlrev_b32 v10, 3, v4
    s_waitcnt vmcnt(8)
    v_mfma_f32_16x16x32_bf16 v[144:147], v[48:51], v[16:19], 0
    v_mfma_f32_16x16x32_bf16 v[148:151], v[64:67], v[16:19], 0
    v_mfma_f32_16x16x32_bf16 v[152:155], v[80:83], v[16:19], 0
    v_mfma_f32_16x16x32_bf16 v[144:147], v[52:55], v[20:23], v[144:147]
    v_mfma_f32_16x16x32_bf16 v[148:151], v[68:71], v[20:23], v[148:151]
    v_mfma_f32_16x16x32_bf16 v[152:155], v[84:87], v[20:23], v[152:155]
    v_mfma_f32_16x16x32_bf16 v[144:147], v[56:59], v[24:27], v[144:147]
    v_mfma_f32_16x16x32_bf16 v[148:151], v[72:75], v[24:27], v[148:151]
    v_mfma_f32_16x16x32_bf16 v[152:155], v[88:91], v[24:27], v[152:155]
    v_mfma_f32_16x16x32_bf16 v[144:147], v[60:63], v[28:31], v[144:147]
    v_mfma_f32_16x16x32_bf16 v[148:151], v[76:79], v[28:31], v[148:151]
    v_mfma_f32_16x16x32_bf16 v[152:155], v[92:95], v[28:31], v[152:155]
    v_mfma_f32_16x16x32_bf16 v[156:159], v[48:51], v[32:35], 0
    v_mfma_f32_16x16x32_bf16 v[160:163], v[64:67], v[32:35], 0
    v_mfma_f32_16x16x32_bf16 v[164:167], v[80:83], v[32:35], 0
    v_mfma_f32_16x16x32_bf16 v[156:159], v[52:55], v[36:39], v[156:159]
    v_mfma_f32_16x16x32_bf16 v[160:163], v[68:71], v[36:39], v[160:163]
    v_mfma_f32_16x16x32_bf16 v[164:167], v[84:87], v[36:39], v[164:167]
    v_mfma_f32_16x16x32_bf16 v[156:159], v[56:59], v[40:43], v[156:159]
    v_mfma_f32_16x16x32_bf16 v[160:163], v[72:75], v[40:43], v[160:163]
    v_mfma_f32_16x16x32_bf16 v[164:167], v[88:91], v[40:43], v[164:167]
    v_mfma_f32_16x16x32_bf16 v[156:159], v[60:63], v[44:47], v[156:159]
    v_mfma_f32_16x16x32_bf16 v[160:163], v[76:79], v[44:47], v[160:163]
    v_mfma_f32_16x16x32_bf16 v[164:167], v[92:95], v[44:47], v[164:167]
    s_nop 7
    v_cvt_pk_bf16_f32 v170, v144, v145
    v_lshlrev_b32 v171, 16, v170
    v_and_b32 v172, 0xffff0000, v170
    v_mul_f32 v171, 0x3db504f3, v171
    v_mul_f32 v172, 0x3db504f3, v172
    v_cvt_pk_bf16_f32 v170, v171, v172
    v_lshlrev_b32 v144, 16, v170
    v_and_b32 v145, 0xffff0000, v170
    v_cvt_pk_bf16_f32 v170, v146, v147
    v_lshlrev_b32 v171, 16, v170
    v_and_b32 v172, 0xffff0000, v170
    v_mul_f32 v171, 0x3db504f3, v171
    v_mul_f32 v172, 0x3db504f3, v172
    v_cvt_pk_bf16_f32 v170, v171, v172
    v_lshlrev_b32 v146, 16, v170
    v_and_b32 v147, 0xffff0000, v170
    v_cvt_pk_bf16_f32 v170, v148, v149
    v_lshlrev_b32 v171, 16, v170
    v_and_b32 v172, 0xffff0000, v170
    v_mul_f32 v171, 0x3db504f3, v171
    v_mul_f32 v172, 0x3db504f3, v172
    v_cvt_pk_bf16_f32 v170, v171, v172
    v_lshlrev_b32 v148, 16, v170
    v_and_b32 v149, 0xffff0000, v170
    v_cvt_pk_bf16_f32 v170, v150, v151
    v_lshlrev_b32 v171, 16, v170
    v_and_b32 v172, 0xffff0000, v170
    v_mul_f32 v171, 0x3db504f3, v171
    v_mul_f32 v172, 0x3db504f3, v172
    v_cvt_pk_bf16_f32 v170, v171, v172
    v_lshlrev_b32 v150, 16, v170
    v_and_b32 v151, 0xffff0000, v170
    v_cvt_pk_bf16_f32 v170, v152, v153
    v_lshlrev_b32 v171, 16, v170
    v_and_b32 v172, 0xffff0000, v170
    v_mul_f32 v171, 0x3db504f3, v171
    v_mul_f32 v172, 0x3db504f3, v172
    v_cvt_pk_bf16_f32 v170, v171, v172
    v_lshlrev_b32 v152, 16, v170
    v_and_b32 v153, 0xffff0000, v170
    v_cvt_pk_bf16_f32 v170, v154, v155
    v_lshlrev_b32 v171, 16, v170
    v_and_b32 v172, 0xffff0000, v170
    v_mul_f32 v171, 0x3db504f3, v171
    v_mul_f32 v172, 0x3db504f3, v172
    v_cvt_pk_bf16_f32 v170, v171, v172
    v_lshlrev_b32 v154, 16, v170
    v_and_b32 v155, 0xffff0000, v170
    v_cndmask_b32 v144, v144, v9, s[76:77]
    v_cndmask_b32 v145, v145, v9, s[76:77]
    v_cndmask_b32 v146, v146, v9, s[76:77]
    v_cndmask_b32 v147, v147, v9, s[76:77]
    v_add_u32 v170, 0, v10
    v_cmp_gt_i32 vcc, v170, v3
    s_nop 1
    v_cndmask_b32 v148, v148, v9, vcc
    v_add_u32 v170, 1, v10
    v_cmp_gt_i32 vcc, v170, v3
    s_nop 1
    v_cndmask_b32 v149, v149, v9, vcc
    v_add_u32 v170, 2, v10
    v_cmp_gt_i32 vcc, v170, v3
    s_nop 1
    v_cndmask_b32 v150, v150, v9, vcc
    v_add_u32 v170, 3, v10
    v_cmp_gt_i32 vcc, v170, v3
    s_nop 1
    v_cndmask_b32 v151, v151, v9, vcc
    v_add_u32 v170, 4, v10
    v_cmp_gt_i32 vcc, v170, v3
    s_nop 1
    v_cndmask_b32 v152, v152, v9, vcc
    v_add_u32 v170, 5, v10
    v_cmp_gt_i32 vcc, v170, v3
    s_nop 1
    v_cndmask_b32 v153, v153, v9, vcc
    v_add_u32 v170, 6, v10
    v_cmp_gt_i32 vcc, v170, v3
    s_nop 1
    v_cndmask_b32 v154, v154, v9, vcc
    v_add_u32 v170, 7, v10
    v_cmp_gt_i32 vcc, v170, v3
    s_nop 1
    v_cndmask_b32 v155, v155, v9, vcc
    v_max3_f32 v170, v144, v145, v146
    v_max3_f32 v171, v147, v148, v149
    v_max3_f32 v172, v150, v151, v152
    v_max3_f32 v173, v153, v154, v155
    v_max3_f32 v170, v170, v171, v172
    v_max_f32 v170, v170, v173
    v_mov_b32 v171, v170
    s_nop 1
    v_permlane32_swap_b32 v170, v171
    v_max_f32 v170, v170, v171
    v_mov_b32 v171, v170
    s_nop 1
    v_permlane16_swap_b32 v170, v171
    v_max_f32 v170, v170, v171
    v_mul_f32 v170, 0xbfb8aa3b, v170
    v_mov_b32 v171, v170
    v_mov_b32 v172, 0x3fb8aa3b
    v_mov_b32 v173, 0x3fb8aa3b
    v_pk_fma_f32 v[144:145], v[144:145], v[172:173], v[170:171]
    v_pk_fma_f32 v[146:147], v[146:147], v[172:173], v[170:171]
    v_pk_fma_f32 v[148:149], v[148:149], v[172:173], v[170:171]
    v_pk_fma_f32 v[150:151], v[150:151], v[172:173], v[170:171]
    v_pk_fma_f32 v[152:153], v[152:153], v[172:173], v[170:171]
    v_pk_fma_f32 v[154:155], v[154:155], v[172:173], v[170:171]
    v_exp_f32 v144, v144
    v_exp_f32 v145, v145
    v_exp_f32 v146, v146
    v_exp_f32 v147, v147
    v_exp_f32 v148, v148
    v_exp_f32 v149, v149
    v_exp_f32 v150, v150
    v_exp_f32 v151, v151
    v_exp_f32 v152, v152
    v_exp_f32 v153, v153
    v_exp_f32 v154, v154
    v_exp_f32 v155, v155
    s_nop 0
    v_pk_add_f32 v[170:171], v[144:145], v[146:147]
    v_pk_add_f32 v[172:173], v[148:149], v[150:151]
    v_pk_add_f32 v[174:175], v[152:153], v[154:155]
    v_pk_add_f32 v[170:171], v[170:171], v[172:173]
    v_pk_add_f32 v[170:171], v[170:171], v[174:175]
    v_add_f32 v170, v170, v171
    v_mov_b32 v171, v170
    s_nop 1
    v_permlane32_swap_b32 v170, v171
    v_add_f32 v170, v170, v171
    v_mov_b32 v171, v170
    s_nop 1
    v_permlane16_swap_b32 v170, v171
    v_add_f32 v170, v170, v171
    v_rcp_f32 v170, v170
    s_nop 0
    v_mov_b32 v171, v170
    v_pk_mul_f32 v[144:145], v[144:145], v[170:171]
    v_pk_mul_f32 v[146:147], v[146:147], v[170:171]
    v_pk_mul_f32 v[148:149], v[148:149], v[170:171]
    v_pk_mul_f32 v[150:151], v[150:151], v[170:171]
    v_pk_mul_f32 v[152:153], v[152:153], v[170:171]
    v_pk_mul_f32 v[154:155], v[154:155], v[170:171]
    v_cvt_pk_bf16_f32 v176, v144, v145
    v_cvt_pk_bf16_f32 v177, v146, v147
    v_cvt_pk_bf16_f32 v178, v148, v149
    v_cvt_pk_bf16_f32 v179, v150, v151
    v_cvt_pk_bf16_f32 v180, v152, v153
    v_cvt_pk_bf16_f32 v181, v154, v155
    v_cvt_pk_bf16_f32 v170, v156, v157
    v_lshlrev_b32 v171, 16, v170
    v_and_b32 v172, 0xffff0000, v170
    v_mul_f32 v171, 0x3db504f3, v171
    v_mul_f32 v172, 0x3db504f3, v172
    v_cvt_pk_bf16_f32 v170, v171, v172
    v_lshlrev_b32 v156, 16, v170
    v_and_b32 v157, 0xffff0000, v170
    v_cvt_pk_bf16_f32 v170, v158, v159
    v_lshlrev_b32 v171, 16, v170
    v_and_b32 v172, 0xffff0000, v170
    v_mul_f32 v171, 0x3db504f3, v171
    v_mul_f32 v172, 0x3db504f3, v172
    v_cvt_pk_bf16_f32 v170, v171, v172
    v_lshlrev_b32 v158, 16, v170
    v_and_b32 v159, 0xffff0000, v170
    v_cvt_pk_bf16_f32 v170, v160, v161
    v_lshlrev_b32 v171, 16, v170
    v_and_b32 v172, 0xffff0000, v170
    v_mul_f32 v171, 0x3db504f3, v171
    v_mul_f32 v172, 0x3db504f3, v172
    v_cvt_pk_bf16_f32 v170, v171, v172
    v_lshlrev_b32 v160, 16, v170
    v_and_b32 v161, 0xffff0000, v170
    v_cvt_pk_bf16_f32 v170, v162, v163
    v_lshlrev_b32 v171, 16, v170
    v_and_b32 v172, 0xffff0000, v170
    v_mul_f32 v171, 0x3db504f3, v171
    v_mul_f32 v172, 0x3db504f3, v172
    v_cvt_pk_bf16_f32 v170, v171, v172
    v_lshlrev_b32 v162, 16, v170
    v_and_b32 v163, 0xffff0000, v170
    v_cvt_pk_bf16_f32 v170, v164, v165
    v_lshlrev_b32 v171, 16, v170
    v_and_b32 v172, 0xffff0000, v170
    v_mul_f32 v171, 0x3db504f3, v171
    v_mul_f32 v172, 0x3db504f3, v172
    v_cvt_pk_bf16_f32 v170, v171, v172
    v_lshlrev_b32 v164, 16, v170
    v_and_b32 v165, 0xffff0000, v170
    v_cvt_pk_bf16_f32 v170, v166, v167
    v_lshlrev_b32 v171, 16, v170
    v_and_b32 v172, 0xffff0000, v170
    v_mul_f32 v171, 0x3db504f3, v171
    v_mul_f32 v172, 0x3db504f3, v172
    v_cvt_pk_bf16_f32 v170, v171, v172
    v_lshlrev_b32 v166, 16, v170
    v_and_b32 v167, 0xffff0000, v170
    v_cndmask_b32 v156, v156, v9, s[76:77]
    v_cndmask_b32 v157, v157, v9, s[76:77]
    v_cndmask_b32 v158, v158, v9, s[76:77]
    v_cndmask_b32 v159, v159, v9, s[76:77]
    v_add_u32 v170, 4294967280, v10
    v_cmp_gt_i32 vcc, v170, v3
    s_nop 1
    v_cndmask_b32 v160, v160, v9, vcc
    v_add_u32 v170, 4294967281, v10
    v_cmp_gt_i32 vcc, v170, v3
    s_nop 1
    v_cndmask_b32 v161, v161, v9, vcc
    v_add_u32 v170, 4294967282, v10
    v_cmp_gt_i32 vcc, v170, v3
    s_nop 1
    v_cndmask_b32 v162, v162, v9, vcc
    v_add_u32 v170, 4294967283, v10
    v_cmp_gt_i32 vcc, v170, v3
    s_nop 1
    v_cndmask_b32 v163, v163, v9, vcc
    v_add_u32 v170, 4294967284, v10
    v_cmp_gt_i32 vcc, v170, v3
    s_nop 1
    v_cndmask_b32 v164, v164, v9, vcc
    v_add_u32 v170, 4294967285, v10
    v_cmp_gt_i32 vcc, v170, v3
    s_nop 1
    v_cndmask_b32 v165, v165, v9, vcc
    v_add_u32 v170, 4294967286, v10
    v_cmp_gt_i32 vcc, v170, v3
    s_nop 1
    v_cndmask_b32 v166, v166, v9, vcc
    v_add_u32 v170, 4294967287, v10
    v_cmp_gt_i32 vcc, v170, v3
    s_nop 1
    v_cndmask_b32 v167, v167, v9, vcc
    v_max3_f32 v170, v156, v157, v158
    v_max3_f32 v171, v159, v160, v161
    v_max3_f32 v172, v162, v163, v164
    v_max3_f32 v173, v165, v166, v167
    v_max3_f32 v170, v170, v171, v172
    v_max_f32 v170, v170, v173
    v_mov_b32 v171, v170
    s_nop 1
    v_permlane32_swap_b32 v170, v171
    v_max_f32 v170, v170, v171
    v_mov_b32 v171, v170
    s_nop 1
    v_permlane16_swap_b32 v170, v171
    v_max_f32 v170, v170, v171
    v_mul_f32 v170, 0xbfb8aa3b, v170
    v_mov_b32 v171, v170
    v_mov_b32 v172, 0x3fb8aa3b
    v_mov_b32 v173, 0x3fb8aa3b
    v_pk_fma_f32 v[156:157], v[156:157], v[172:173], v[170:171]
    v_pk_fma_f32 v[158:159], v[158:159], v[172:173], v[170:171]
    v_pk_fma_f32 v[160:161], v[160:161], v[172:173], v[170:171]
    v_pk_fma_f32 v[162:163], v[162:163], v[172:173], v[170:171]
    v_pk_fma_f32 v[164:165], v[164:165], v[172:173], v[170:171]
    v_pk_fma_f32 v[166:167], v[166:167], v[172:173], v[170:171]
    v_exp_f32 v156, v156
    v_exp_f32 v157, v157
    v_exp_f32 v158, v158
    v_exp_f32 v159, v159
    v_exp_f32 v160, v160
    v_exp_f32 v161, v161
    v_exp_f32 v162, v162
    v_exp_f32 v163, v163
    v_exp_f32 v164, v164
    v_exp_f32 v165, v165
    v_exp_f32 v166, v166
    v_exp_f32 v167, v167
    s_nop 0
    v_pk_add_f32 v[170:171], v[156:157], v[158:159]
    v_pk_add_f32 v[172:173], v[160:161], v[162:163]
    v_pk_add_f32 v[174:175], v[164:165], v[166:167]
    v_pk_add_f32 v[170:171], v[170:171], v[172:173]
    v_pk_add_f32 v[170:171], v[170:171], v[174:175]
    v_add_f32 v170, v170, v171
    v_mov_b32 v171, v170
    s_nop 1
    v_permlane32_swap_b32 v170, v171
    v_add_f32 v170, v170, v171
    v_mov_b32 v171, v170
    s_nop 1
    v_permlane16_swap_b32 v170, v171
    v_add_f32 v170, v170, v171
    v_rcp_f32 v170, v170
    s_nop 0
    v_mov_b32 v171, v170
    v_pk_mul_f32 v[156:157], v[156:157], v[170:171]
    v_pk_mul_f32 v[158:159], v[158:159], v[170:171]
    v_pk_mul_f32 v[160:161], v[160:161], v[170:171]
    v_pk_mul_f32 v[162:163], v[162:163], v[170:171]
    v_pk_mul_f32 v[164:165], v[164:165], v[170:171]
    v_pk_mul_f32 v[166:167], v[166:167], v[170:171]
    v_cvt_pk_bf16_f32 v182, v156, v157
    v_cvt_pk_bf16_f32 v183, v158, v159
    v_cvt_pk_bf16_f32 v184, v160, v161
    v_cvt_pk_bf16_f32 v185, v162, v163
    v_cvt_pk_bf16_f32 v186, v164, v165
    v_cvt_pk_bf16_f32 v187, v166, v167
    s_waitcnt vmcnt(0)
    s_nop 1
    v_mfma_f32_16x16x32_bf16 v[16:19], v[96:99], v[178:181], 0
    v_mfma_f32_16x16x32_bf16 v[20:23], v[100:103], v[178:181], 0
    v_mfma_f32_16x16x32_bf16 v[24:27], v[104:107], v[178:181], 0
    v_mfma_f32_16x16x32_bf16 v[28:31], v[108:111], v[178:181], 0
    v_mfma_f32_16x16x32_bf16 v[32:35], v[112:115], v[178:181], 0
    v_mfma_f32_16x16x32_bf16 v[36:39], v[116:119], v[178:181], 0
    v_mfma_f32_16x16x32_bf16 v[40:43], v[120:123], v[178:181], 0
    v_mfma_f32_16x16x32_bf16 v[44:47], v[124:127], v[178:181], 0
    v_mfma_f32_16x16x16_bf16 v[16:19], v[128:129], v[176:177], v[16:19]
    v_mfma_f32_16x16x16_bf16 v[20:23], v[130:131], v[176:177], v[20:23]
    v_mfma_f32_16x16x16_bf16 v[24:27], v[132:133], v[176:177], v[24:27]
    v_mfma_f32_16x16x16_bf16 v[28:31], v[134:135], v[176:177], v[28:31]
    v_mfma_f32_16x16x16_bf16 v[32:35], v[136:137], v[176:177], v[32:35]
    v_mfma_f32_16x16x16_bf16 v[36:39], v[138:139], v[176:177], v[36:39]
    v_mfma_f32_16x16x16_bf16 v[40:43], v[140:141], v[176:177], v[40:43]
    v_mfma_f32_16x16x16_bf16 v[44:47], v[142:143], v[176:177], v[44:47]
    v_mfma_f32_16x16x32_bf16 v[48:51], v[96:99], v[184:187], 0
    v_mfma_f32_16x16x32_bf16 v[52:55], v[100:103], v[184:187], 0
    v_mfma_f32_16x16x32_bf16 v[56:59], v[104:107], v[184:187], 0
    v_mfma_f32_16x16x32_bf16 v[60:63], v[108:111], v[184:187], 0
    v_mfma_f32_16x16x32_bf16 v[64:67], v[112:115], v[184:187], 0
    v_mfma_f32_16x16x32_bf16 v[68:71], v[116:119], v[184:187], 0
    v_mfma_f32_16x16x32_bf16 v[72:75], v[120:123], v[184:187], 0
    v_mfma_f32_16x16x32_bf16 v[76:79], v[124:127], v[184:187], 0
    v_mfma_f32_16x16x16_bf16 v[48:51], v[128:129], v[182:183], v[48:51]
    v_mfma_f32_16x16x16_bf16 v[52:55], v[130:131], v[182:183], v[52:55]
    v_mfma_f32_16x16x16_bf16 v[56:59], v[132:133], v[182:183], v[56:59]
    v_mfma_f32_16x16x16_bf16 v[60:63], v[134:135], v[182:183], v[60:63]
    v_mfma_f32_16x16x16_bf16 v[64:67], v[136:137], v[182:183], v[64:67]
    v_mfma_f32_16x16x16_bf16 v[68:71], v[138:139], v[182:183], v[68:71]
    v_mfma_f32_16x16x16_bf16 v[72:75], v[140:141], v[182:183], v[72:75]
    v_mfma_f32_16x16x16_bf16 v[76:79], v[142:143], v[182:183], v[76:79]
    s_nop 7
    v_add_u32 v11, 131072, v8
    v_cvt_pk_bf16_f32 v144, v16, v17
    v_cvt_pk_bf16_f32 v145, v18, v19
    v_cvt_pk_bf16_f32 v146, v20, v21
    v_cvt_pk_bf16_f32 v147, v22, v23
    buffer_store_dwordx4 v[144:147], v8, s[16:19], 0 offen offset:0 sc1
    s_nop 1
    v_cvt_pk_bf16_f32 v144, v24, v25
    v_cvt_pk_bf16_f32 v145, v26, v27
    v_cvt_pk_bf16_f32 v146, v28, v29
    v_cvt_pk_bf16_f32 v147, v30, v31
    buffer_store_dwordx4 v[144:147], v8, s[16:19], 0 offen offset:64 sc1
    s_nop 1
    v_cvt_pk_bf16_f32 v144, v32, v33
    v_cvt_pk_bf16_f32 v145, v34, v35
    v_cvt_pk_bf16_f32 v146, v36, v37
    v_cvt_pk_bf16_f32 v147, v38, v39
    buffer_store_dwordx4 v[144:147], v8, s[16:19], 0 offen offset:128 sc1
    s_nop 1
    v_cvt_pk_bf16_f32 v144, v40, v41
    v_cvt_pk_bf16_f32 v145, v42, v43
    v_cvt_pk_bf16_f32 v146, v44, v45
    v_cvt_pk_bf16_f32 v147, v46, v47
    buffer_store_dwordx4 v[144:147], v8, s[16:19], 0 offen offset:192 sc1
    s_nop 1
    v_cvt_pk_bf16_f32 v144, v48, v49
    v_cvt_pk_bf16_f32 v145, v50, v51
    v_cvt_pk_bf16_f32 v146, v52, v53
    v_cvt_pk_bf16_f32 v147, v54, v55
    buffer_store_dwordx4 v[144:147], v11, s[16:19], 0 offen offset:0 sc1
    s_nop 1
    v_cvt_pk_bf16_f32 v144, v56, v57
    v_cvt_pk_bf16_f32 v145, v58, v59
    v_cvt_pk_bf16_f32 v146, v60, v61
    v_cvt_pk_bf16_f32 v147, v62, v63
    buffer_store_dwordx4 v[144:147], v11, s[16:19], 0 offen offset:64 sc1
    s_nop 1
    v_cvt_pk_bf16_f32 v144, v64, v65
    v_cvt_pk_bf16_f32 v145, v66, v67
    v_cvt_pk_bf16_f32 v146, v68, v69
    v_cvt_pk_bf16_f32 v147, v70, v71
    buffer_store_dwordx4 v[144:147], v11, s[16:19], 0 offen offset:128 sc1
    s_nop 1
    v_cvt_pk_bf16_f32 v144, v72, v73
    v_cvt_pk_bf16_f32 v145, v74, v75
    v_cvt_pk_bf16_f32 v146, v76, v77
    v_cvt_pk_bf16_f32 v147, v78, v79
    buffer_store_dwordx4 v[144:147], v11, s[16:19], 0 offen offset:192 sc1
    s_nop 1
    s_branch .wloop_21
.tO_30:
    s_cmp_eq_u32 s4, 0
    s_cbranch_scc1 .wloop_21
    s_sub_u32 s95, s4, 1
    s_cmp_ge_u32 s4, 56
    s_cselect_b32 s3, 40, 10
    s_mul_i32 s3, s95, s3
    s_add_u32 s3, s3, s5
    s_sub_u32 s3, s3, 8
    s_cmp_lg_u32 s39, 0
    s_cbranch_scc1 .wsk_61
    v_mov_b32 v250, 109064704
    s_mov_b32 s101, 0
.wp_62:
    buffer_load_dword v251, v250, s[16:19], 0 offen sc1
    s_waitcnt vmcnt(0)
    v_readfirstlane_b32 s100, v251
    s_add_u32 s100, s100, 1
    s_cmp_ge_u32 s100, s95
    s_cbranch_scc1 .wpok_63
    s_add_u32 s101, s101, 1
    s_cmp_gt_u32 s101, 100000
    s_cbranch_scc1 .fexit_3
    s_sub_u32 s100, s95, s100
.wps_64:
    s_sleep 110
    s_sub_u32 s100, s100, 1
    s_cmp_lg_u32 s100, 0
    s_cbranch_scc1 .wps_64
    s_branch .wp_62
.wpok_63:
    s_lshr_b32 s100, s95, 1
    s_lshl_b32 s100, s100, 6
    s_add_u32 s100, s100, 109054080
    v_mov_b32 v250, s100
    s_mov_b32 s101, 0
.ww_65:
    buffer_load_dword v251, v250, s[16:19], 0 offen sc1
    s_waitcnt vmcnt(0)
    v_readfirstlane_b32 s100, v251
    s_cmp_ge_u32 s100, 5
    s_cbranch_scc1 .wok_66
    s_add_u32 s101, s101, 1
    s_cmp_gt_u32 s101, 200000
    s_cbranch_scc1 .fexit_3
    s_sleep 24
    s_branch .ww_65
.wok_66:
    s_mov_b32 s100, 109056128
    v_mov_b32 v250, s100
    s_mov_b32 s101, 0
.ww_67:
    buffer_load_dword v251, v250, s[16:19], 0 offen sc1
    s_waitcnt vmcnt(0)
    v_readfirstlane_b32 s100, v251
    s_cmp_ge_u32 s100, 64
    s_cbranch_scc1 .wok_68
    s_add_u32 s101, s101, 1
    s_cmp_gt_u32 s101, 200000
    s_cbranch_scc1 .fexit_3
    s_sleep 24
    s_branch .ww_67
.wok_68:
.wsk_61:
    s_barrier
    s_cmp_ge_u32 s95, 55
    s_cbranch_scc1 .tOS_69
    s_cmp_lg_u32 s39, 0
    s_cbranch_scc1 .wsk_70
    s_lshl_b32 s100, s95, 6
    s_add_u32 s100, s100, 109060288
    v_mov_b32 v250, s100
    s_mov_b32 s101, 0
.ww_71:
    buffer_load_dword v251, v250, s[16:19], 0 offen sc1
    s_waitcnt vmcnt(0)
    v_readfirstlane_b32 s100, v251
    s_cmp_ge_u32 s100, 8
    s_cbranch_scc1 .wok_72
    s_add_u32 s101, s101, 1
    s_cmp_gt_u32 s101, 200000
    s_cbranch_scc1 .fexit_3
    s_sleep 8
    s_branch .ww_71
.wok_72:
.wsk_70:
    s_barrier
    s_mov_b32 s12, s56
    s_and_b32 s13, s57, 0xffff
    s_mov_b32 s14, 5242880
    s_mov_b32 s15, 0x00020000
    s_mul_i32 s30, s3, 52429
    s_lshr_b32 s30, s30, 19
    s_mul_i32 s31, s30, 10
    s_sub_u32 s31, s3, s31
    v_and_b32 v7, 63, v0
    v_lshrrev_b32 v20, 6, v0
    s_nop 0
    v_readfirstlane_b32 s6, v20
    v_and_b32 v24, 15, v7
    v_lshrrev_b32 v25, 4, v7
    v_lshrrev_b32 v26, 2, v24
    v_and_b32 v27, 3, v24
    s_mul_i32 s32, s6, 13824
    v_lshrrev_b32 v20, 3, v7
    v_and_b32 v21, 7, v7
    v_mul_u32_u24 v3, 144, v20
    v_lshl_add_u32 v3, v21, 4, v3
    v_add_u32 v3, s32, v3
    s_lshl_b32 s7, s30, 5
    v_add_u32 v28, s7, v20
    v_lshlrev_b32 v8, 13, v28
    v_lshl_add_u32 v8, v21, 4, v8
    s_lshl_b32 s7, s6, 11

    s_add_u32 s7, s7, 50331648
    v_add_u32 v8, s7, v8
    v_add_u32 v9, 0x10000, v8
    v_add_u32 v10, 0x20000, v8
    v_add_u32 v11, 0x30000, v8
    v_mul_u32_u24 v12, 1280, v20
    v_lshl_add_u32 v12, v21, 4, v12
    s_mul_i32 s7, s6, 1310720
    s_lshl_b32 s33, s31, 7
    s_add_u32 s7, s7, s33
    v_add_u32 v12, s7, v12
    v_lshl_add_u32 v28, v26, 3, v27
    v_mul_u32_u24 v5, 144, v28
    v_lshl_add_u32 v5, v25, 4, v5
    v_add_u32 v5, s32, v5
    v_lshl_add_u32 v28, v25, 3, v26
    v_mul_u32_u24 v6, 144, v28
    v_lshl_add_u32 v6, v27, 4, v6
    v_add_u32 v6, s32, v6
    v_add_u32 v6, 4608, v6
    s_mov_b32 s34, 0
    s_mov_b32 s35, 0
    v_mov_b32 v64, 0
    v_mov_b32 v65, 0
    v_mov_b32 v66, 0
    v_mov_b32 v67, 0
    v_mov_b32 v68, 0
    v_mov_b32 v69, 0
    v_mov_b32 v70, 0
    v_mov_b32 v71, 0
    v_mov_b32 v72, 0
    v_mov_b32 v73, 0
    v_mov_b32 v74, 0
    v_mov_b32 v75, 0
    v_mov_b32 v76, 0
    v_mov_b32 v77, 0
    v_mov_b32 v78, 0
    v_mov_b32 v79, 0
    v_mov_b32 v80, 0
    v_mov_b32 v81, 0
    v_mov_b32 v82, 0
    v_mov_b32 v83, 0
    v_mov_b32 v84, 0
    v_mov_b32 v85, 0
    v_mov_b32 v86, 0
    v_mov_b32 v87, 0
    v_mov_b32 v88, 0
    v_mov_b32 v89, 0
    v_mov_b32 v90, 0
    v_mov_b32 v91, 0
    v_mov_b32 v92, 0
    v_mov_b32 v93, 0
    v_mov_b32 v94, 0
    v_mov_b32 v95, 0
    buffer_load_dwordx4 v[128:131], v8, s[16:19], s34 offen sc1
    buffer_load_dwordx4 v[132:135], v9, s[16:19], s34 offen sc1
    buffer_load_dwordx4 v[136:139], v10, s[16:19], s34 offen sc1
    buffer_load_dwordx4 v[140:143], v11, s[16:19], s34 offen sc1
    s_add_u32 s36, s35, 0
    buffer_load_dwordx4 v[144:147], v12, s[12:15], s36 offen
    s_add_u32 s36, s35, 10240
    buffer_load_dwordx4 v[148:151], v12, s[12:15], s36 offen
    s_add_u32 s36, s35, 20480
    buffer_load_dwordx4 v[152:155], v12, s[12:15], s36 offen
    s_add_u32 s36, s35, 30720
    buffer_load_dwordx4 v[156:159], v12, s[12:15], s36 offen
    s_add_u32 s36, s35, 40960
    buffer_load_dwordx4 v[160:163], v12, s[12:15], s36 offen
    s_add_u32 s36, s35, 51200
    buffer_load_dwordx4 v[164:167], v12, s[12:15], s36 offen
    s_add_u32 s36, s35, 61440
    buffer_load_dwordx4 v[168:171], v12, s[12:15], s36 offen
    s_add_u32 s36, s35, 71680
    buffer_load_dwordx4 v[172:175], v12, s[12:15], s36 offen
    s_add_u32 s34, s34, 128
    s_add_u32 s35, s35, 81920
    buffer_load_dwordx4 a[0:3], v8, s[16:19], s34 offen sc1
    buffer_load_dwordx4 a[4:7], v9, s[16:19], s34 offen sc1
    buffer_load_dwordx4 a[8:11], v10, s[16:19], s34 offen sc1
    buffer_load_dwordx4 a[12:15], v11, s[16:19], s34 offen sc1
    s_add_u32 s36, s35, 0
    buffer_load_dwordx4 a[16:19], v12, s[12:15], s36 offen
    s_add_u32 s36, s35, 10240
    buffer_load_dwordx4 a[20:23], v12, s[12:15], s36 offen
    s_add_u32 s36, s35, 20480
    buffer_load_dwordx4 a[24:27], v12, s[12:15], s36 offen
    s_add_u32 s36, s35, 30720
    buffer_load_dwordx4 a[28:31], v12, s[12:15], s36 offen
    s_add_u32 s36, s35, 40960
    buffer_load_dwordx4 a[32:35], v12, s[12:15], s36 offen
    s_add_u32 s36, s35, 51200
    buffer_load_dwordx4 a[36:39], v12, s[12:15], s36 offen
    s_add_u32 s36, s35, 61440
    buffer_load_dwordx4 a[40:43], v12, s[12:15], s36 offen
    s_add_u32 s36, s35, 71680
    buffer_load_dwordx4 a[44:47], v12, s[12:15], s36 offen
    s_add_u32 s34, s34, 128
    s_add_u32 s35, s35, 81920
    buffer_load_dwordx4 a[48:51], v8, s[16:19], s34 offen sc1
    buffer_load_dwordx4 a[52:55], v9, s[16:19], s34 offen sc1
    buffer_load_dwordx4 a[56:59], v10, s[16:19], s34 offen sc1
    buffer_load_dwordx4 a[60:63], v11, s[16:19], s34 offen sc1
    s_add_u32 s36, s35, 0
    buffer_load_dwordx4 a[64:67], v12, s[12:15], s36 offen
    s_add_u32 s36, s35, 10240
    buffer_load_dwordx4 a[68:71], v12, s[12:15], s36 offen
    s_add_u32 s36, s35, 20480
    buffer_load_dwordx4 a[72:75], v12, s[12:15], s36 offen
    s_add_u32 s36, s35, 30720
    buffer_load_dwordx4 a[76:79], v12, s[12:15], s36 offen
    s_add_u32 s36, s35, 40960
    buffer_load_dwordx4 a[80:83], v12, s[12:15], s36 offen
    s_add_u32 s36, s35, 51200
    buffer_load_dwordx4 a[84:87], v12, s[12:15], s36 offen
    s_add_u32 s36, s35, 61440
    buffer_load_dwordx4 a[88:91], v12, s[12:15], s36 offen
    s_add_u32 s36, s35, 71680
    buffer_load_dwordx4 a[92:95], v12, s[12:15], s36 offen
    s_add_u32 s34, s34, 128
    s_add_u32 s35, s35, 81920
    buffer_load_dwordx4 a[96:99], v8, s[16:19], s34 offen sc1
    buffer_load_dwordx4 a[100:103], v9, s[16:19], s34 offen sc1
    buffer_load_dwordx4 a[104:107], v10, s[16:19], s34 offen sc1
    buffer_load_dwordx4 a[108:111], v11, s[16:19], s34 offen sc1
    s_add_u32 s36, s35, 0
    buffer_load_dwordx4 a[112:115], v12, s[12:15], s36 offen
    s_add_u32 s36, s35, 10240
    buffer_load_dwordx4 a[116:119], v12, s[12:15], s36 offen
    s_add_u32 s36, s35, 20480
    buffer_load_dwordx4 a[120:123], v12, s[12:15], s36 offen
    s_add_u32 s36, s35, 30720
    buffer_load_dwordx4 a[124:127], v12, s[12:15], s36 offen
    s_add_u32 s36, s35, 40960
    buffer_load_dwordx4 a[128:131], v12, s[12:15], s36 offen
    s_add_u32 s36, s35, 51200
    buffer_load_dwordx4 a[132:135], v12, s[12:15], s36 offen
    s_add_u32 s36, s35, 61440
    buffer_load_dwordx4 a[136:139], v12, s[12:15], s36 offen
    s_add_u32 s36, s35, 71680
    buffer_load_dwordx4 a[140:143], v12, s[12:15], s36 offen
    s_add_u32 s34, s34, 128
    s_add_u32 s35, s35, 81920
    s_mov_b32 s5, 0
.o2l_73:
    s_waitcnt vmcnt(36)
    ds_write_b128 v3, v[128:131] offset:0
    ds_write_b128 v3, v[132:135] offset:1152
    ds_write_b128 v3, v[136:139] offset:2304
    ds_write_b128 v3, v[140:143] offset:3456
    ds_write_b128 v3, v[144:147] offset:4608
    ds_write_b128 v3, v[148:151] offset:5760
    ds_write_b128 v3, v[152:155] offset:6912
    ds_write_b128 v3, v[156:159] offset:8064
    ds_write_b128 v3, v[160:163] offset:9216
    ds_write_b128 v3, v[164:167] offset:10368
    ds_write_b128 v3, v[168:171] offset:11520
    ds_write_b128 v3, v[172:175] offset:12672
    ds_read_b128 v[16:19], v5 offset:0
    ds_read_b128 v[20:23], v5 offset:576
    ds_read_b64_tr_b16 v[32:33], v6 offset:0
    ds_read_b64_tr_b16 v[34:35], v6 offset:576
    ds_read_b64_tr_b16 v[36:37], v6 offset:8
    ds_read_b64_tr_b16 v[38:39], v6 offset:584
    ds_read_b64_tr_b16 v[40:41], v6 offset:64
    ds_read_b64_tr_b16 v[42:43], v6 offset:640
    ds_read_b64_tr_b16 v[44:45], v6 offset:72
    ds_read_b64_tr_b16 v[46:47], v6 offset:648
    ds_read_b128 v[24:27], v5 offset:64
    ds_read_b128 v[28:31], v5 offset:640
    ds_read_b64_tr_b16 v[48:49], v6 offset:4608
    ds_read_b64_tr_b16 v[50:51], v6 offset:5184
    ds_read_b64_tr_b16 v[52:53], v6 offset:4616
    ds_read_b64_tr_b16 v[54:55], v6 offset:5192
    ds_read_b64_tr_b16 v[56:57], v6 offset:4672
    ds_read_b64_tr_b16 v[58:59], v6 offset:5248
    ds_read_b64_tr_b16 v[60:61], v6 offset:4680
    ds_read_b64_tr_b16 v[62:63], v6 offset:5256
    s_waitcnt lgkmcnt(0)
    buffer_load_dwordx4 v[128:131], v8, s[16:19], s34 offen sc1
    buffer_load_dwordx4 v[132:135], v9, s[16:19], s34 offen sc1
    buffer_load_dwordx4 v[136:139], v10, s[16:19], s34 offen sc1
    buffer_load_dwordx4 v[140:143], v11, s[16:19], s34 offen sc1
    s_add_u32 s36, s35, 0
    buffer_load_dwordx4 v[144:147], v12, s[12:15], s36 offen
    s_add_u32 s36, s35, 10240
    buffer_load_dwordx4 v[148:151], v12, s[12:15], s36 offen
    s_add_u32 s36, s35, 20480
    buffer_load_dwordx4 v[152:155], v12, s[12:15], s36 offen
    s_add_u32 s36, s35, 30720
    buffer_load_dwordx4 v[156:159], v12, s[12:15], s36 offen
    s_add_u32 s36, s35, 40960
    buffer_load_dwordx4 v[160:163], v12, s[12:15], s36 offen
    s_add_u32 s36, s35, 51200
    buffer_load_dwordx4 v[164:167], v12, s[12:15], s36 offen
    s_add_u32 s36, s35, 61440
    buffer_load_dwordx4 v[168:171], v12, s[12:15], s36 offen
    s_add_u32 s36, s35, 71680
    buffer_load_dwordx4 v[172:175], v12, s[12:15], s36 offen
    s_add_u32 s34, s34, 128
    s_add_u32 s35, s35, 81920
    v_mfma_f32_16x16x32_bf16 v[64:67], v[32:35], v[16:19], v[64:67]
    v_mfma_f32_16x16x32_bf16 v[68:71], v[32:35], v[20:23], v[68:71]
    v_mfma_f32_16x16x32_bf16 v[72:75], v[36:39], v[16:19], v[72:75]
    v_mfma_f32_16x16x32_bf16 v[76:79], v[36:39], v[20:23], v[76:79]
    v_mfma_f32_16x16x32_bf16 v[80:83], v[40:43], v[16:19], v[80:83]
    v_mfma_f32_16x16x32_bf16 v[84:87], v[40:43], v[20:23], v[84:87]
    v_mfma_f32_16x16x32_bf16 v[88:91], v[44:47], v[16:19], v[88:91]
    v_mfma_f32_16x16x32_bf16 v[92:95], v[44:47], v[20:23], v[92:95]
    v_mfma_f32_16x16x32_bf16 v[64:67], v[48:51], v[24:27], v[64:67]
    v_mfma_f32_16x16x32_bf16 v[68:71], v[48:51], v[28:31], v[68:71]
    v_mfma_f32_16x16x32_bf16 v[72:75], v[52:55], v[24:27], v[72:75]
    v_mfma_f32_16x16x32_bf16 v[76:79], v[52:55], v[28:31], v[76:79]
    v_mfma_f32_16x16x32_bf16 v[80:83], v[56:59], v[24:27], v[80:83]
    v_mfma_f32_16x16x32_bf16 v[84:87], v[56:59], v[28:31], v[84:87]
    v_mfma_f32_16x16x32_bf16 v[88:91], v[60:63], v[24:27], v[88:91]
    v_mfma_f32_16x16x32_bf16 v[92:95], v[60:63], v[28:31], v[92:95]
    s_waitcnt vmcnt(36)
    ds_write_b128 v3, a[0:3] offset:0
    ds_write_b128 v3, a[4:7] offset:1152
    ds_write_b128 v3, a[8:11] offset:2304
    ds_write_b128 v3, a[12:15] offset:3456
    ds_write_b128 v3, a[16:19] offset:4608
    ds_write_b128 v3, a[20:23] offset:5760
    ds_write_b128 v3, a[24:27] offset:6912
    ds_write_b128 v3, a[28:31] offset:8064
    ds_write_b128 v3, a[32:35] offset:9216
    ds_write_b128 v3, a[36:39] offset:10368
    ds_write_b128 v3, a[40:43] offset:11520
    ds_write_b128 v3, a[44:47] offset:12672
    ds_read_b128 v[16:19], v5 offset:0
    ds_read_b128 v[20:23], v5 offset:576
    ds_read_b64_tr_b16 v[32:33], v6 offset:0
    ds_read_b64_tr_b16 v[34:35], v6 offset:576
    ds_read_b64_tr_b16 v[36:37], v6 offset:8
    ds_read_b64_tr_b16 v[38:39], v6 offset:584
    ds_read_b64_tr_b16 v[40:41], v6 offset:64
    ds_read_b64_tr_b16 v[42:43], v6 offset:640
    ds_read_b64_tr_b16 v[44:45], v6 offset:72
    ds_read_b64_tr_b16 v[46:47], v6 offset:648
    ds_read_b128 v[24:27], v5 offset:64
    ds_read_b128 v[28:31], v5 offset:640
    ds_read_b64_tr_b16 v[48:49], v6 offset:4608
    ds_read_b64_tr_b16 v[50:51], v6 offset:5184
    ds_read_b64_tr_b16 v[52:53], v6 offset:4616
    ds_read_b64_tr_b16 v[54:55], v6 offset:5192
    ds_read_b64_tr_b16 v[56:57], v6 offset:4672
    ds_read_b64_tr_b16 v[58:59], v6 offset:5248
    ds_read_b64_tr_b16 v[60:61], v6 offset:4680
    ds_read_b64_tr_b16 v[62:63], v6 offset:5256
    s_waitcnt lgkmcnt(0)
    buffer_load_dwordx4 a[0:3], v8, s[16:19], s34 offen sc1
    buffer_load_dwordx4 a[4:7], v9, s[16:19], s34 offen sc1
    buffer_load_dwordx4 a[8:11], v10, s[16:19], s34 offen sc1
    buffer_load_dwordx4 a[12:15], v11, s[16:19], s34 offen sc1
    s_add_u32 s36, s35, 0
    buffer_load_dwordx4 a[16:19], v12, s[12:15], s36 offen
    s_add_u32 s36, s35, 10240
    buffer_load_dwordx4 a[20:23], v12, s[12:15], s36 offen
    s_add_u32 s36, s35, 20480
    buffer_load_dwordx4 a[24:27], v12, s[12:15], s36 offen
    s_add_u32 s36, s35, 30720
    buffer_load_dwordx4 a[28:31], v12, s[12:15], s36 offen
    s_add_u32 s36, s35, 40960
    buffer_load_dwordx4 a[32:35], v12, s[12:15], s36 offen
    s_add_u32 s36, s35, 51200
    buffer_load_dwordx4 a[36:39], v12, s[12:15], s36 offen
    s_add_u32 s36, s35, 61440
    buffer_load_dwordx4 a[40:43], v12, s[12:15], s36 offen
    s_add_u32 s36, s35, 71680
    buffer_load_dwordx4 a[44:47], v12, s[12:15], s36 offen
    s_add_u32 s34, s34, 128
    s_add_u32 s35, s35, 81920
    v_mfma_f32_16x16x32_bf16 v[64:67], v[32:35], v[16:19], v[64:67]
    v_mfma_f32_16x16x32_bf16 v[68:71], v[32:35], v[20:23], v[68:71]
    v_mfma_f32_16x16x32_bf16 v[72:75], v[36:39], v[16:19], v[72:75]
    v_mfma_f32_16x16x32_bf16 v[76:79], v[36:39], v[20:23], v[76:79]
    v_mfma_f32_16x16x32_bf16 v[80:83], v[40:43], v[16:19], v[80:83]
    v_mfma_f32_16x16x32_bf16 v[84:87], v[40:43], v[20:23], v[84:87]
    v_mfma_f32_16x16x32_bf16 v[88:91], v[44:47], v[16:19], v[88:91]
    v_mfma_f32_16x16x32_bf16 v[92:95], v[44:47], v[20:23], v[92:95]
    v_mfma_f32_16x16x32_bf16 v[64:67], v[48:51], v[24:27], v[64:67]
    v_mfma_f32_16x16x32_bf16 v[68:71], v[48:51], v[28:31], v[68:71]
    v_mfma_f32_16x16x32_bf16 v[72:75], v[52:55], v[24:27], v[72:75]
    v_mfma_f32_16x16x32_bf16 v[76:79], v[52:55], v[28:31], v[76:79]
    v_mfma_f32_16x16x32_bf16 v[80:83], v[56:59], v[24:27], v[80:83]
    v_mfma_f32_16x16x32_bf16 v[84:87], v[56:59], v[28:31], v[84:87]
    v_mfma_f32_16x16x32_bf16 v[88:91], v[60:63], v[24:27], v[88:91]
    v_mfma_f32_16x16x32_bf16 v[92:95], v[60:63], v[28:31], v[92:95]
    s_waitcnt vmcnt(36)
    ds_write_b128 v3, a[48:51] offset:0
    ds_write_b128 v3, a[52:55] offset:1152
    ds_write_b128 v3, a[56:59] offset:2304
    ds_write_b128 v3, a[60:63] offset:3456
    ds_write_b128 v3, a[64:67] offset:4608
    ds_write_b128 v3, a[68:71] offset:5760
    ds_write_b128 v3, a[72:75] offset:6912
    ds_write_b128 v3, a[76:79] offset:8064
    ds_write_b128 v3, a[80:83] offset:9216
    ds_write_b128 v3, a[84:87] offset:10368
    ds_write_b128 v3, a[88:91] offset:11520
    ds_write_b128 v3, a[92:95] offset:12672
    ds_read_b128 v[16:19], v5 offset:0
    ds_read_b128 v[20:23], v5 offset:576
    ds_read_b64_tr_b16 v[32:33], v6 offset:0
    ds_read_b64_tr_b16 v[34:35], v6 offset:576
    ds_read_b64_tr_b16 v[36:37], v6 offset:8
    ds_read_b64_tr_b16 v[38:39], v6 offset:584
    ds_read_b64_tr_b16 v[40:41], v6 offset:64
    ds_read_b64_tr_b16 v[42:43], v6 offset:640
    ds_read_b64_tr_b16 v[44:45], v6 offset:72
    ds_read_b64_tr_b16 v[46:47], v6 offset:648
    ds_read_b128 v[24:27], v5 offset:64
    ds_read_b128 v[28:31], v5 offset:640
    ds_read_b64_tr_b16 v[48:49], v6 offset:4608
    ds_read_b64_tr_b16 v[50:51], v6 offset:5184
    ds_read_b64_tr_b16 v[52:53], v6 offset:4616
    ds_read_b64_tr_b16 v[54:55], v6 offset:5192
    ds_read_b64_tr_b16 v[56:57], v6 offset:4672
    ds_read_b64_tr_b16 v[58:59], v6 offset:5248
    ds_read_b64_tr_b16 v[60:61], v6 offset:4680
    ds_read_b64_tr_b16 v[62:63], v6 offset:5256
    s_waitcnt lgkmcnt(0)
    buffer_load_dwordx4 a[48:51], v8, s[16:19], s34 offen sc1
    buffer_load_dwordx4 a[52:55], v9, s[16:19], s34 offen sc1
    buffer_load_dwordx4 a[56:59], v10, s[16:19], s34 offen sc1
    buffer_load_dwordx4 a[60:63], v11, s[16:19], s34 offen sc1
    s_add_u32 s36, s35, 0
    buffer_load_dwordx4 a[64:67], v12, s[12:15], s36 offen
    s_add_u32 s36, s35, 10240
    buffer_load_dwordx4 a[68:71], v12, s[12:15], s36 offen
    s_add_u32 s36, s35, 20480
    buffer_load_dwordx4 a[72:75], v12, s[12:15], s36 offen
    s_add_u32 s36, s35, 30720
    buffer_load_dwordx4 a[76:79], v12, s[12:15], s36 offen
    s_add_u32 s36, s35, 40960
    buffer_load_dwordx4 a[80:83], v12, s[12:15], s36 offen
    s_add_u32 s36, s35, 51200
    buffer_load_dwordx4 a[84:87], v12, s[12:15], s36 offen
    s_add_u32 s36, s35, 61440
    buffer_load_dwordx4 a[88:91], v12, s[12:15], s36 offen
    s_add_u32 s36, s35, 71680
    buffer_load_dwordx4 a[92:95], v12, s[12:15], s36 offen
    s_add_u32 s34, s34, 128
    s_add_u32 s35, s35, 81920
    v_mfma_f32_16x16x32_bf16 v[64:67], v[32:35], v[16:19], v[64:67]
    v_mfma_f32_16x16x32_bf16 v[68:71], v[32:35], v[20:23], v[68:71]
    v_mfma_f32_16x16x32_bf16 v[72:75], v[36:39], v[16:19], v[72:75]
    v_mfma_f32_16x16x32_bf16 v[76:79], v[36:39], v[20:23], v[76:79]
    v_mfma_f32_16x16x32_bf16 v[80:83], v[40:43], v[16:19], v[80:83]
    v_mfma_f32_16x16x32_bf16 v[84:87], v[40:43], v[20:23], v[84:87]
    v_mfma_f32_16x16x32_bf16 v[88:91], v[44:47], v[16:19], v[88:91]
    v_mfma_f32_16x16x32_bf16 v[92:95], v[44:47], v[20:23], v[92:95]
    v_mfma_f32_16x16x32_bf16 v[64:67], v[48:51], v[24:27], v[64:67]
    v_mfma_f32_16x16x32_bf16 v[68:71], v[48:51], v[28:31], v[68:71]
    v_mfma_f32_16x16x32_bf16 v[72:75], v[52:55], v[24:27], v[72:75]
    v_mfma_f32_16x16x32_bf16 v[76:79], v[52:55], v[28:31], v[76:79]
    v_mfma_f32_16x16x32_bf16 v[80:83], v[56:59], v[24:27], v[80:83]
    v_mfma_f32_16x16x32_bf16 v[84:87], v[56:59], v[28:31], v[84:87]
    v_mfma_f32_16x16x32_bf16 v[88:91], v[60:63], v[24:27], v[88:91]
    v_mfma_f32_16x16x32_bf16 v[92:95], v[60:63], v[28:31], v[92:95]
    s_waitcnt vmcnt(36)
    ds_write_b128 v3, a[96:99] offset:0
    ds_write_b128 v3, a[100:103] offset:1152
    ds_write_b128 v3, a[104:107] offset:2304
    ds_write_b128 v3, a[108:111] offset:3456
    ds_write_b128 v3, a[112:115] offset:4608
    ds_write_b128 v3, a[116:119] offset:5760
    ds_write_b128 v3, a[120:123] offset:6912
    ds_write_b128 v3, a[124:127] offset:8064
    ds_write_b128 v3, a[128:131] offset:9216
    ds_write_b128 v3, a[132:135] offset:10368
    ds_write_b128 v3, a[136:139] offset:11520
    ds_write_b128 v3, a[140:143] offset:12672
    ds_read_b128 v[16:19], v5 offset:0
    ds_read_b128 v[20:23], v5 offset:576
    ds_read_b64_tr_b16 v[32:33], v6 offset:0
    ds_read_b64_tr_b16 v[34:35], v6 offset:576
    ds_read_b64_tr_b16 v[36:37], v6 offset:8
    ds_read_b64_tr_b16 v[38:39], v6 offset:584
    ds_read_b64_tr_b16 v[40:41], v6 offset:64
    ds_read_b64_tr_b16 v[42:43], v6 offset:640
    ds_read_b64_tr_b16 v[44:45], v6 offset:72
    ds_read_b64_tr_b16 v[46:47], v6 offset:648
    ds_read_b128 v[24:27], v5 offset:64
    ds_read_b128 v[28:31], v5 offset:640
    ds_read_b64_tr_b16 v[48:49], v6 offset:4608
    ds_read_b64_tr_b16 v[50:51], v6 offset:5184
    ds_read_b64_tr_b16 v[52:53], v6 offset:4616
    ds_read_b64_tr_b16 v[54:55], v6 offset:5192
    ds_read_b64_tr_b16 v[56:57], v6 offset:4672
    ds_read_b64_tr_b16 v[58:59], v6 offset:5248
    ds_read_b64_tr_b16 v[60:61], v6 offset:4680
    ds_read_b64_tr_b16 v[62:63], v6 offset:5256
    s_waitcnt lgkmcnt(0)
    buffer_load_dwordx4 a[96:99], v8, s[16:19], s34 offen sc1
    buffer_load_dwordx4 a[100:103], v9, s[16:19], s34 offen sc1
    buffer_load_dwordx4 a[104:107], v10, s[16:19], s34 offen sc1
    buffer_load_dwordx4 a[108:111], v11, s[16:19], s34 offen sc1
    s_add_u32 s36, s35, 0
    buffer_load_dwordx4 a[112:115], v12, s[12:15], s36 offen
    s_add_u32 s36, s35, 10240
    buffer_load_dwordx4 a[116:119], v12, s[12:15], s36 offen
    s_add_u32 s36, s35, 20480
    buffer_load_dwordx4 a[120:123], v12, s[12:15], s36 offen
    s_add_u32 s36, s35, 30720
    buffer_load_dwordx4 a[124:127], v12, s[12:15], s36 offen
    s_add_u32 s36, s35, 40960
    buffer_load_dwordx4 a[128:131], v12, s[12:15], s36 offen
    s_add_u32 s36, s35, 51200
    buffer_load_dwordx4 a[132:135], v12, s[12:15], s36 offen
    s_add_u32 s36, s35, 61440
    buffer_load_dwordx4 a[136:139], v12, s[12:15], s36 offen
    s_add_u32 s36, s35, 71680
    buffer_load_dwordx4 a[140:143], v12, s[12:15], s36 offen
    s_add_u32 s34, s34, 128
    s_add_u32 s35, s35, 81920
    v_mfma_f32_16x16x32_bf16 v[64:67], v[32:35], v[16:19], v[64:67]
    v_mfma_f32_16x16x32_bf16 v[68:71], v[32:35], v[20:23], v[68:71]
    v_mfma_f32_16x16x32_bf16 v[72:75], v[36:39], v[16:19], v[72:75]
    v_mfma_f32_16x16x32_bf16 v[76:79], v[36:39], v[20:23], v[76:79]
    v_mfma_f32_16x16x32_bf16 v[80:83], v[40:43], v[16:19], v[80:83]
    v_mfma_f32_16x16x32_bf16 v[84:87], v[40:43], v[20:23], v[84:87]
    v_mfma_f32_16x16x32_bf16 v[88:91], v[44:47], v[16:19], v[88:91]
    v_mfma_f32_16x16x32_bf16 v[92:95], v[44:47], v[20:23], v[92:95]
    v_mfma_f32_16x16x32_bf16 v[64:67], v[48:51], v[24:27], v[64:67]
    v_mfma_f32_16x16x32_bf16 v[68:71], v[48:51], v[28:31], v[68:71]
    v_mfma_f32_16x16x32_bf16 v[72:75], v[52:55], v[24:27], v[72:75]
    v_mfma_f32_16x16x32_bf16 v[76:79], v[52:55], v[28:31], v[76:79]
    v_mfma_f32_16x16x32_bf16 v[80:83], v[56:59], v[24:27], v[80:83]
    v_mfma_f32_16x16x32_bf16 v[84:87], v[56:59], v[28:31], v[84:87]
    v_mfma_f32_16x16x32_bf16 v[88:91], v[60:63], v[24:27], v[88:91]
    v_mfma_f32_16x16x32_bf16 v[92:95], v[60:63], v[28:31], v[92:95]
    s_add_u32 s5, s5, 1
    s_cmp_lt_u32 s5, 3
    s_cbranch_scc1 .o2l_73
    s_waitcnt vmcnt(36)
    ds_write_b128 v3, v[128:131] offset:0
    ds_write_b128 v3, v[132:135] offset:1152
    ds_write_b128 v3, v[136:139] offset:2304
    ds_write_b128 v3, v[140:143] offset:3456
    ds_write_b128 v3, v[144:147] offset:4608
    ds_write_b128 v3, v[148:151] offset:5760
    ds_write_b128 v3, v[152:155] offset:6912
    ds_write_b128 v3, v[156:159] offset:8064
    ds_write_b128 v3, v[160:163] offset:9216
    ds_write_b128 v3, v[164:167] offset:10368
    ds_write_b128 v3, v[168:171] offset:11520
    ds_write_b128 v3, v[172:175] offset:12672
    ds_read_b128 v[16:19], v5 offset:0
    ds_read_b128 v[20:23], v5 offset:576
    ds_read_b64_tr_b16 v[32:33], v6 offset:0
    ds_read_b64_tr_b16 v[34:35], v6 offset:576
    ds_read_b64_tr_b16 v[36:37], v6 offset:8
    ds_read_b64_tr_b16 v[38:39], v6 offset:584
    ds_read_b64_tr_b16 v[40:41], v6 offset:64
    ds_read_b64_tr_b16 v[42:43], v6 offset:640
    ds_read_b64_tr_b16 v[44:45], v6 offset:72
    ds_read_b64_tr_b16 v[46:47], v6 offset:648
    ds_read_b128 v[24:27], v5 offset:64
    ds_read_b128 v[28:31], v5 offset:640
    ds_read_b64_tr_b16 v[48:49], v6 offset:4608
    ds_read_b64_tr_b16 v[50:51], v6 offset:5184
    ds_read_b64_tr_b16 v[52:53], v6 offset:4616
    ds_read_b64_tr_b16 v[54:55], v6 offset:5192
    ds_read_b64_tr_b16 v[56:57], v6 offset:4672
    ds_read_b64_tr_b16 v[58:59], v6 offset:5248
    ds_read_b64_tr_b16 v[60:61], v6 offset:4680
    ds_read_b64_tr_b16 v[62:63], v6 offset:5256
    s_waitcnt lgkmcnt(0)
    v_mfma_f32_16x16x32_bf16 v[64:67], v[32:35], v[16:19], v[64:67]
    v_mfma_f32_16x16x32_bf16 v[68:71], v[32:35], v[20:23], v[68:71]
    v_mfma_f32_16x16x32_bf16 v[72:75], v[36:39], v[16:19], v[72:75]
    v_mfma_f32_16x16x32_bf16 v[76:79], v[36:39], v[20:23], v[76:79]
    v_mfma_f32_16x16x32_bf16 v[80:83], v[40:43], v[16:19], v[80:83]
    v_mfma_f32_16x16x32_bf16 v[84:87], v[40:43], v[20:23], v[84:87]
    v_mfma_f32_16x16x32_bf16 v[88:91], v[44:47], v[16:19], v[88:91]
    v_mfma_f32_16x16x32_bf16 v[92:95], v[44:47], v[20:23], v[92:95]
    v_mfma_f32_16x16x32_bf16 v[64:67], v[48:51], v[24:27], v[64:67]
    v_mfma_f32_16x16x32_bf16 v[68:71], v[48:51], v[28:31], v[68:71]
    v_mfma_f32_16x16x32_bf16 v[72:75], v[52:55], v[24:27], v[72:75]
    v_mfma_f32_16x16x32_bf16 v[76:79], v[52:55], v[28:31], v[76:79]
    v_mfma_f32_16x16x32_bf16 v[80:83], v[56:59], v[24:27], v[80:83]
    v_mfma_f32_16x16x32_bf16 v[84:87], v[56:59], v[28:31], v[84:87]
    v_mfma_f32_16x16x32_bf16 v[88:91], v[60:63], v[24:27], v[88:91]
    v_mfma_f32_16x16x32_bf16 v[92:95], v[60:63], v[28:31], v[92:95]
    s_waitcnt vmcnt(24)
    ds_write_b128 v3, a[0:3] offset:0
    ds_write_b128 v3, a[4:7] offset:1152
    ds_write_b128 v3, a[8:11] offset:2304
    ds_write_b128 v3, a[12:15] offset:3456
    ds_write_b128 v3, a[16:19] offset:4608
    ds_write_b128 v3, a[20:23] offset:5760
    ds_write_b128 v3, a[24:27] offset:6912
    ds_write_b128 v3, a[28:31] offset:8064
    ds_write_b128 v3, a[32:35] offset:9216
    ds_write_b128 v3, a[36:39] offset:10368
    ds_write_b128 v3, a[40:43] offset:11520
    ds_write_b128 v3, a[44:47] offset:12672
    ds_read_b128 v[16:19], v5 offset:0
    ds_read_b128 v[20:23], v5 offset:576
    ds_read_b64_tr_b16 v[32:33], v6 offset:0
    ds_read_b64_tr_b16 v[34:35], v6 offset:576
    ds_read_b64_tr_b16 v[36:37], v6 offset:8
    ds_read_b64_tr_b16 v[38:39], v6 offset:584
    ds_read_b64_tr_b16 v[40:41], v6 offset:64
    ds_read_b64_tr_b16 v[42:43], v6 offset:640
    ds_read_b64_tr_b16 v[44:45], v6 offset:72
    ds_read_b64_tr_b16 v[46:47], v6 offset:648
    ds_read_b128 v[24:27], v5 offset:64
    ds_read_b128 v[28:31], v5 offset:640
    ds_read_b64_tr_b16 v[48:49], v6 offset:4608
    ds_read_b64_tr_b16 v[50:51], v6 offset:5184
    ds_read_b64_tr_b16 v[52:53], v6 offset:4616
    ds_read_b64_tr_b16 v[54:55], v6 offset:5192
    ds_read_b64_tr_b16 v[56:57], v6 offset:4672
    ds_read_b64_tr_b16 v[58:59], v6 offset:5248
    ds_read_b64_tr_b16 v[60:61], v6 offset:4680
    ds_read_b64_tr_b16 v[62:63], v6 offset:5256
    s_waitcnt lgkmcnt(0)
    v_mfma_f32_16x16x32_bf16 v[64:67], v[32:35], v[16:19], v[64:67]
    v_mfma_f32_16x16x32_bf16 v[68:71], v[32:35], v[20:23], v[68:71]
    v_mfma_f32_16x16x32_bf16 v[72:75], v[36:39], v[16:19], v[72:75]
    v_mfma_f32_16x16x32_bf16 v[76:79], v[36:39], v[20:23], v[76:79]
    v_mfma_f32_16x16x32_bf16 v[80:83], v[40:43], v[16:19], v[80:83]
    v_mfma_f32_16x16x32_bf16 v[84:87], v[40:43], v[20:23], v[84:87]
    v_mfma_f32_16x16x32_bf16 v[88:91], v[44:47], v[16:19], v[88:91]
    v_mfma_f32_16x16x32_bf16 v[92:95], v[44:47], v[20:23], v[92:95]
    v_mfma_f32_16x16x32_bf16 v[64:67], v[48:51], v[24:27], v[64:67]
    v_mfma_f32_16x16x32_bf16 v[68:71], v[48:51], v[28:31], v[68:71]
    v_mfma_f32_16x16x32_bf16 v[72:75], v[52:55], v[24:27], v[72:75]
    v_mfma_f32_16x16x32_bf16 v[76:79], v[52:55], v[28:31], v[76:79]
    v_mfma_f32_16x16x32_bf16 v[80:83], v[56:59], v[24:27], v[80:83]
    v_mfma_f32_16x16x32_bf16 v[84:87], v[56:59], v[28:31], v[84:87]
    v_mfma_f32_16x16x32_bf16 v[88:91], v[60:63], v[24:27], v[88:91]
    v_mfma_f32_16x16x32_bf16 v[92:95], v[60:63], v[28:31], v[92:95]
    s_waitcnt vmcnt(12)
    ds_write_b128 v3, a[48:51] offset:0
    ds_write_b128 v3, a[52:55] offset:1152
    ds_write_b128 v3, a[56:59] offset:2304
    ds_write_b128 v3, a[60:63] offset:3456
    ds_write_b128 v3, a[64:67] offset:4608
    ds_write_b128 v3, a[68:71] offset:5760
    ds_write_b128 v3, a[72:75] offset:6912
    ds_write_b128 v3, a[76:79] offset:8064
    ds_write_b128 v3, a[80:83] offset:9216
    ds_write_b128 v3, a[84:87] offset:10368
    ds_write_b128 v3, a[88:91] offset:11520
    ds_write_b128 v3, a[92:95] offset:12672
    ds_read_b128 v[16:19], v5 offset:0
    ds_read_b128 v[20:23], v5 offset:576
    ds_read_b64_tr_b16 v[32:33], v6 offset:0
    ds_read_b64_tr_b16 v[34:35], v6 offset:576
    ds_read_b64_tr_b16 v[36:37], v6 offset:8
    ds_read_b64_tr_b16 v[38:39], v6 offset:584
    ds_read_b64_tr_b16 v[40:41], v6 offset:64
    ds_read_b64_tr_b16 v[42:43], v6 offset:640
    ds_read_b64_tr_b16 v[44:45], v6 offset:72
    ds_read_b64_tr_b16 v[46:47], v6 offset:648
    ds_read_b128 v[24:27], v5 offset:64
    ds_read_b128 v[28:31], v5 offset:640
    ds_read_b64_tr_b16 v[48:49], v6 offset:4608
    ds_read_b64_tr_b16 v[50:51], v6 offset:5184
    ds_read_b64_tr_b16 v[52:53], v6 offset:4616
    ds_read_b64_tr_b16 v[54:55], v6 offset:5192
    ds_read_b64_tr_b16 v[56:57], v6 offset:4672
    ds_read_b64_tr_b16 v[58:59], v6 offset:5248
    ds_read_b64_tr_b16 v[60:61], v6 offset:4680
    ds_read_b64_tr_b16 v[62:63], v6 offset:5256
    s_waitcnt lgkmcnt(0)
    v_mfma_f32_16x16x32_bf16 v[64:67], v[32:35], v[16:19], v[64:67]
    v_mfma_f32_16x16x32_bf16 v[68:71], v[32:35], v[20:23], v[68:71]
    v_mfma_f32_16x16x32_bf16 v[72:75], v[36:39], v[16:19], v[72:75]
    v_mfma_f32_16x16x32_bf16 v[76:79], v[36:39], v[20:23], v[76:79]
    v_mfma_f32_16x16x32_bf16 v[80:83], v[40:43], v[16:19], v[80:83]
    v_mfma_f32_16x16x32_bf16 v[84:87], v[40:43], v[20:23], v[84:87]
    v_mfma_f32_16x16x32_bf16 v[88:91], v[44:47], v[16:19], v[88:91]
    v_mfma_f32_16x16x32_bf16 v[92:95], v[44:47], v[20:23], v[92:95]
    v_mfma_f32_16x16x32_bf16 v[64:67], v[48:51], v[24:27], v[64:67]
    v_mfma_f32_16x16x32_bf16 v[68:71], v[48:51], v[28:31], v[68:71]
    v_mfma_f32_16x16x32_bf16 v[72:75], v[52:55], v[24:27], v[72:75]
    v_mfma_f32_16x16x32_bf16 v[76:79], v[52:55], v[28:31], v[76:79]
    v_mfma_f32_16x16x32_bf16 v[80:83], v[56:59], v[24:27], v[80:83]
    v_mfma_f32_16x16x32_bf16 v[84:87], v[56:59], v[28:31], v[84:87]
    v_mfma_f32_16x16x32_bf16 v[88:91], v[60:63], v[24:27], v[88:91]
    v_mfma_f32_16x16x32_bf16 v[92:95], v[60:63], v[28:31], v[92:95]
    s_waitcnt vmcnt(0)
    ds_write_b128 v3, a[96:99] offset:0
    ds_write_b128 v3, a[100:103] offset:1152
    ds_write_b128 v3, a[104:107] offset:2304
    ds_write_b128 v3, a[108:111] offset:3456
    ds_write_b128 v3, a[112:115] offset:4608
    ds_write_b128 v3, a[116:119] offset:5760
    ds_write_b128 v3, a[120:123] offset:6912
    ds_write_b128 v3, a[124:127] offset:8064
    ds_write_b128 v3, a[128:131] offset:9216
    ds_write_b128 v3, a[132:135] offset:10368
    ds_write_b128 v3, a[136:139] offset:11520
    ds_write_b128 v3, a[140:143] offset:12672
    ds_read_b128 v[16:19], v5 offset:0
    ds_read_b128 v[20:23], v5 offset:576
    ds_read_b64_tr_b16 v[32:33], v6 offset:0
    ds_read_b64_tr_b16 v[34:35], v6 offset:576
    ds_read_b64_tr_b16 v[36:37], v6 offset:8
    ds_read_b64_tr_b16 v[38:39], v6 offset:584
    ds_read_b64_tr_b16 v[40:41], v6 offset:64
    ds_read_b64_tr_b16 v[42:43], v6 offset:640
    ds_read_b64_tr_b16 v[44:45], v6 offset:72
    ds_read_b64_tr_b16 v[46:47], v6 offset:648
    ds_read_b128 v[24:27], v5 offset:64
    ds_read_b128 v[28:31], v5 offset:640
    ds_read_b64_tr_b16 v[48:49], v6 offset:4608
    ds_read_b64_tr_b16 v[50:51], v6 offset:5184
    ds_read_b64_tr_b16 v[52:53], v6 offset:4616
    ds_read_b64_tr_b16 v[54:55], v6 offset:5192
    ds_read_b64_tr_b16 v[56:57], v6 offset:4672
    ds_read_b64_tr_b16 v[58:59], v6 offset:5248
    ds_read_b64_tr_b16 v[60:61], v6 offset:4680
    ds_read_b64_tr_b16 v[62:63], v6 offset:5256
    s_waitcnt lgkmcnt(0)
    v_mfma_f32_16x16x32_bf16 v[64:67], v[32:35], v[16:19], v[64:67]
    v_mfma_f32_16x16x32_bf16 v[68:71], v[32:35], v[20:23], v[68:71]
    v_mfma_f32_16x16x32_bf16 v[72:75], v[36:39], v[16:19], v[72:75]
    v_mfma_f32_16x16x32_bf16 v[76:79], v[36:39], v[20:23], v[76:79]
    v_mfma_f32_16x16x32_bf16 v[80:83], v[40:43], v[16:19], v[80:83]
    v_mfma_f32_16x16x32_bf16 v[84:87], v[40:43], v[20:23], v[84:87]
    v_mfma_f32_16x16x32_bf16 v[88:91], v[44:47], v[16:19], v[88:91]
    v_mfma_f32_16x16x32_bf16 v[92:95], v[44:47], v[20:23], v[92:95]
    v_mfma_f32_16x16x32_bf16 v[64:67], v[48:51], v[24:27], v[64:67]
    v_mfma_f32_16x16x32_bf16 v[68:71], v[48:51], v[28:31], v[68:71]
    v_mfma_f32_16x16x32_bf16 v[72:75], v[52:55], v[24:27], v[72:75]
    v_mfma_f32_16x16x32_bf16 v[76:79], v[52:55], v[28:31], v[76:79]
    v_mfma_f32_16x16x32_bf16 v[80:83], v[56:59], v[24:27], v[80:83]
    v_mfma_f32_16x16x32_bf16 v[84:87], v[56:59], v[28:31], v[84:87]
    v_mfma_f32_16x16x32_bf16 v[88:91], v[60:63], v[24:27], v[88:91]
    v_mfma_f32_16x16x32_bf16 v[92:95], v[60:63], v[28:31], v[92:95]
    s_nop 7
    s_barrier
    v_and_b32 v24, 15, v7
    v_lshrrev_b32 v25, 4, v7
    v_lshrrev_b32 v26, 2, v24
    v_and_b32 v27, 3, v24
    s_lshl_b32 s7, s6, 13
    v_lshlrev_b32 v3, 4, v7
    v_add_u32 v4, s7, v3
    ds_write_b128 v4, v[64:67] offset:0
    ds_write_b128 v4, v[68:71] offset:1024
    ds_write_b128 v4, v[72:75] offset:2048
    ds_write_b128 v4, v[76:79] offset:3072
    ds_write_b128 v4, v[80:83] offset:4096
    ds_write_b128 v4, v[84:87] offset:5120
    ds_write_b128 v4, v[88:91] offset:6144
    ds_write_b128 v4, v[92:95] offset:7168
    s_waitcnt lgkmcnt(0)
    s_barrier
    s_lshr_b32 s37, s6, 1
    s_and_b32 s38, s6, 1
    s_lshl_b32 s7, s37, 12
    s_lshl_b32 s36, s38, 10
    s_add_u32 s7, s7, s36
    v_add_u32 v4, s7, v3
    ds_read_b128 v[64:67], v4 offset:0
    ds_read_b128 v[68:71], v4 offset:2048
    ds_read_b128 v[72:75], v4 offset:8192
    ds_read_b128 v[76:79], v4 offset:10240
    ds_read_b128 v[80:83], v4 offset:16384
    ds_read_b128 v[84:87], v4 offset:18432
    ds_read_b128 v[88:91], v4 offset:24576
    ds_read_b128 v[92:95], v4 offset:26624
    v_lshl_add_u32 v28, v26, 3, v27
    s_lshl_b32 s7, s30, 5
    s_lshl_b32 s36, s38, 2
    s_add_u32 s7, s7, s36
    v_add_u32 v28, s7, v28
    v_lshlrev_b32 v30, 3, v28
    v_add_u32 v30, 103809024, v30
    v_mul_u32_u24 v29, 1280, v28
    v_lshl_add_u32 v29, v25, 4, v29
    s_lshl_b32 s7, s31, 7
    s_lshl_b32 s36, s37, 6
    s_add_u32 s7, s7, s36
    v_add_u32 v29, s7, v29
    s_mov_b32 s36, 100663296
    buffer_load_dwordx2 v[100:101], v30, s[16:19], 0 offen sc1
    buffer_load_dwordx4 v[104:107], v29, s[16:19], s36 offen sc1
    s_waitcnt lgkmcnt(0)
    v_pk_add_f32 v[64:65], v[64:65], v[72:73]
    v_pk_add_f32 v[80:81], v[80:81], v[88:89]
    v_pk_add_f32 v[66:67], v[66:67], v[74:75]
    v_pk_add_f32 v[82:83], v[82:83], v[90:91]
    v_pk_add_f32 v[68:69], v[68:69], v[76:77]
    v_pk_add_f32 v[84:85], v[84:85], v[92:93]
    v_pk_add_f32 v[70:71], v[70:71], v[78:79]
    v_pk_add_f32 v[86:87], v[86:87], v[94:95]
    v_pk_add_f32 v[64:65], v[64:65], v[80:81]
    v_pk_add_f32 v[66:67], v[66:67], v[82:83]
    v_pk_add_f32 v[68:69], v[68:69], v[84:85]
    v_pk_add_f32 v[70:71], v[70:71], v[86:87]
    s_waitcnt vmcnt(0)
    v_cvt_pk_bf16_f32 v16, v64, v65
    v_lshlrev_b32 v17, 16, v16
    v_and_b32 v18, 0xffff0000, v16
    v_mul_f32 v17, v17, v101
    v_mul_f32 v18, v18, v101
    v_cvt_pk_bf16_f32 v16, v17, v18
    v_lshlrev_b32 v17, 16, v104
    v_and_b32 v18, 0xffff0000, v104
    v_mul_f32 v17, v17, v100
    v_mul_f32 v18, v18, v100
    v_cvt_pk_bf16_f32 v19, v17, v18
    v_lshlrev_b32 v17, 16, v16
    v_and_b32 v18, 0xffff0000, v16
    v_lshlrev_b32 v20, 16, v19
    v_and_b32 v21, 0xffff0000, v19
    v_add_f32 v17, v17, v20
    v_add_f32 v18, v18, v21
    v_cvt_pk_bf16_f32 v32, v17, v18
    v_cvt_pk_bf16_f32 v16, v66, v67
    v_lshlrev_b32 v17, 16, v16
    v_and_b32 v18, 0xffff0000, v16
    v_mul_f32 v17, v17, v101
    v_mul_f32 v18, v18, v101
    v_cvt_pk_bf16_f32 v16, v17, v18
    v_lshlrev_b32 v17, 16, v105
    v_and_b32 v18, 0xffff0000, v105
    v_mul_f32 v17, v17, v100
    v_mul_f32 v18, v18, v100
    v_cvt_pk_bf16_f32 v19, v17, v18
    v_lshlrev_b32 v17, 16, v16
    v_and_b32 v18, 0xffff0000, v16
    v_lshlrev_b32 v20, 16, v19
    v_and_b32 v21, 0xffff0000, v19
    v_add_f32 v17, v17, v20
    v_add_f32 v18, v18, v21
    v_cvt_pk_bf16_f32 v33, v17, v18
    v_cvt_pk_bf16_f32 v16, v68, v69
    v_lshlrev_b32 v17, 16, v16
    v_and_b32 v18, 0xffff0000, v16
    v_mul_f32 v17, v17, v101
    v_mul_f32 v18, v18, v101
    v_cvt_pk_bf16_f32 v16, v17, v18
    v_lshlrev_b32 v17, 16, v106
    v_and_b32 v18, 0xffff0000, v106
    v_mul_f32 v17, v17, v100
    v_mul_f32 v18, v18, v100
    v_cvt_pk_bf16_f32 v19, v17, v18
    v_lshlrev_b32 v17, 16, v16
    v_and_b32 v18, 0xffff0000, v16
    v_lshlrev_b32 v20, 16, v19
    v_and_b32 v21, 0xffff0000, v19
    v_add_f32 v17, v17, v20
    v_add_f32 v18, v18, v21
    v_cvt_pk_bf16_f32 v34, v17, v18
    v_cvt_pk_bf16_f32 v16, v70, v71
    v_lshlrev_b32 v17, 16, v16
    v_and_b32 v18, 0xffff0000, v16
    v_mul_f32 v17, v17, v101
    v_mul_f32 v18, v18, v101
    v_cvt_pk_bf16_f32 v16, v17, v18
    v_lshlrev_b32 v17, 16, v107
    v_and_b32 v18, 0xffff0000, v107
    v_mul_f32 v17, v17, v100
    v_mul_f32 v18, v18, v100
    v_cvt_pk_bf16_f32 v19, v17, v18
    v_lshlrev_b32 v17, 16, v16
    v_and_b32 v18, 0xffff0000, v16
    v_lshlrev_b32 v20, 16, v19
    v_and_b32 v21, 0xffff0000, v19
    v_add_f32 v17, v17, v20
    v_add_f32 v18, v18, v21
    v_cvt_pk_bf16_f32 v35, v17, v18
    buffer_store_dwordx4 v[32:35], v29, s[20:23], 0 offen
.o2done_74:
    s_branch .wloop_21
.tOS_69:
    s_mov_b32 s12, s56
    s_and_b32 s13, s57, 0xffff
    s_mov_b32 s14, 5242880
    s_mov_b32 s15, 0x00020000
    s_and_b32 s39, s3, 3
    s_lshr_b32 s3, s3, 2
    s_mul_i32 s30, s3, 52429
    s_lshr_b32 s30, s30, 19
    s_mul_i32 s31, s30, 10
    s_sub_u32 s31, s3, s31
    v_and_b32 v7, 63, v0
    v_lshrrev_b32 v20, 6, v0
    s_nop 0
    v_readfirstlane_b32 s6, v20
    v_and_b32 v24, 15, v7
    v_lshrrev_b32 v25, 4, v7
    v_lshrrev_b32 v26, 2, v24
    v_and_b32 v27, 3, v24
    s_mul_i32 s32, s6, 13824
    v_lshrrev_b32 v20, 3, v7
    v_and_b32 v21, 7, v7
    v_mul_u32_u24 v3, 144, v20
    v_lshl_add_u32 v3, v21, 4, v3
    v_add_u32 v3, s32, v3
    s_lshl_b32 s7, s30, 5
    v_add_u32 v28, s7, v20
    v_lshlrev_b32 v8, 13, v28
    v_lshl_add_u32 v8, v21, 4, v8
    s_lshl_b32 s7, s39, 2
    s_add_u32 s7, s7, s6
    s_mov_b32 s38, s7
    s_lshl_b32 s7, s7, 9
    s_add_u32 s7, s7, 50331648
    v_add_u32 v8, s7, v8
    v_add_u32 v9, 0x10000, v8
    v_add_u32 v10, 0x20000, v8
    v_add_u32 v11, 0x30000, v8
    v_mul_u32_u24 v12, 1280, v20
    v_lshl_add_u32 v12, v21, 4, v12
    s_mul_i32 s7, s38, 327680
    s_lshl_b32 s33, s31, 7
    s_add_u32 s7, s7, s33
    v_add_u32 v12, s7, v12
    v_lshl_add_u32 v28, v26, 3, v27
    v_mul_u32_u24 v5, 144, v28
    v_lshl_add_u32 v5, v25, 4, v5
    v_add_u32 v5, s32, v5
    v_lshl_add_u32 v28, v25, 3, v26
    v_mul_u32_u24 v6, 144, v28
    v_lshl_add_u32 v6, v27, 4, v6
    v_add_u32 v6, s32, v6
    v_add_u32 v6, 4608, v6
    s_mov_b32 s34, 0
    s_mov_b32 s35, 0
    v_mov_b32 v64, 0
    v_mov_b32 v65, 0
    v_mov_b32 v66, 0
    v_mov_b32 v67, 0
    v_mov_b32 v68, 0
    v_mov_b32 v69, 0
    v_mov_b32 v70, 0
    v_mov_b32 v71, 0
    v_mov_b32 v72, 0
    v_mov_b32 v73, 0
    v_mov_b32 v74, 0
    v_mov_b32 v75, 0
    v_mov_b32 v76, 0
    v_mov_b32 v77, 0
    v_mov_b32 v78, 0
    v_mov_b32 v79, 0
    v_mov_b32 v80, 0
    v_mov_b32 v81, 0
    v_mov_b32 v82, 0
    v_mov_b32 v83, 0
    v_mov_b32 v84, 0
    v_mov_b32 v85, 0
    v_mov_b32 v86, 0
    v_mov_b32 v87, 0
    v_mov_b32 v88, 0
    v_mov_b32 v89, 0
    v_mov_b32 v90, 0
    v_mov_b32 v91, 0
    v_mov_b32 v92, 0
    v_mov_b32 v93, 0
    v_mov_b32 v94, 0
    v_mov_b32 v95, 0
    s_mov_b32 s36, 0
    buffer_load_dwordx4 v[144:147], v12, s[12:15], s36 offen
    s_mov_b32 s36, 10240
    buffer_load_dwordx4 v[148:151], v12, s[12:15], s36 offen
    s_mov_b32 s36, 20480
    buffer_load_dwordx4 v[152:155], v12, s[12:15], s36 offen
    s_mov_b32 s36, 30720
    buffer_load_dwordx4 v[156:159], v12, s[12:15], s36 offen
    s_mov_b32 s36, 40960
    buffer_load_dwordx4 v[160:163], v12, s[12:15], s36 offen
    s_mov_b32 s36, 51200
    buffer_load_dwordx4 v[164:167], v12, s[12:15], s36 offen
    s_mov_b32 s36, 61440
    buffer_load_dwordx4 v[168:171], v12, s[12:15], s36 offen
    s_mov_b32 s36, 71680
    buffer_load_dwordx4 v[172:175], v12, s[12:15], s36 offen
    s_mov_b32 s36, 81920
    buffer_load_dwordx4 a[16:19], v12, s[12:15], s36 offen
    s_mov_b32 s36, 92160
    buffer_load_dwordx4 a[20:23], v12, s[12:15], s36 offen
    s_mov_b32 s36, 102400
    buffer_load_dwordx4 a[24:27], v12, s[12:15], s36 offen
    s_mov_b32 s36, 112640
    buffer_load_dwordx4 a[28:31], v12, s[12:15], s36 offen
    s_mov_b32 s36, 122880
    buffer_load_dwordx4 a[32:35], v12, s[12:15], s36 offen
    s_mov_b32 s36, 133120
    buffer_load_dwordx4 a[36:39], v12, s[12:15], s36 offen
    s_mov_b32 s36, 143360
    buffer_load_dwordx4 a[40:43], v12, s[12:15], s36 offen
    s_mov_b32 s36, 153600
    buffer_load_dwordx4 a[44:47], v12, s[12:15], s36 offen
    s_mov_b32 s36, 163840
    buffer_load_dwordx4 a[64:67], v12, s[12:15], s36 offen
    s_mov_b32 s36, 174080
    buffer_load_dwordx4 a[68:71], v12, s[12:15], s36 offen
    s_mov_b32 s36, 184320
    buffer_load_dwordx4 a[72:75], v12, s[12:15], s36 offen
    s_mov_b32 s36, 194560
    buffer_load_dwordx4 a[76:79], v12, s[12:15], s36 offen
    s_mov_b32 s36, 204800
    buffer_load_dwordx4 a[80:83], v12, s[12:15], s36 offen
    s_mov_b32 s36, 215040
    buffer_load_dwordx4 a[84:87], v12, s[12:15], s36 offen
    s_mov_b32 s36, 225280
    buffer_load_dwordx4 a[88:91], v12, s[12:15], s36 offen
    s_mov_b32 s36, 235520
    buffer_load_dwordx4 a[92:95], v12, s[12:15], s36 offen
    s_mov_b32 s36, 245760
    buffer_load_dwordx4 a[112:115], v12, s[12:15], s36 offen
    s_mov_b32 s36, 256000
    buffer_load_dwordx4 a[116:119], v12, s[12:15], s36 offen
    s_mov_b32 s36, 266240
    buffer_load_dwordx4 a[120:123], v12, s[12:15], s36 offen
    s_mov_b32 s36, 276480
    buffer_load_dwordx4 a[124:127], v12, s[12:15], s36 offen
    s_mov_b32 s36, 286720
    buffer_load_dwordx4 a[128:131], v12, s[12:15], s36 offen
    s_mov_b32 s36, 296960
    buffer_load_dwordx4 a[132:135], v12, s[12:15], s36 offen
    s_mov_b32 s36, 307200
    buffer_load_dwordx4 a[136:139], v12, s[12:15], s36 offen
    s_mov_b32 s36, 317440
    buffer_load_dwordx4 a[140:143], v12, s[12:15], s36 offen
    s_mov_b32 s37, s39
    s_mov_b32 s39, s6
    s_cmp_lg_u32 s39, 0
    s_cbranch_scc1 .wsk_75
    s_lshl_b32 s100, s95, 6
    s_add_u32 s100, s100, 109060288
    v_mov_b32 v250, s100
    s_mov_b32 s101, 0
.ww_76:
    buffer_load_dword v251, v250, s[16:19], 0 offen sc1
    s_waitcnt vmcnt(0)
    v_readfirstlane_b32 s100, v251
    s_cmp_ge_u32 s100, 8
    s_cbranch_scc1 .wok_77
    s_add_u32 s101, s101, 1
    s_cmp_gt_u32 s101, 200000
    s_cbranch_scc1 .fexit_3
    s_sleep 8
    s_branch .ww_76
.wok_77:
.wsk_75:
    s_barrier
    s_mov_b32 s39, s37
    buffer_load_dwordx4 v[128:131], v8, s[16:19], 0 offen offset:0 sc1
    buffer_load_dwordx4 v[132:135], v9, s[16:19], 0 offen offset:0 sc1
    buffer_load_dwordx4 v[136:139], v10, s[16:19], 0 offen offset:0 sc1
    buffer_load_dwordx4 v[140:143], v11, s[16:19], 0 offen offset:0 sc1
    buffer_load_dwordx4 a[0:3], v8, s[16:19], 0 offen offset:128 sc1
    buffer_load_dwordx4 a[4:7], v9, s[16:19], 0 offen offset:128 sc1
    buffer_load_dwordx4 a[8:11], v10, s[16:19], 0 offen offset:128 sc1
    buffer_load_dwordx4 a[12:15], v11, s[16:19], 0 offen offset:128 sc1
    buffer_load_dwordx4 a[48:51], v8, s[16:19], 0 offen offset:256 sc1
    buffer_load_dwordx4 a[52:55], v9, s[16:19], 0 offen offset:256 sc1
    buffer_load_dwordx4 a[56:59], v10, s[16:19], 0 offen offset:256 sc1
    buffer_load_dwordx4 a[60:63], v11, s[16:19], 0 offen offset:256 sc1
    buffer_load_dwordx4 a[96:99], v8, s[16:19], 0 offen offset:384 sc1
    buffer_load_dwordx4 a[100:103], v9, s[16:19], 0 offen offset:384 sc1
    buffer_load_dwordx4 a[104:107], v10, s[16:19], 0 offen offset:384 sc1
    buffer_load_dwordx4 a[108:111], v11, s[16:19], 0 offen offset:384 sc1
    s_mov_b32 s5, 0
.o2l_78:
    s_waitcnt vmcnt(12)
    ds_write_b128 v3, v[128:131] offset:0
    ds_write_b128 v3, v[132:135] offset:1152
    ds_write_b128 v3, v[136:139] offset:2304
    ds_write_b128 v3, v[140:143] offset:3456
    ds_write_b128 v3, v[144:147] offset:4608
    ds_write_b128 v3, v[148:151] offset:5760
    ds_write_b128 v3, v[152:155] offset:6912
    ds_write_b128 v3, v[156:159] offset:8064
    ds_write_b128 v3, v[160:163] offset:9216
    ds_write_b128 v3, v[164:167] offset:10368
    ds_write_b128 v3, v[168:171] offset:11520
    ds_write_b128 v3, v[172:175] offset:12672
    ds_read_b128 v[16:19], v5 offset:0
    ds_read_b128 v[20:23], v5 offset:576
    ds_read_b64_tr_b16 v[32:33], v6 offset:0
    ds_read_b64_tr_b16 v[34:35], v6 offset:576
    ds_read_b64_tr_b16 v[36:37], v6 offset:8
    ds_read_b64_tr_b16 v[38:39], v6 offset:584
    ds_read_b64_tr_b16 v[40:41], v6 offset:64
    ds_read_b64_tr_b16 v[42:43], v6 offset:640
    ds_read_b64_tr_b16 v[44:45], v6 offset:72
    ds_read_b64_tr_b16 v[46:47], v6 offset:648
    ds_read_b128 v[24:27], v5 offset:64
    ds_read_b128 v[28:31], v5 offset:640
    ds_read_b64_tr_b16 v[48:49], v6 offset:4608
    ds_read_b64_tr_b16 v[50:51], v6 offset:5184
    ds_read_b64_tr_b16 v[52:53], v6 offset:4616
    ds_read_b64_tr_b16 v[54:55], v6 offset:5192
    ds_read_b64_tr_b16 v[56:57], v6 offset:4672
    ds_read_b64_tr_b16 v[58:59], v6 offset:5248
    ds_read_b64_tr_b16 v[60:61], v6 offset:4680
    ds_read_b64_tr_b16 v[62:63], v6 offset:5256
    s_waitcnt lgkmcnt(0)
    v_mfma_f32_16x16x32_bf16 v[64:67], v[32:35], v[16:19], v[64:67]
    v_mfma_f32_16x16x32_bf16 v[68:71], v[32:35], v[20:23], v[68:71]
    v_mfma_f32_16x16x32_bf16 v[72:75], v[36:39], v[16:19], v[72:75]
    v_mfma_f32_16x16x32_bf16 v[76:79], v[36:39], v[20:23], v[76:79]
    v_mfma_f32_16x16x32_bf16 v[80:83], v[40:43], v[16:19], v[80:83]
    v_mfma_f32_16x16x32_bf16 v[84:87], v[40:43], v[20:23], v[84:87]
    v_mfma_f32_16x16x32_bf16 v[88:91], v[44:47], v[16:19], v[88:91]
    v_mfma_f32_16x16x32_bf16 v[92:95], v[44:47], v[20:23], v[92:95]
    v_mfma_f32_16x16x32_bf16 v[64:67], v[48:51], v[24:27], v[64:67]
    v_mfma_f32_16x16x32_bf16 v[68:71], v[48:51], v[28:31], v[68:71]
    v_mfma_f32_16x16x32_bf16 v[72:75], v[52:55], v[24:27], v[72:75]
    v_mfma_f32_16x16x32_bf16 v[76:79], v[52:55], v[28:31], v[76:79]
    v_mfma_f32_16x16x32_bf16 v[80:83], v[56:59], v[24:27], v[80:83]
    v_mfma_f32_16x16x32_bf16 v[84:87], v[56:59], v[28:31], v[84:87]
    v_mfma_f32_16x16x32_bf16 v[88:91], v[60:63], v[24:27], v[88:91]
    v_mfma_f32_16x16x32_bf16 v[92:95], v[60:63], v[28:31], v[92:95]
    s_waitcnt vmcnt(8)
    ds_write_b128 v3, a[0:3] offset:0
    ds_write_b128 v3, a[4:7] offset:1152
    ds_write_b128 v3, a[8:11] offset:2304
    ds_write_b128 v3, a[12:15] offset:3456
    ds_write_b128 v3, a[16:19] offset:4608
    ds_write_b128 v3, a[20:23] offset:5760
    ds_write_b128 v3, a[24:27] offset:6912
    ds_write_b128 v3, a[28:31] offset:8064
    ds_write_b128 v3, a[32:35] offset:9216
    ds_write_b128 v3, a[36:39] offset:10368
    ds_write_b128 v3, a[40:43] offset:11520
    ds_write_b128 v3, a[44:47] offset:12672
    ds_read_b128 v[16:19], v5 offset:0
    ds_read_b128 v[20:23], v5 offset:576
    ds_read_b64_tr_b16 v[32:33], v6 offset:0
    ds_read_b64_tr_b16 v[34:35], v6 offset:576
    ds_read_b64_tr_b16 v[36:37], v6 offset:8
    ds_read_b64_tr_b16 v[38:39], v6 offset:584
    ds_read_b64_tr_b16 v[40:41], v6 offset:64
    ds_read_b64_tr_b16 v[42:43], v6 offset:640
    ds_read_b64_tr_b16 v[44:45], v6 offset:72
    ds_read_b64_tr_b16 v[46:47], v6 offset:648
    ds_read_b128 v[24:27], v5 offset:64
    ds_read_b128 v[28:31], v5 offset:640
    ds_read_b64_tr_b16 v[48:49], v6 offset:4608
    ds_read_b64_tr_b16 v[50:51], v6 offset:5184
    ds_read_b64_tr_b16 v[52:53], v6 offset:4616
    ds_read_b64_tr_b16 v[54:55], v6 offset:5192
    ds_read_b64_tr_b16 v[56:57], v6 offset:4672
    ds_read_b64_tr_b16 v[58:59], v6 offset:5248
    ds_read_b64_tr_b16 v[60:61], v6 offset:4680
    ds_read_b64_tr_b16 v[62:63], v6 offset:5256
    s_waitcnt lgkmcnt(0)
    v_mfma_f32_16x16x32_bf16 v[64:67], v[32:35], v[16:19], v[64:67]
    v_mfma_f32_16x16x32_bf16 v[68:71], v[32:35], v[20:23], v[68:71]
    v_mfma_f32_16x16x32_bf16 v[72:75], v[36:39], v[16:19], v[72:75]
    v_mfma_f32_16x16x32_bf16 v[76:79], v[36:39], v[20:23], v[76:79]
    v_mfma_f32_16x16x32_bf16 v[80:83], v[40:43], v[16:19], v[80:83]
    v_mfma_f32_16x16x32_bf16 v[84:87], v[40:43], v[20:23], v[84:87]
    v_mfma_f32_16x16x32_bf16 v[88:91], v[44:47], v[16:19], v[88:91]
    v_mfma_f32_16x16x32_bf16 v[92:95], v[44:47], v[20:23], v[92:95]
    v_mfma_f32_16x16x32_bf16 v[64:67], v[48:51], v[24:27], v[64:67]
    v_mfma_f32_16x16x32_bf16 v[68:71], v[48:51], v[28:31], v[68:71]
    v_mfma_f32_16x16x32_bf16 v[72:75], v[52:55], v[24:27], v[72:75]
    v_mfma_f32_16x16x32_bf16 v[76:79], v[52:55], v[28:31], v[76:79]
    v_mfma_f32_16x16x32_bf16 v[80:83], v[56:59], v[24:27], v[80:83]
    v_mfma_f32_16x16x32_bf16 v[84:87], v[56:59], v[28:31], v[84:87]
    v_mfma_f32_16x16x32_bf16 v[88:91], v[60:63], v[24:27], v[88:91]
    v_mfma_f32_16x16x32_bf16 v[92:95], v[60:63], v[28:31], v[92:95]
    s_waitcnt vmcnt(4)
    ds_write_b128 v3, a[48:51] offset:0
    ds_write_b128 v3, a[52:55] offset:1152
    ds_write_b128 v3, a[56:59] offset:2304
    ds_write_b128 v3, a[60:63] offset:3456
    ds_write_b128 v3, a[64:67] offset:4608
    ds_write_b128 v3, a[68:71] offset:5760
    ds_write_b128 v3, a[72:75] offset:6912
    ds_write_b128 v3, a[76:79] offset:8064
    ds_write_b128 v3, a[80:83] offset:9216
    ds_write_b128 v3, a[84:87] offset:10368
    ds_write_b128 v3, a[88:91] offset:11520
    ds_write_b128 v3, a[92:95] offset:12672
    ds_read_b128 v[16:19], v5 offset:0
    ds_read_b128 v[20:23], v5 offset:576
    ds_read_b64_tr_b16 v[32:33], v6 offset:0
    ds_read_b64_tr_b16 v[34:35], v6 offset:576
    ds_read_b64_tr_b16 v[36:37], v6 offset:8
    ds_read_b64_tr_b16 v[38:39], v6 offset:584
    ds_read_b64_tr_b16 v[40:41], v6 offset:64
    ds_read_b64_tr_b16 v[42:43], v6 offset:640
    ds_read_b64_tr_b16 v[44:45], v6 offset:72
    ds_read_b64_tr_b16 v[46:47], v6 offset:648
    ds_read_b128 v[24:27], v5 offset:64
    ds_read_b128 v[28:31], v5 offset:640
    ds_read_b64_tr_b16 v[48:49], v6 offset:4608
    ds_read_b64_tr_b16 v[50:51], v6 offset:5184
    ds_read_b64_tr_b16 v[52:53], v6 offset:4616
    ds_read_b64_tr_b16 v[54:55], v6 offset:5192
    ds_read_b64_tr_b16 v[56:57], v6 offset:4672
    ds_read_b64_tr_b16 v[58:59], v6 offset:5248
    ds_read_b64_tr_b16 v[60:61], v6 offset:4680
    ds_read_b64_tr_b16 v[62:63], v6 offset:5256
    s_waitcnt lgkmcnt(0)
    v_mfma_f32_16x16x32_bf16 v[64:67], v[32:35], v[16:19], v[64:67]
    v_mfma_f32_16x16x32_bf16 v[68:71], v[32:35], v[20:23], v[68:71]
    v_mfma_f32_16x16x32_bf16 v[72:75], v[36:39], v[16:19], v[72:75]
    v_mfma_f32_16x16x32_bf16 v[76:79], v[36:39], v[20:23], v[76:79]
    v_mfma_f32_16x16x32_bf16 v[80:83], v[40:43], v[16:19], v[80:83]
    v_mfma_f32_16x16x32_bf16 v[84:87], v[40:43], v[20:23], v[84:87]
    v_mfma_f32_16x16x32_bf16 v[88:91], v[44:47], v[16:19], v[88:91]
    v_mfma_f32_16x16x32_bf16 v[92:95], v[44:47], v[20:23], v[92:95]
    v_mfma_f32_16x16x32_bf16 v[64:67], v[48:51], v[24:27], v[64:67]
    v_mfma_f32_16x16x32_bf16 v[68:71], v[48:51], v[28:31], v[68:71]
    v_mfma_f32_16x16x32_bf16 v[72:75], v[52:55], v[24:27], v[72:75]
    v_mfma_f32_16x16x32_bf16 v[76:79], v[52:55], v[28:31], v[76:79]
    v_mfma_f32_16x16x32_bf16 v[80:83], v[56:59], v[24:27], v[80:83]
    v_mfma_f32_16x16x32_bf16 v[84:87], v[56:59], v[28:31], v[84:87]
    v_mfma_f32_16x16x32_bf16 v[88:91], v[60:63], v[24:27], v[88:91]
    v_mfma_f32_16x16x32_bf16 v[92:95], v[60:63], v[28:31], v[92:95]
    s_waitcnt vmcnt(0)
    ds_write_b128 v3, a[96:99] offset:0
    ds_write_b128 v3, a[100:103] offset:1152
    ds_write_b128 v3, a[104:107] offset:2304
    ds_write_b128 v3, a[108:111] offset:3456
    ds_write_b128 v3, a[112:115] offset:4608
    ds_write_b128 v3, a[116:119] offset:5760
    ds_write_b128 v3, a[120:123] offset:6912
    ds_write_b128 v3, a[124:127] offset:8064
    ds_write_b128 v3, a[128:131] offset:9216
    ds_write_b128 v3, a[132:135] offset:10368
    ds_write_b128 v3, a[136:139] offset:11520
    ds_write_b128 v3, a[140:143] offset:12672
    ds_read_b128 v[16:19], v5 offset:0
    ds_read_b128 v[20:23], v5 offset:576
    ds_read_b64_tr_b16 v[32:33], v6 offset:0
    ds_read_b64_tr_b16 v[34:35], v6 offset:576
    ds_read_b64_tr_b16 v[36:37], v6 offset:8
    ds_read_b64_tr_b16 v[38:39], v6 offset:584
    ds_read_b64_tr_b16 v[40:41], v6 offset:64
    ds_read_b64_tr_b16 v[42:43], v6 offset:640
    ds_read_b64_tr_b16 v[44:45], v6 offset:72
    ds_read_b64_tr_b16 v[46:47], v6 offset:648
    ds_read_b128 v[24:27], v5 offset:64
    ds_read_b128 v[28:31], v5 offset:640
    ds_read_b64_tr_b16 v[48:49], v6 offset:4608
    ds_read_b64_tr_b16 v[50:51], v6 offset:5184
    ds_read_b64_tr_b16 v[52:53], v6 offset:4616
    ds_read_b64_tr_b16 v[54:55], v6 offset:5192
    ds_read_b64_tr_b16 v[56:57], v6 offset:4672
    ds_read_b64_tr_b16 v[58:59], v6 offset:5248
    ds_read_b64_tr_b16 v[60:61], v6 offset:4680
    ds_read_b64_tr_b16 v[62:63], v6 offset:5256
    s_waitcnt lgkmcnt(0)
    v_mfma_f32_16x16x32_bf16 v[64:67], v[32:35], v[16:19], v[64:67]
    v_mfma_f32_16x16x32_bf16 v[68:71], v[32:35], v[20:23], v[68:71]
    v_mfma_f32_16x16x32_bf16 v[72:75], v[36:39], v[16:19], v[72:75]
    v_mfma_f32_16x16x32_bf16 v[76:79], v[36:39], v[20:23], v[76:79]
    v_mfma_f32_16x16x32_bf16 v[80:83], v[40:43], v[16:19], v[80:83]
    v_mfma_f32_16x16x32_bf16 v[84:87], v[40:43], v[20:23], v[84:87]
    v_mfma_f32_16x16x32_bf16 v[88:91], v[44:47], v[16:19], v[88:91]
    v_mfma_f32_16x16x32_bf16 v[92:95], v[44:47], v[20:23], v[92:95]
    v_mfma_f32_16x16x32_bf16 v[64:67], v[48:51], v[24:27], v[64:67]
    v_mfma_f32_16x16x32_bf16 v[68:71], v[48:51], v[28:31], v[68:71]
    v_mfma_f32_16x16x32_bf16 v[72:75], v[52:55], v[24:27], v[72:75]
    v_mfma_f32_16x16x32_bf16 v[76:79], v[52:55], v[28:31], v[76:79]
    v_mfma_f32_16x16x32_bf16 v[80:83], v[56:59], v[24:27], v[80:83]
    v_mfma_f32_16x16x32_bf16 v[84:87], v[56:59], v[28:31], v[84:87]
    v_mfma_f32_16x16x32_bf16 v[88:91], v[60:63], v[24:27], v[88:91]
    v_mfma_f32_16x16x32_bf16 v[92:95], v[60:63], v[28:31], v[92:95]
    s_nop 7
    s_barrier
    v_and_b32 v24, 15, v7
    v_lshrrev_b32 v25, 4, v7
    v_lshrrev_b32 v26, 2, v24
    v_and_b32 v27, 3, v24
    s_lshl_b32 s7, s6, 13
    v_lshlrev_b32 v3, 4, v7
    v_add_u32 v4, s7, v3
    ds_write_b128 v4, v[64:67] offset:0
    ds_write_b128 v4, v[68:71] offset:1024
    ds_write_b128 v4, v[72:75] offset:2048
    ds_write_b128 v4, v[76:79] offset:3072
    ds_write_b128 v4, v[80:83] offset:4096
    ds_write_b128 v4, v[84:87] offset:5120
    ds_write_b128 v4, v[88:91] offset:6144
    ds_write_b128 v4, v[92:95] offset:7168
    s_waitcnt lgkmcnt(0)
    s_barrier
    s_lshr_b32 s37, s6, 1
    s_and_b32 s38, s6, 1
    s_lshl_b32 s7, s37, 12
    s_lshl_b32 s36, s38, 10
    s_add_u32 s7, s7, s36
    v_add_u32 v4, s7, v3
    ds_read_b128 v[64:67], v4 offset:0
    ds_read_b128 v[68:71], v4 offset:2048
    ds_read_b128 v[72:75], v4 offset:8192
    ds_read_b128 v[76:79], v4 offset:10240
    ds_read_b128 v[80:83], v4 offset:16384
    ds_read_b128 v[84:87], v4 offset:18432
    ds_read_b128 v[88:91], v4 offset:24576
    ds_read_b128 v[92:95], v4 offset:26624
    v_lshl_add_u32 v28, v26, 3, v27
    s_lshl_b32 s7, s30, 5
    s_lshl_b32 s36, s38, 2
    s_add_u32 s7, s7, s36
    v_add_u32 v28, s7, v28
    v_lshlrev_b32 v30, 3, v28
    v_add_u32 v30, 103809024, v30
    v_mul_u32_u24 v29, 1280, v28
    v_lshl_add_u32 v29, v25, 4, v29
    s_lshl_b32 s7, s31, 7
    s_lshl_b32 s36, s37, 6
    s_add_u32 s7, s7, s36
    v_add_u32 v29, s7, v29
    s_mov_b32 s36, 100663296
    buffer_load_dwordx2 v[100:101], v30, s[16:19], 0 offen sc1
    buffer_load_dwordx4 v[104:107], v29, s[16:19], s36 offen sc1
    s_waitcnt lgkmcnt(0)
    v_pk_add_f32 v[64:65], v[64:65], v[72:73]
    v_pk_add_f32 v[80:81], v[80:81], v[88:89]
    v_pk_add_f32 v[66:67], v[66:67], v[74:75]
    v_pk_add_f32 v[82:83], v[82:83], v[90:91]
    v_pk_add_f32 v[68:69], v[68:69], v[76:77]
    v_pk_add_f32 v[84:85], v[84:85], v[92:93]
    v_pk_add_f32 v[70:71], v[70:71], v[78:79]
    v_pk_add_f32 v[86:87], v[86:87], v[94:95]
    v_pk_add_f32 v[64:65], v[64:65], v[80:81]
    v_pk_add_f32 v[66:67], v[66:67], v[82:83]
    v_pk_add_f32 v[68:69], v[68:69], v[84:85]
    v_pk_add_f32 v[70:71], v[70:71], v[86:87]
    s_lshl_b32 s7, s3, 2
    s_add_u32 s7, s7, s39
    s_lshl_b32 s7, s7, 13
    s_add_u32 s7, s7, 117440512
    v_lshlrev_b32 v3, 5, v0
    buffer_store_dwordx4 v[64:67], v3, s[16:19], s7 offen sc1
    buffer_store_dwordx4 v[68:71], v3, s[16:19], s7 offen offset:16 sc1
    s_waitcnt vmcnt(0)
    s_barrier
    v_mov_b32 v4, 1
    s_lshl_b32 s7, s3, 2
    s_add_u32 s7, s7, 109068288
    v_mov_b32 v5, s7
    v_cmp_eq_u32 vcc, 0, v0
    s_and_saveexec_b64 s[84:85], vcc
    s_cbranch_execz .Lo2sk
    buffer_atomic_add v4, v5, s[16:19], 0 offen sc0
    s_waitcnt vmcnt(0)
    v_mov_b32 v5, 151000
    ds_write_b32 v5, v4
.Lo2sk:
    s_mov_b64 exec, s[84:85]
    s_waitcnt lgkmcnt(0)
    s_barrier
    v_mov_b32 v5, 151000
    ds_read_b32 v4, v5
    s_waitcnt lgkmcnt(0)
    v_readfirstlane_b32 s7, v4
    s_cmp_lg_u32 s7, 3
    s_cbranch_scc1 .o2done_79
    s_lshl_b32 s7, s3, 15
    s_add_u32 s7, s7, 117440512
    buffer_load_dwordx4 v[64:67], v3, s[16:19], s7 offen sc1
    buffer_load_dwordx4 v[68:71], v3, s[16:19], s7 offen offset:16 sc1
    s_add_u32 s7, s7, 8192
    buffer_load_dwordx4 v[72:75], v3, s[16:19], s7 offen sc1
    buffer_load_dwordx4 v[76:79], v3, s[16:19], s7 offen offset:16 sc1
    s_add_u32 s7, s7, 8192
    buffer_load_dwordx4 v[80:83], v3, s[16:19], s7 offen sc1
    buffer_load_dwordx4 v[84:87], v3, s[16:19], s7 offen offset:16 sc1
    s_add_u32 s7, s7, 8192
    buffer_load_dwordx4 v[88:91], v3, s[16:19], s7 offen sc1
    buffer_load_dwordx4 v[92:95], v3, s[16:19], s7 offen offset:16 sc1
    s_add_u32 s7, s7, 8192
    s_waitcnt vmcnt(0)
    v_pk_add_f32 v[64:65], v[64:65], v[72:73]
    v_pk_add_f32 v[80:81], v[80:81], v[88:89]
    v_pk_add_f32 v[66:67], v[66:67], v[74:75]
    v_pk_add_f32 v[82:83], v[82:83], v[90:91]
    v_pk_add_f32 v[68:69], v[68:69], v[76:77]
    v_pk_add_f32 v[84:85], v[84:85], v[92:93]
    v_pk_add_f32 v[70:71], v[70:71], v[78:79]
    v_pk_add_f32 v[86:87], v[86:87], v[94:95]
    v_pk_add_f32 v[64:65], v[64:65], v[80:81]
    v_pk_add_f32 v[66:67], v[66:67], v[82:83]
    v_pk_add_f32 v[68:69], v[68:69], v[84:85]
    v_pk_add_f32 v[70:71], v[70:71], v[86:87]
    s_waitcnt vmcnt(0)
    v_cvt_pk_bf16_f32 v16, v64, v65
    v_lshlrev_b32 v17, 16, v16
    v_and_b32 v18, 0xffff0000, v16
    v_mul_f32 v17, v17, v101
    v_mul_f32 v18, v18, v101
    v_cvt_pk_bf16_f32 v16, v17, v18
    v_lshlrev_b32 v17, 16, v104
    v_and_b32 v18, 0xffff0000, v104
    v_mul_f32 v17, v17, v100
    v_mul_f32 v18, v18, v100
    v_cvt_pk_bf16_f32 v19, v17, v18
    v_lshlrev_b32 v17, 16, v16
    v_and_b32 v18, 0xffff0000, v16
    v_lshlrev_b32 v20, 16, v19
    v_and_b32 v21, 0xffff0000, v19
    v_add_f32 v17, v17, v20
    v_add_f32 v18, v18, v21
    v_cvt_pk_bf16_f32 v32, v17, v18
    v_cvt_pk_bf16_f32 v16, v66, v67
    v_lshlrev_b32 v17, 16, v16
    v_and_b32 v18, 0xffff0000, v16
    v_mul_f32 v17, v17, v101
    v_mul_f32 v18, v18, v101
    v_cvt_pk_bf16_f32 v16, v17, v18
    v_lshlrev_b32 v17, 16, v105
    v_and_b32 v18, 0xffff0000, v105
    v_mul_f32 v17, v17, v100
    v_mul_f32 v18, v18, v100
    v_cvt_pk_bf16_f32 v19, v17, v18
    v_lshlrev_b32 v17, 16, v16
    v_and_b32 v18, 0xffff0000, v16
    v_lshlrev_b32 v20, 16, v19
    v_and_b32 v21, 0xffff0000, v19
    v_add_f32 v17, v17, v20
    v_add_f32 v18, v18, v21
    v_cvt_pk_bf16_f32 v33, v17, v18
    v_cvt_pk_bf16_f32 v16, v68, v69
    v_lshlrev_b32 v17, 16, v16
    v_and_b32 v18, 0xffff0000, v16
    v_mul_f32 v17, v17, v101
    v_mul_f32 v18, v18, v101
    v_cvt_pk_bf16_f32 v16, v17, v18
    v_lshlrev_b32 v17, 16, v106
    v_and_b32 v18, 0xffff0000, v106
    v_mul_f32 v17, v17, v100
    v_mul_f32 v18, v18, v100
    v_cvt_pk_bf16_f32 v19, v17, v18
    v_lshlrev_b32 v17, 16, v16
    v_and_b32 v18, 0xffff0000, v16
    v_lshlrev_b32 v20, 16, v19
    v_and_b32 v21, 0xffff0000, v19
    v_add_f32 v17, v17, v20
    v_add_f32 v18, v18, v21
    v_cvt_pk_bf16_f32 v34, v17, v18
    v_cvt_pk_bf16_f32 v16, v70, v71
    v_lshlrev_b32 v17, 16, v16
    v_and_b32 v18, 0xffff0000, v16
    v_mul_f32 v17, v17, v101
    v_mul_f32 v18, v18, v101
    v_cvt_pk_bf16_f32 v16, v17, v18
    v_lshlrev_b32 v17, 16, v107
    v_and_b32 v18, 0xffff0000, v107
    v_mul_f32 v17, v17, v100
    v_mul_f32 v18, v18, v100
    v_cvt_pk_bf16_f32 v19, v17, v18
    v_lshlrev_b32 v17, 16, v16
    v_and_b32 v18, 0xffff0000, v16
    v_lshlrev_b32 v20, 16, v19
    v_and_b32 v21, 0xffff0000, v19
    v_add_f32 v17, v17, v20
    v_add_f32 v18, v18, v21
    v_cvt_pk_bf16_f32 v35, v17, v18
    buffer_store_dwordx4 v[32:35], v29, s[20:23], 0 offen
.o2done_79:
    v_lshrrev_b32 v250, 6, v0
    s_nop 0
    v_readfirstlane_b32 s39, v250
    s_branch .wloop_21
.fexit_3:
.exit_1:
    s_endpgm
.section .rodata,"a"
.p2align 6
.amdhsa_kernel fused_kernel
  .amdhsa_next_free_vgpr 512
  .amdhsa_next_free_sgpr 102
  .amdhsa_accum_offset 256
  .amdhsa_group_segment_fixed_size 0
  .amdhsa_kernarg_size 112
  .amdhsa_user_sgpr_count 2
  .amdhsa_user_sgpr_kernarg_segment_ptr 1
  .amdhsa_system_sgpr_workgroup_id_x 1
.end_amdhsa_kernel
```
